```python
import torch

def _softmax(x, axis=-1):
    return torch.softmax(x, dim=axis)
def _gelu(x):
    return torch.nn.functional.gelu(x, approximate="tanh")
def _silu(x):
    return torch.nn.functional.silu(x)
def _sigmoid(x):
    return torch.sigmoid(x)
def _layernorm(x, axis=-1, eps=1e-5):
    m = x.mean(dim=axis, keepdim=True)
    v = x.var(dim=axis, keepdim=True, unbiased=False)
    return (x - m) / torch.sqrt(v + eps)
def _scatter_add(tgt, idx, src, axis=0):
    return tgt.clone().index_add_(axis, idx, src)
def _segment_sum(src, seg, n):
    out = torch.zeros((n,) + src.shape[1:], dtype=src.dtype)
    return out.index_add_(0, seg, src)
def _pad(x, pw):
    flat = tuple(v for pair in reversed(pw) for v in pair)
    return torch.nn.functional.pad(x, flat)

kernel_name = 'standalone__gqa_softmax__near_ridge'

def setup_inputs():

    _w = (lambda a: (lambda t: t.to(torch.bfloat16) if t.is_floating_point() else t)(torch.as_tensor(a)))
    B, Hq, Hkv, Sq, Sk, D = 8, 32, 8, 384, 512, 128
    return {
        "q": _w((lambda *s: torch.randn(*s, dtype=torch.bfloat16) * 0.8)(B, Hq, Sq, D)),
        "k": _w((lambda *s: torch.randn(*s, dtype=torch.bfloat16) * 0.8)(B, Hkv, Sk, D)),
        "v": _w((lambda *s: torch.randn(*s, dtype=torch.bfloat16) * 0.05)(B, Hkv, Sk, D)),
    }

def reference(q, k, v):
    B, Hq, Sq, D = q.shape
    Hkv = k.shape[1]
    rep = Hq // Hkv
    k = (lambda x, n, axis: torch.repeat_interleave(x, n, dim=axis))(k, rep, axis=1)
    v = (lambda x, n, axis: torch.repeat_interleave(x, n, dim=axis))(v, rep, axis=1)
    scale = D ** -0.5
    scores = torch.einsum("bhqd,bhkd->bhqk", q, k) * scale
    p = _softmax(scores, axis=-1)
    return torch.einsum("bhqk,bhkd->bhqd", p, v)
```

```asm
; @launch grid=(256,1,1) block=(256,1,1) lds=163840
.amdgcn_target "amdgcn-amd-amdhsa--gfx950"
.text
.globl standalone__gqa_softmax__near_ridge_kernel
.p2align 12
.p2align 8
.type standalone__gqa_softmax__near_ridge_kernel,@function
standalone__gqa_softmax__near_ridge_kernel:
    s_load_dwordx8 s[4:11], s[0:1], 0
    s_cmp_ge_u32 s2, 256
    s_cbranch_scc1 L_end
    s_getpc_b64 s[32:33]
    s_lshr_b32 s3, s2, 3
    s_and_b32 s3, s3, 3
    s_lshl_b32 s3, s3, 13
    v_and_b32 v245, 15, v0
    v_lshrrev_b32 v246, 6, v0
    v_lshl_add_u32 v245, v246, 4, v245
    v_lshl_add_u32 v245, v245, 7, s3
    s_mov_b64 exec, 0xffff
    global_load_dword v244, v245, s[32:33]
    s_mov_b64 exec, -1
    v_lshrrev_b32 v247, 6, v0
    v_and_b32 v0, 63, v0
    s_and_b32 s3, s2, 7
    v_readfirstlane_b32 s28, v247
    s_lshr_b32 s2, s2, 3
    s_lshl_b32 s3, s3, 5
    s_add_u32 s2, s2, s3
    s_lshr_b32 s3, s2, 2
    s_mul_i32 s30, s2, 98304
    s_lshl_b32 s31, s3, 17
    v_and_b32 v250, 15, v0
    v_lshrrev_b32 v251, 4, v0
    v_lshrrev_b32 v253, 3, v0
    v_lshl_add_u32 v252, v247, 5, v253
    v_lshlrev_b32 v255, 8, v252
    v_and_b32 v254, 7, v0
    v_xor_b32 v254, v251, v254
    v_and_b32 v253, 1, v253
    v_lshlrev_b32 v253, 2, v253
    v_xor_b32 v254, v253, v254
    v_lshl_add_u32 v240, v254, 4, v255
    v_xor_b32 v241, 64, v240
    v_add_u32 v242, 0x800, v240
    v_add_u32 v241, 0x400, v241
    v_add_u32 v243, 0x800, v241
    v_lshl_add_u32 v252, v247, 3, v251
    v_and_b32 v253, 15, v252
    v_xor_b32 v254, v253, v250
    v_lshlrev_b32 v255, 8, v252
    v_lshl_add_u32 v13, v254, 4, v255
    v_xor_b32 v254, 4, v254
    v_lshl_add_u32 v14, v254, 4, v255
    s_lshl_b32 s42, s28, 13
    s_add_u32 s42, s42, 131072
    s_lshl_b32 s28, s28, 11
    s_mov_b32 s36, 0
    s_movk_i32 s37, 128
    s_mov_b32 s44, 0
    s_mov_b32 s14, 98304
    s_mov_b32 s15, 0x00020000
    s_mov_b32 s18, 131072
    s_mov_b32 s19, 0x00020000
    s_waitcnt lgkmcnt(0)
    s_add_u32 s16, s6, s31
    s_addc_u32 s17, s7, 0
    s_add_u32 s12, s4, s30
    s_addc_u32 s13, s5, 0
    s_add_u32 m0, s28, 0
    s_nop 0
    buffer_load_dwordx4 v13, s[16:19], s44 offen offset:0 nt lds
    buffer_load_dwordx4 v14, s[16:19], s44 offen offset:1024 nt lds
    s_add_u32 m0, s42, 0
    s_nop 0
    buffer_load_dwordx4 v240, s[12:15], s36 offen offset:0 nt lds
    buffer_load_dwordx4 v241, s[12:15], s36 offen offset:1024 nt lds
    buffer_load_dwordx4 v242, s[12:15], s36 offen offset:2048 nt lds
    buffer_load_dwordx4 v243, s[12:15], s36 offen offset:3072 nt lds
    s_add_u32 m0, s42, 4096
    s_nop 0
    buffer_load_dwordx4 v240, s[12:15], s37 offen offset:0 nt lds
    buffer_load_dwordx4 v241, s[12:15], s37 offen offset:1024 nt lds
    buffer_load_dwordx4 v242, s[12:15], s37 offen offset:2048 nt lds
    buffer_load_dwordx4 v243, s[12:15], s37 offen offset:3072 nt lds
    v_lshlrev_b32 v254, 2, v251
    v_xor_b32 v254, v254, v250
    v_lshl_add_u32 v15, v254, 4, v255
    s_add_u32 s20, s8, s31
    s_addc_u32 s21, s9, 0
    s_mov_b32 s22, 131072
    s_mov_b32 s23, 0x00020000
    s_add_u32 s24, s10, s30
    s_addc_u32 s25, s11, 0
    s_mov_b32 s26, 98304
    s_mov_b32 s27, 0x00020000
    s_mov_b32 s29, 0x53800000
    s_mov_b32 s34, 0x3e0293ee
    s_mov_b32 s35, 0xffff0000
    s_mov_b32 s38, 32768
    s_mov_b32 s39, 32896
    s_mov_b32 s40, 65536
    s_mov_b32 s41, 65664
    s_mov_b32 s45, 8192
    s_mov_b32 s46, 16384
    s_mov_b32 s47, 24576
    s_mov_b32 s48, 32768
    s_mov_b32 s49, 40960
    s_mov_b32 s50, 49152
    s_mov_b32 s51, 57344
    s_mov_b32 s52, 65536
    s_mov_b32 s53, 73728
    s_mov_b32 s54, 81920
    s_mov_b32 s55, 90112
    s_mov_b32 s56, 98304
    s_mov_b32 s57, 106496
    s_mov_b32 s58, 114688
    s_mov_b32 s59, 122880
    v_and_b32 v248, 31, v0
    v_lshrrev_b32 v249, 5, v0
    v_lshlrev_b32 v255, 8, v248
    v_xor_b32 v254, v249, v250
    v_lshl_add_u32 v1, v254, 4, v255
    v_xor_b32 v2, 32, v1
    v_xor_b32 v3, 64, v1
    v_xor_b32 v4, 96, v1
    v_xor_b32 v5, 128, v1
    v_xor_b32 v6, 160, v1
    v_xor_b32 v7, 192, v1
    v_xor_b32 v8, 224, v1
    v_bfe_u32 v254, v0, 1, 3
    v_xor_b32 v254, v249, v254
    v_and_b32 v255, 1, v0
    v_lshlrev_b32 v255, 2, v255
    v_xor_b32 v254, v255, v254
    v_lshlrev_b32 v255, 7, v248
    v_lshl_add_u32 v255, v254, 4, v255
    v_add_u32 v232, s42, v255
    v_xor_b32 v233, 32, v232
    v_xor_b32 v234, 64, v232
    v_xor_b32 v235, 96, v232
    v_lshl_add_u32 v239, v247, 5, v248
    v_lshlrev_b32 v239, 8, v239
    v_lshl_add_u32 v239, v249, 4, v239
    v_lshlrev_b32 v16, 4, v0
    v_add_u32 v16, s42, v16
    v_lshrrev_b32 v252, 2, v250
    v_lshl_add_u32 v253, v249, 2, v252
    v_lshlrev_b32 v253, 8, v253
    v_and_b32 v254, 1, v251
    v_lshl_add_u32 v253, v254, 5, v253
    v_and_b32 v254, 1, v0
    v_lshl_add_u32 v253, v254, 4, v253
    v_bfe_u32 v254, v0, 1, 1
    v_lshl_add_u32 v253, v254, 3, v253
    v_add_u32 v253, 65536, v253
    v_lshl_add_u32 v9, v252, 6, v253
    v_xor_b32 v10, 64, v9
    v_xor_b32 v11, 0x80, v9
    v_xor_b32 v12, 0xc0, v9
    s_lshr_b32 s3, s28, 11
    s_cmp_eq_u32 s3, 0
    s_cbranch_scc1 L_stub0_0
    s_cmp_eq_u32 s3, 1
    s_cbranch_scc1 L_stub1_0
    s_cmp_eq_u32 s3, 2
    s_cbranch_scc1 L_stub2_0
    s_cmp_eq_u32 s3, 3
    s_cbranch_scc1 L_stub3_0
L_walk_done:
    s_cmp_eq_u32 s3, 99
    s_add_u32 m0, s28, 8192
    s_nop 0
    buffer_load_dwordx4 v13, s[16:19], s45 offen offset:0 nt lds
    buffer_load_dwordx4 v14, s[16:19], s45 offen offset:1024 nt lds
    s_add_u32 m0, s28, 16384
    s_nop 0
    buffer_load_dwordx4 v13, s[16:19], s46 offen offset:0 nt lds
    buffer_load_dwordx4 v14, s[16:19], s46 offen offset:1024 nt lds
    s_waitcnt vmcnt(8)
    ds_read_b128 v[136:139], v232 offset:0
    ds_read_b128 v[140:143], v233 offset:0
    ds_read_b128 v[144:147], v234 offset:0
    ds_read_b128 v[148:151], v235 offset:0
    s_barrier
    ds_read_b128 a[192:195], v1 offset:0
    ds_read_b128 a[196:199], v2 offset:0
    ds_read_b128 a[200:203], v3 offset:0
    ds_read_b128 a[204:207], v4 offset:0
    ds_read_b128 a[208:211], v5 offset:0
    ds_read_b128 a[212:215], v6 offset:0
    ds_read_b128 a[216:219], v7 offset:0
    ds_read_b128 a[220:223], v8 offset:0
    s_waitcnt lgkmcnt(11)
    v_lshlrev_b32 v36, 16, v136
    v_and_b32 v37, s35, v136
    v_mul_f32 v36, s34, v36
    v_mul_f32 v37, s34, v37
    v_cvt_pk_bf16_f32 v136, v36, v37
    v_lshlrev_b32 v38, 16, v137
    v_and_b32 v39, s35, v137
    v_mul_f32 v38, s34, v38
    v_mul_f32 v39, s34, v39
    s_add_u32 m0, s28, 65536
    s_nop 0
    buffer_load_dwordx4 v15, s[20:23], s44 offen offset:0 nt lds
    v_cvt_pk_bf16_f32 v137, v38, v39
    v_lshlrev_b32 v36, 16, v138
    v_and_b32 v37, s35, v138
    v_mul_f32 v36, s34, v36
    v_mul_f32 v37, s34, v37
    v_cvt_pk_bf16_f32 v138, v36, v37
    buffer_load_dwordx4 v15, s[20:23], s44 offen offset:1024 nt lds
    v_lshlrev_b32 v38, 16, v139
    v_and_b32 v39, s35, v139
    v_mul_f32 v38, s34, v38
    v_mul_f32 v39, s34, v39
    v_cvt_pk_bf16_f32 v139, v38, v39
    s_waitcnt lgkmcnt(10)
    v_lshlrev_b32 v36, 16, v140
    s_add_u32 m0, s28, 73728
    s_nop 0
    buffer_load_dwordx4 v15, s[20:23], s45 offen offset:0 nt lds
    v_and_b32 v37, s35, v140
    v_mul_f32 v36, s34, v36
    v_mul_f32 v37, s34, v37
    v_cvt_pk_bf16_f32 v140, v36, v37
    v_lshlrev_b32 v38, 16, v141
    v_and_b32 v39, s35, v141
    buffer_load_dwordx4 v15, s[20:23], s45 offen offset:1024 nt lds
    v_mul_f32 v38, s34, v38
    v_mul_f32 v39, s34, v39
    v_cvt_pk_bf16_f32 v141, v38, v39
    v_lshlrev_b32 v36, 16, v142
    v_and_b32 v37, s35, v142
    v_mul_f32 v36, s34, v36
    v_mul_f32 v37, s34, v37
    v_cvt_pk_bf16_f32 v142, v36, v37
    v_lshlrev_b32 v38, 16, v143
    v_and_b32 v39, s35, v143
    v_mul_f32 v38, s34, v38
    v_mul_f32 v39, s34, v39
    v_cvt_pk_bf16_f32 v143, v38, v39
    s_waitcnt lgkmcnt(9)
    v_lshlrev_b32 v36, 16, v144
    v_and_b32 v37, s35, v144
    v_mul_f32 v36, s34, v36
    v_mul_f32 v37, s34, v37
    v_cvt_pk_bf16_f32 v144, v36, v37
    v_lshlrev_b32 v38, 16, v145
    v_and_b32 v39, s35, v145
    v_mul_f32 v38, s34, v38
    v_mul_f32 v39, s34, v39
    v_cvt_pk_bf16_f32 v145, v38, v39
    v_lshlrev_b32 v36, 16, v146
    v_and_b32 v37, s35, v146
    v_mul_f32 v36, s34, v36
    v_mul_f32 v37, s34, v37
    v_cvt_pk_bf16_f32 v146, v36, v37
    v_lshlrev_b32 v38, 16, v147
    v_and_b32 v39, s35, v147
    v_mul_f32 v38, s34, v38
    v_mul_f32 v39, s34, v39
    v_cvt_pk_bf16_f32 v147, v38, v39
    s_waitcnt lgkmcnt(8)
    v_lshlrev_b32 v36, 16, v148
    v_and_b32 v37, s35, v148
    v_mul_f32 v36, s34, v36
    s_add_u32 m0, s42, 0
    s_nop 0
    buffer_load_dwordx4 v240, s[12:15], s38 offen offset:0 nt lds
    v_mul_f32 v37, s34, v37
    v_cvt_pk_bf16_f32 v148, v36, v37
    v_lshlrev_b32 v38, 16, v149
    v_and_b32 v39, s35, v149
    v_mul_f32 v38, s34, v38
    v_mul_f32 v39, s34, v39
    v_cvt_pk_bf16_f32 v149, v38, v39
    v_lshlrev_b32 v36, 16, v150
    v_and_b32 v37, s35, v150
    v_mul_f32 v36, s34, v36
    v_mul_f32 v37, s34, v37
    v_cvt_pk_bf16_f32 v150, v36, v37
    v_lshlrev_b32 v38, 16, v151
    v_and_b32 v39, s35, v151
    v_mul_f32 v38, s34, v38
    v_mul_f32 v39, s34, v39
    v_cvt_pk_bf16_f32 v151, v38, v39
    s_waitcnt lgkmcnt(7)
    v_mfma_f32_32x32x16_bf16 v[40:55], a[192:195], v[136:139], 0
    s_waitcnt lgkmcnt(6)
    buffer_load_dwordx4 v241, s[12:15], s38 offen offset:1024 nt lds
    buffer_load_dwordx4 v242, s[12:15], s38 offen offset:2048 nt lds
    s_waitcnt vmcnt(11)
    ds_read_b128 v[152:155], v232 offset:4096
    ds_read_b128 v[156:159], v233 offset:4096
    v_mfma_f32_32x32x16_bf16 v[40:55], a[196:199], v[140:143], v[40:55]
    s_waitcnt lgkmcnt(7)
    ds_read_b128 v[160:163], v234 offset:4096
    ds_read_b128 v[164:167], v235 offset:4096
    v_mfma_f32_32x32x16_bf16 v[40:55], a[200:203], v[144:147], v[40:55]
    s_waitcnt lgkmcnt(8)
    v_mfma_f32_32x32x16_bf16 v[40:55], a[204:207], v[148:151], v[40:55]
    s_waitcnt lgkmcnt(7)
    s_waitcnt lgkmcnt(3)
    v_lshlrev_b32 v36, 16, v152
    v_and_b32 v37, s35, v152
    v_mul_f32 v36, s34, v36
    v_mul_f32 v37, s34, v37
    v_cvt_pk_bf16_f32 v152, v36, v37
    v_lshlrev_b32 v38, 16, v153
    v_and_b32 v39, s35, v153
    v_mul_f32 v38, s34, v38
    v_mul_f32 v39, s34, v39
    v_cvt_pk_bf16_f32 v153, v38, v39
    v_lshlrev_b32 v36, 16, v154
    v_and_b32 v37, s35, v154
    v_mul_f32 v36, s34, v36
    v_mul_f32 v37, s34, v37
    v_cvt_pk_bf16_f32 v154, v36, v37
    v_lshlrev_b32 v38, 16, v155
    v_and_b32 v39, s35, v155
    v_mul_f32 v38, s34, v38
    v_mul_f32 v39, s34, v39
    v_cvt_pk_bf16_f32 v155, v38, v39
    s_nop 1
    v_mfma_f32_32x32x16_bf16 v[40:55], a[208:211], v[152:155], v[40:55]
    s_waitcnt vmcnt(9)
    s_barrier
    ds_read_b128 a[192:195], v1 offset:8192
    s_waitcnt lgkmcnt(3)
    v_lshlrev_b32 v36, 16, v156
    v_and_b32 v37, s35, v156
    v_mul_f32 v36, s34, v36
    v_mul_f32 v37, s34, v37
    v_cvt_pk_bf16_f32 v156, v36, v37
    v_lshlrev_b32 v38, 16, v157
    v_and_b32 v39, s35, v157
    v_mul_f32 v38, s34, v38
    v_mul_f32 v39, s34, v39
    v_cvt_pk_bf16_f32 v157, v38, v39
    v_lshlrev_b32 v36, 16, v158
    v_and_b32 v37, s35, v158
    v_mul_f32 v36, s34, v36
    v_mul_f32 v37, s34, v37
    v_cvt_pk_bf16_f32 v158, v36, v37
    v_lshlrev_b32 v38, 16, v159
    v_and_b32 v39, s35, v159
    v_mul_f32 v38, s34, v38
    v_mul_f32 v39, s34, v39
    v_cvt_pk_bf16_f32 v159, v38, v39
    s_nop 1
    v_mfma_f32_32x32x16_bf16 v[40:55], a[212:215], v[156:159], v[40:55]
    ds_read_b128 a[196:199], v2 offset:8192
    s_waitcnt lgkmcnt(3)
    v_lshlrev_b32 v36, 16, v160
    v_and_b32 v37, s35, v160
    v_mul_f32 v36, s34, v36
    v_mul_f32 v37, s34, v37
    v_cvt_pk_bf16_f32 v160, v36, v37
    v_lshlrev_b32 v38, 16, v161
    v_and_b32 v39, s35, v161
    v_mul_f32 v38, s34, v38
    v_mul_f32 v39, s34, v39
    v_cvt_pk_bf16_f32 v161, v38, v39
    v_lshlrev_b32 v36, 16, v162
    v_and_b32 v37, s35, v162
    v_mul_f32 v36, s34, v36
    v_mul_f32 v37, s34, v37
    v_cvt_pk_bf16_f32 v162, v36, v37
    v_lshlrev_b32 v38, 16, v163
    v_and_b32 v39, s35, v163
    v_mul_f32 v38, s34, v38
    v_mul_f32 v39, s34, v39
    v_cvt_pk_bf16_f32 v163, v38, v39
    s_nop 1
    v_mfma_f32_32x32x16_bf16 v[40:55], a[216:219], v[160:163], v[40:55]
    ds_read_b128 a[200:203], v3 offset:8192
    s_waitcnt lgkmcnt(3)
    v_lshlrev_b32 v36, 16, v164
    v_and_b32 v37, s35, v164
    v_mul_f32 v36, s34, v36
    v_mul_f32 v37, s34, v37
    v_cvt_pk_bf16_f32 v164, v36, v37
    v_lshlrev_b32 v38, 16, v165
    v_and_b32 v39, s35, v165
    v_mul_f32 v38, s34, v38
    v_mul_f32 v39, s34, v39
    v_cvt_pk_bf16_f32 v165, v38, v39
    v_lshlrev_b32 v36, 16, v166
    v_and_b32 v37, s35, v166
    v_mul_f32 v36, s34, v36
    v_mul_f32 v37, s34, v37
    v_cvt_pk_bf16_f32 v166, v36, v37
    v_lshlrev_b32 v38, 16, v167
    v_and_b32 v39, s35, v167
    v_mul_f32 v38, s34, v38
    v_mul_f32 v39, s34, v39
    v_cvt_pk_bf16_f32 v167, v38, v39
    s_nop 1
    v_mfma_f32_32x32x16_bf16 v[40:55], a[220:223], v[164:167], v[40:55]
    s_waitcnt lgkmcnt(2)
    ds_read_b128 a[204:207], v4 offset:8192
    ds_read_b128 a[208:211], v5 offset:8192
    ds_read_b128 a[212:215], v6 offset:8192
    s_nop 2
    v_mfma_f32_32x32x16_bf16 v[56:71], a[192:195], v[136:139], 0
    s_waitcnt lgkmcnt(4)
    ds_read_b128 a[216:219], v7 offset:8192
    ds_read_b128 a[220:223], v8 offset:8192
    s_nop 0
    v_max3_f32 v22, v40, v41, v42
    v_max3_f32 v23, v43, v44, v45
    v_max3_f32 v22, v22, v46, v47
    v_mfma_f32_32x32x16_bf16 v[56:71], a[196:199], v[140:143], v[56:71]
    s_waitcnt lgkmcnt(5)
    v_max3_f32 v23, v23, v48, v49
    v_max3_f32 v22, v22, v50, v51
    v_max3_f32 v23, v23, v52, v53
    v_max3_f32 v22, v22, v54, v55
    v_max_f32 v22, v22, v23
    v_mov_b32 v23, v22
    v_mfma_f32_32x32x16_bf16 v[56:71], a[200:203], v[144:147], v[56:71]
    s_waitcnt lgkmcnt(4)
    buffer_load_dwordx4 v243, s[12:15], s38 offen offset:3072 nt lds
    v_permlane32_swap_b32 v22, v23
    v_mfma_f32_32x32x16_bf16 v[56:71], a[204:207], v[148:151], v[56:71]
    s_waitcnt lgkmcnt(3)
    s_waitcnt vmcnt(8)
    s_barrier
    ds_read_b128 a[192:195], v1 offset:16384
    ds_read_b128 a[196:199], v2 offset:16384
    v_mfma_f32_32x32x16_bf16 v[56:71], a[208:211], v[152:155], v[56:71]
    s_waitcnt lgkmcnt(4)
    ds_read_b128 a[200:203], v3 offset:16384
    ds_read_b128 a[204:207], v4 offset:16384
    s_add_u32 m0, s28, 81920
    v_max_f32 v22, v22, v23
    v_sub_f32 v88, 0, v22
    v_mov_b32 v89, v88
    v_mfma_f32_32x32x16_bf16 v[56:71], a[212:215], v[156:159], v[56:71]
    s_waitcnt lgkmcnt(5)
    buffer_load_dwordx4 v15, s[20:23], s46 offen offset:0 nt lds
    buffer_load_dwordx4 v15, s[20:23], s46 offen offset:1024 nt lds
    s_waitcnt vmcnt(8)
    s_barrier
    v_mfma_f32_32x32x16_bf16 v[56:71], a[216:219], v[160:163], v[56:71]
    s_waitcnt lgkmcnt(4)
    ds_read_b64_tr_b16 a[224:225], v9 offset:0
    ds_read_b64_tr_b16 a[226:227], v9 offset:2048
    v_mov_b32 v90, v88
    v_mov_b32 v91, v88
    v_mov_b32 v92, v88
    v_mov_b32 v93, v88
    v_mfma_f32_32x32x16_bf16 v[56:71], a[220:223], v[164:167], v[56:71]
    s_waitcnt lgkmcnt(5)
    v_mov_b32 v94, v88
    v_mov_b32 v95, v88
    v_mov_b32 v96, v88
    v_mov_b32 v97, v88
    v_mov_b32 v98, v88
    v_mov_b32 v99, v88
    v_mov_b32 v100, v88
    v_mov_b32 v101, v88
    v_mov_b32 v102, v88
    v_mov_b32 v103, v88
    v_add_f32 v40, v88, v40
    v_exp_f32 v28, v40
    v_add_f32 v41, v88, v41
    v_exp_f32 v29, v41
    s_nop 0
    v_add_f32 v20, v28, v29
    v_cvt_pk_bf16_f32 v72, v28, v29
    v_add_f32 v42, v88, v42
    v_exp_f32 v30, v42
    v_add_f32 v43, v88, v43
    v_exp_f32 v31, v43
    v_add_f32 v20, v20, v30
    v_add_f32 v20, v20, v31
    v_cvt_pk_bf16_f32 v73, v30, v31
    v_add_f32 v44, v88, v44
    v_exp_f32 v32, v44
    v_add_f32 v45, v88, v45
    v_exp_f32 v33, v45
    v_add_f32 v20, v20, v32
    v_add_f32 v20, v20, v33
    v_cvt_pk_bf16_f32 v74, v32, v33
    v_add_f32 v46, v88, v46
    v_exp_f32 v34, v46
    v_add_f32 v47, v88, v47
    v_exp_f32 v35, v47
    v_add_f32 v20, v20, v34
    v_add_f32 v20, v20, v35
    v_cvt_pk_bf16_f32 v75, v34, v35
    v_add_f32 v48, v88, v48
    v_exp_f32 v28, v48
    v_add_f32 v49, v88, v49
    v_exp_f32 v29, v49
    v_add_f32 v50, v88, v50
    v_exp_f32 v30, v50
    v_add_f32 v51, v88, v51
    v_exp_f32 v31, v51
    v_add_f32 v52, v88, v52
    v_exp_f32 v32, v52
    v_add_f32 v53, v88, v53
    v_exp_f32 v33, v53
    v_add_f32 v54, v88, v54
    v_exp_f32 v34, v54
    v_add_f32 v55, v88, v55
    v_exp_f32 v35, v55
    v_mfma_f32_32x32x16_bf16 v[40:55], a[192:195], v[136:139], v[88:103]
    s_waitcnt lgkmcnt(4)
    ds_read_b64_tr_b16 a[228:229], v10 offset:0
    ds_read_b64_tr_b16 a[230:231], v10 offset:2048
    ds_read_b128 a[208:211], v5 offset:16384
    v_cvt_pk_bf16_f32 v76, v28, v29
    v_cvt_pk_bf16_f32 v77, v30, v31
    v_cvt_pk_bf16_f32 v78, v32, v33
    v_mfma_f32_32x32x16_bf16 v[40:55], a[196:199], v[140:143], v[40:55]
    s_waitcnt lgkmcnt(3)
    ds_read_b128 a[212:215], v6 offset:16384
    ds_read_b64_tr_b16 a[232:233], v11 offset:0
    v_cvt_pk_bf16_f32 v79, v34, v35
    v_add_f32 v20, v20, v28
    v_add_f32 v20, v20, v29
    v_add_f32 v20, v20, v30
    v_mfma_f32_32x32x16_bf16 a[0:15], a[224:227], v[72:75], 0
    ds_read_b64_tr_b16 a[234:235], v11 offset:2048
    ds_read_b128 a[216:219], v7 offset:16384
    v_add_f32 v20, v20, v31
    v_add_f32 v20, v20, v32
    v_add_f32 v20, v20, v33
    v_add_f32 v20, v20, v34
    v_mfma_f32_32x32x16_bf16 v[40:55], a[200:203], v[144:147], v[40:55]
    ds_read_b128 a[220:223], v8 offset:16384
    ds_read_b64_tr_b16 a[236:237], v12 offset:0
    s_add_u32 m0, s42, 4096
    v_add_f32 v20, v20, v35
    v_mov_b32 v17, v20
    v_add_f32 v56, v88, v56
    v_mfma_f32_32x32x16_bf16 v[40:55], a[204:207], v[148:151], v[40:55]
    s_waitcnt lgkmcnt(7)
    ds_read_b64_tr_b16 a[238:239], v12 offset:2048
    ds_read_b64_tr_b16 a[240:241], v9 offset:4096
    v_exp_f32 v28, v56
    v_add_f32 v57, v88, v57
    v_add_f32 v58, v88, v58
    v_mfma_f32_32x32x16_bf16 a[16:31], a[228:231], v[72:75], 0
    s_waitcnt lgkmcnt(8)
    ds_read_b64_tr_b16 a[242:243], v9 offset:6144
    ds_read_b64_tr_b16 a[244:245], v10 offset:4096
    v_exp_f32 v29, v57
    v_exp_f32 v30, v58
    v_mfma_f32_32x32x16_bf16 v[40:55], a[208:211], v[152:155], v[40:55]
    s_waitcnt lgkmcnt(9)
    ds_read_b64_tr_b16 a[246:247], v10 offset:6144
    ds_read_b64_tr_b16 a[248:249], v11 offset:4096
    v_add_f32 v21, v28, v29
    v_cvt_pk_bf16_f32 v80, v28, v29
    v_add_f32 v59, v88, v59
    v_add_f32 v21, v21, v30
    v_mfma_f32_32x32x16_bf16 v[40:55], a[212:215], v[156:159], v[40:55]
    s_waitcnt lgkmcnt(9)
    ds_read_b64_tr_b16 a[250:251], v11 offset:6144
    ds_read_b64_tr_b16 a[252:253], v12 offset:4096
    v_exp_f32 v31, v59
    v_add_f32 v60, v88, v60
    v_add_f32 v21, v21, v31
    v_mfma_f32_32x32x16_bf16 a[32:47], a[232:235], v[72:75], 0
    s_waitcnt lgkmcnt(10)
    ds_read_b64_tr_b16 a[254:255], v12 offset:6144
    buffer_load_dwordx4 v240, s[12:15], s39 offen offset:0 nt lds
    v_cvt_pk_bf16_f32 v81, v30, v31
    v_mfma_f32_32x32x16_bf16 v[40:55], a[216:219], v[160:163], v[40:55]
    s_waitcnt lgkmcnt(10)
    v_exp_f32 v32, v60
    v_add_f32 v61, v88, v61
    v_exp_f32 v33, v61
    v_add_f32 v21, v21, v32
    v_mfma_f32_32x32x16_bf16 v[40:55], a[220:223], v[164:167], v[40:55]
    s_waitcnt lgkmcnt(8)
    v_add_f32 v21, v21, v33
    v_cvt_pk_bf16_f32 v82, v32, v33
    v_add_f32 v62, v88, v62
    v_exp_f32 v34, v62
    v_add_f32 v63, v88, v63
    v_mfma_f32_32x32x16_bf16 a[48:63], a[236:239], v[72:75], 0
    s_waitcnt lgkmcnt(6)
    s_waitcnt vmcnt(7)
    s_barrier
    ds_read_b64_tr_b16 a[224:225], v9 offset:8192
    ds_read_b64_tr_b16 a[226:227], v9 offset:10240
    v_mfma_f32_32x32x16_bf16 a[0:15], a[240:243], v[76:79], a[0:15]
    s_waitcnt lgkmcnt(6)
    ds_read_b64_tr_b16 a[228:229], v10 offset:8192
    ds_read_b64_tr_b16 a[230:231], v10 offset:10240
    ds_read_b64_tr_b16 a[232:233], v11 offset:8192
    ds_read_b64_tr_b16 a[234:235], v11 offset:10240
    v_exp_f32 v35, v63
    v_mfma_f32_32x32x16_bf16 a[16:31], a[244:247], v[76:79], a[16:31]
    s_waitcnt lgkmcnt(8)
    ds_read_b64_tr_b16 a[236:237], v12 offset:8192
    ds_read_b64_tr_b16 a[238:239], v12 offset:10240
    v_add_f32 v21, v21, v34
    v_add_f32 v21, v21, v35
    v_cvt_pk_bf16_f32 v83, v34, v35
    v_add_f32 v64, v88, v64
    v_mfma_f32_32x32x16_bf16 a[32:47], a[248:251], v[76:79], a[32:47]
    s_waitcnt lgkmcnt(8)
    v_exp_f32 v28, v64
    v_add_f32 v65, v88, v65
    v_exp_f32 v29, v65
    v_add_f32 v21, v21, v28
    v_add_f32 v21, v21, v29
    v_cvt_pk_bf16_f32 v84, v28, v29
    v_add_f32 v66, v88, v66
    v_exp_f32 v30, v66
    v_add_f32 v67, v88, v67
    v_exp_f32 v31, v67
    v_add_f32 v21, v21, v30
    v_add_f32 v21, v21, v31
    v_cvt_pk_bf16_f32 v85, v30, v31
    v_add_f32 v68, v88, v68
    v_exp_f32 v32, v68
    v_add_f32 v69, v88, v69
    v_exp_f32 v33, v69
    v_add_f32 v21, v21, v32
    v_add_f32 v21, v21, v33
    v_cvt_pk_bf16_f32 v86, v32, v33
    v_add_f32 v70, v88, v70
    v_exp_f32 v34, v70
    v_add_f32 v71, v88, v71
    v_exp_f32 v35, v71
    v_add_f32 v21, v21, v34
    v_add_f32 v21, v21, v35
    v_cvt_pk_bf16_f32 v87, v34, v35
    v_cmp_lt_f32 vcc, s29, v21
    v_mfma_f32_32x32x16_bf16 a[48:63], a[252:255], v[76:79], a[48:63]
    s_waitcnt lgkmcnt(6)
    s_cbranch_vccnz L_tr1
L_bk1:
    ds_read_b64_tr_b16 a[240:241], v9 offset:12288
    ds_read_b64_tr_b16 a[242:243], v9 offset:14336
    ds_read_b64_tr_b16 a[244:245], v10 offset:12288
    ds_read_b64_tr_b16 a[246:247], v10 offset:14336
    v_add_f32 v17, v17, v21
    v_mfma_f32_32x32x16_bf16 a[0:15], a[224:227], v[80:83], a[0:15]
    s_waitcnt lgkmcnt(8)
    ds_read_b64_tr_b16 a[248:249], v11 offset:12288
    ds_read_b64_tr_b16 a[250:251], v11 offset:14336
    v_exp_f32 v28, v40
    v_exp_f32 v29, v41
    v_mfma_f32_32x32x16_bf16 a[16:31], a[228:231], v[80:83], a[16:31]
    s_waitcnt lgkmcnt(8)
    ds_read_b64_tr_b16 a[252:253], v12 offset:12288
    ds_read_b64_tr_b16 a[254:255], v12 offset:14336
    v_add_f32 v20, v28, v29
    v_cvt_pk_bf16_f32 v72, v28, v29
    v_exp_f32 v30, v42
    v_mfma_f32_32x32x16_bf16 a[32:47], a[232:235], v[80:83], a[32:47]
    s_waitcnt lgkmcnt(8)
    buffer_load_dwordx4 v241, s[12:15], s39 offen offset:1024 nt lds
    v_exp_f32 v31, v43
    v_mfma_f32_32x32x16_bf16 a[48:63], a[236:239], v[80:83], a[48:63]
    s_waitcnt lgkmcnt(6)
    buffer_load_dwordx4 v242, s[12:15], s39 offen offset:2048 nt lds
    buffer_load_dwordx4 v243, s[12:15], s39 offen offset:3072 nt lds
    s_add_u32 m0, s28, 24576
    s_nop 0
    buffer_load_dwordx4 v13, s[16:19], s47 offen offset:0 nt lds
    buffer_load_dwordx4 v14, s[16:19], s47 offen offset:1024 nt lds
    s_add_u32 m0, s28, 32768
    s_nop 0
    buffer_load_dwordx4 v13, s[16:19], s48 offen offset:0 nt lds
    buffer_load_dwordx4 v14, s[16:19], s48 offen offset:1024 nt lds
    s_waitcnt vmcnt(8)
    s_barrier
    v_mfma_f32_32x32x16_bf16 a[0:15], a[240:243], v[84:87], a[0:15]
    s_waitcnt lgkmcnt(4)
    ds_read_b64_tr_b16 a[224:225], v9 offset:16384
    ds_read_b64_tr_b16 a[226:227], v9 offset:18432
    ds_read_b64_tr_b16 a[228:229], v10 offset:16384
    ds_read_b64_tr_b16 a[230:231], v10 offset:18432
    ds_read_b64_tr_b16 a[232:233], v11 offset:16384
    ds_read_b64_tr_b16 a[234:235], v11 offset:18432
    v_mfma_f32_32x32x16_bf16 a[16:31], a[244:247], v[84:87], a[16:31]
    s_waitcnt lgkmcnt(8)
    ds_read_b64_tr_b16 a[236:237], v12 offset:16384
    ds_read_b64_tr_b16 a[238:239], v12 offset:18432
    s_add_u32 m0, s28, 90112
    v_add_f32 v20, v20, v30
    v_add_f32 v20, v20, v31
    v_cvt_pk_bf16_f32 v73, v30, v31
    v_mfma_f32_32x32x16_bf16 a[32:47], a[248:251], v[84:87], a[32:47]
    s_waitcnt lgkmcnt(8)
    v_exp_f32 v32, v44
    v_exp_f32 v33, v45
    v_add_f32 v20, v20, v32
    v_add_f32 v20, v20, v33
    v_cvt_pk_bf16_f32 v74, v32, v33
    v_exp_f32 v34, v46
    v_exp_f32 v35, v47
    v_add_f32 v20, v20, v34
    v_add_f32 v20, v20, v35
    v_cvt_pk_bf16_f32 v75, v34, v35
    v_exp_f32 v28, v48
    v_exp_f32 v29, v49
    v_add_f32 v20, v20, v28
    v_add_f32 v20, v20, v29
    v_cvt_pk_bf16_f32 v76, v28, v29
    v_exp_f32 v30, v50
    v_exp_f32 v31, v51
    v_add_f32 v20, v20, v30
    v_add_f32 v20, v20, v31
    v_cvt_pk_bf16_f32 v77, v30, v31
    v_exp_f32 v32, v52
    v_exp_f32 v33, v53
    v_add_f32 v20, v20, v32
    v_add_f32 v20, v20, v33
    v_cvt_pk_bf16_f32 v78, v32, v33
    v_exp_f32 v34, v54
    v_exp_f32 v35, v55
    v_add_f32 v20, v20, v34
    v_add_f32 v20, v20, v35
    v_cvt_pk_bf16_f32 v79, v34, v35
    v_cmp_lt_f32 vcc, s29, v20
    v_mfma_f32_32x32x16_bf16 a[48:63], a[252:255], v[84:87], a[48:63]
    s_waitcnt lgkmcnt(6)
    s_cbranch_vccnz L_tr2
L_bk2:
    ds_read_b64_tr_b16 a[240:241], v9 offset:20480
    ds_read_b64_tr_b16 a[242:243], v9 offset:22528
    ds_read_b64_tr_b16 a[244:245], v10 offset:20480
    ds_read_b64_tr_b16 a[246:247], v10 offset:22528
    v_add_f32 v17, v17, v20
    v_mfma_f32_32x32x16_bf16 a[0:15], a[224:227], v[72:75], a[0:15]
    s_waitcnt lgkmcnt(8)
    ds_read_b64_tr_b16 a[248:249], v11 offset:20480
    ds_read_b64_tr_b16 a[250:251], v11 offset:22528
    ds_read_b128 v[168:171], v232 offset:0
    ds_read_b128 v[172:175], v233 offset:0
L_stub0_0:
    s_cbranch_scc1 L_stub0_1
    ds_read_b128 v[176:179], v234 offset:0
    ds_read_b128 v[180:183], v235 offset:0
    v_mfma_f32_32x32x16_bf16 a[16:31], a[228:231], v[72:75], a[16:31]
    s_waitcnt lgkmcnt(12)
    ds_read_b64_tr_b16 a[252:253], v12 offset:20480
    ds_read_b64_tr_b16 a[254:255], v12 offset:22528
    v_mfma_f32_32x32x16_bf16 a[32:47], a[232:235], v[72:75], a[32:47]
    s_waitcnt lgkmcnt(12)
    buffer_load_dwordx4 v15, s[20:23], s47 offen offset:0 nt lds
    v_mfma_f32_32x32x16_bf16 a[48:63], a[236:239], v[72:75], a[48:63]
    s_waitcnt lgkmcnt(10)
    buffer_load_dwordx4 v15, s[20:23], s47 offen offset:1024 nt lds
    s_add_u32 m0, s28, 40960
    v_mfma_f32_32x32x16_bf16 a[0:15], a[240:243], v[76:79], a[0:15]
    s_waitcnt lgkmcnt(8)
    buffer_load_dwordx4 v13, s[16:19], s49 offen offset:0 nt lds
    s_waitcnt lgkmcnt(5)
    v_lshlrev_b32 v36, 16, v168
    v_mfma_f32_32x32x16_bf16 a[16:31], a[244:247], v[76:79], a[16:31]
    v_and_b32 v37, s35, v168
    v_mul_f32 v36, s34, v36
    v_mul_f32 v37, s34, v37
    v_cvt_pk_bf16_f32 v168, v36, v37
    v_lshlrev_b32 v38, 16, v169
    v_and_b32 v39, s35, v169
    v_mfma_f32_32x32x16_bf16 a[32:47], a[248:251], v[76:79], a[32:47]
    s_waitcnt lgkmcnt(0)
    v_mul_f32 v38, s34, v38
    v_mul_f32 v39, s34, v39
    v_cvt_pk_bf16_f32 v169, v38, v39
    v_lshlrev_b32 v36, 16, v170
    v_and_b32 v37, s35, v170
    v_mul_f32 v36, s34, v36
    v_mul_f32 v37, s34, v37
    v_cvt_pk_bf16_f32 v170, v36, v37
    v_lshlrev_b32 v38, 16, v171
    v_and_b32 v39, s35, v171
    v_mul_f32 v38, s34, v38
    v_mul_f32 v39, s34, v39
    v_cvt_pk_bf16_f32 v171, v38, v39
    v_lshlrev_b32 v36, 16, v172
    v_and_b32 v37, s35, v172
    v_mul_f32 v36, s34, v36
    v_mul_f32 v37, s34, v37
    v_cvt_pk_bf16_f32 v172, v36, v37
    v_lshlrev_b32 v38, 16, v173
    v_and_b32 v39, s35, v173
    v_mul_f32 v38, s34, v38
    v_mul_f32 v39, s34, v39
    v_cvt_pk_bf16_f32 v173, v38, v39
    v_lshlrev_b32 v36, 16, v174
    v_and_b32 v37, s35, v174
    v_mul_f32 v36, s34, v36
    v_mul_f32 v37, s34, v37
    v_cvt_pk_bf16_f32 v174, v36, v37
    v_lshlrev_b32 v38, 16, v175
    v_and_b32 v39, s35, v175
    v_mul_f32 v38, s34, v38
    v_mul_f32 v39, s34, v39
    v_cvt_pk_bf16_f32 v175, v38, v39
    v_lshlrev_b32 v36, 16, v176
    v_and_b32 v37, s35, v176
    v_mul_f32 v36, s34, v36
    v_mul_f32 v37, s34, v37
    v_cvt_pk_bf16_f32 v176, v36, v37
    v_lshlrev_b32 v38, 16, v177
    v_and_b32 v39, s35, v177
    v_mul_f32 v38, s34, v38
    v_mul_f32 v39, s34, v39
    v_cvt_pk_bf16_f32 v177, v38, v39
    v_lshlrev_b32 v36, 16, v178
    v_and_b32 v37, s35, v178
    v_mul_f32 v36, s34, v36
    v_mul_f32 v37, s34, v37
    v_cvt_pk_bf16_f32 v178, v36, v37
    v_lshlrev_b32 v38, 16, v179
    v_and_b32 v39, s35, v179
    v_mul_f32 v38, s34, v38
    v_mul_f32 v39, s34, v39
    v_cvt_pk_bf16_f32 v179, v38, v39
    v_lshlrev_b32 v36, 16, v180
    v_and_b32 v37, s35, v180
    v_mul_f32 v36, s34, v36
    v_mul_f32 v37, s34, v37
    v_cvt_pk_bf16_f32 v180, v36, v37
    v_lshlrev_b32 v38, 16, v181
    v_and_b32 v39, s35, v181
    v_mul_f32 v38, s34, v38
    v_mul_f32 v39, s34, v39
    v_cvt_pk_bf16_f32 v181, v38, v39
    v_lshlrev_b32 v36, 16, v182
    v_and_b32 v37, s35, v182
    v_mul_f32 v36, s34, v36
    v_mul_f32 v37, s34, v37
    v_cvt_pk_bf16_f32 v182, v36, v37
    v_lshlrev_b32 v38, 16, v183
    v_and_b32 v39, s35, v183
    v_mul_f32 v38, s34, v38
    v_mul_f32 v39, s34, v39
    v_cvt_pk_bf16_f32 v183, v38, v39
    v_mfma_f32_32x32x16_bf16 a[48:63], a[252:255], v[76:79], a[48:63]
    buffer_load_dwordx4 v14, s[16:19], s49 offen offset:1024 nt lds
    s_add_u32 m0, s28, 98304
    s_nop 0
    buffer_load_dwordx4 v15, s[20:23], s48 offen offset:0 nt lds
    buffer_load_dwordx4 v15, s[20:23], s48 offen offset:1024 nt lds
    s_add_u32 m0, s28, 49152
    s_nop 0
    buffer_load_dwordx4 v13, s[16:19], s50 offen offset:0 nt lds
    s_waitcnt vmcnt(11)
    ds_read_b128 v[184:187], v232 offset:4096
    v_mfma_f32_32x32x16_bf16 v[56:71], a[192:195], v[168:171], 0
    ds_read_b128 v[188:191], v233 offset:4096
    v_mfma_f32_32x32x16_bf16 v[56:71], a[196:199], v[172:175], v[56:71]
    ds_read_b128 v[192:195], v234 offset:4096
    v_mfma_f32_32x32x16_bf16 v[56:71], a[200:203], v[176:179], v[56:71]
    ds_read_b128 v[196:199], v235 offset:4096
    buffer_load_dwordx4 v14, s[16:19], s50 offen offset:1024 nt lds
    s_add_u32 m0, s42, 0
    v_mfma_f32_32x32x16_bf16 v[56:71], a[204:207], v[180:183], v[56:71]
    s_waitcnt lgkmcnt(3)
    v_lshlrev_b32 v36, 16, v184
    v_and_b32 v37, s35, v184
    v_mul_f32 v36, s34, v36
    v_mul_f32 v37, s34, v37
    v_cvt_pk_bf16_f32 v184, v36, v37
    v_lshlrev_b32 v38, 16, v185
    v_and_b32 v39, s35, v185
    v_mul_f32 v38, s34, v38
    v_mul_f32 v39, s34, v39
    v_cvt_pk_bf16_f32 v185, v38, v39
    v_lshlrev_b32 v36, 16, v186
    v_and_b32 v37, s35, v186
    v_mul_f32 v36, s34, v36
    v_mul_f32 v37, s34, v37
    v_cvt_pk_bf16_f32 v186, v36, v37
    v_lshlrev_b32 v38, 16, v187
    v_and_b32 v39, s35, v187
    v_mul_f32 v38, s34, v38
    v_mul_f32 v39, s34, v39
    v_cvt_pk_bf16_f32 v187, v38, v39
    s_nop 1
    v_mfma_f32_32x32x16_bf16 v[56:71], a[208:211], v[184:187], v[56:71]
    buffer_load_dwordx4 v240, s[12:15], s40 offen offset:0 nt lds
    s_waitcnt vmcnt(11)
    s_barrier
    ds_read_b128 a[192:195], v1 offset:24576
    s_waitcnt lgkmcnt(3)
    v_lshlrev_b32 v36, 16, v188
    v_and_b32 v37, s35, v188
    v_mul_f32 v36, s34, v36
    v_mul_f32 v37, s34, v37
    v_cvt_pk_bf16_f32 v188, v36, v37
    v_lshlrev_b32 v38, 16, v189
    v_and_b32 v39, s35, v189
    v_mul_f32 v38, s34, v38
    v_mul_f32 v39, s34, v39
    v_cvt_pk_bf16_f32 v189, v38, v39
    v_lshlrev_b32 v36, 16, v190
    v_and_b32 v37, s35, v190
    v_mul_f32 v36, s34, v36
    v_mul_f32 v37, s34, v37
    v_cvt_pk_bf16_f32 v190, v36, v37
    v_lshlrev_b32 v38, 16, v191
    v_and_b32 v39, s35, v191
    v_mul_f32 v38, s34, v38
    v_mul_f32 v39, s34, v39
    v_cvt_pk_bf16_f32 v191, v38, v39
    s_nop 1
    v_mfma_f32_32x32x16_bf16 v[56:71], a[212:215], v[188:191], v[56:71]
    ds_read_b128 a[196:199], v2 offset:24576
    s_waitcnt lgkmcnt(3)
    v_lshlrev_b32 v36, 16, v192
    v_and_b32 v37, s35, v192
    v_mul_f32 v36, s34, v36
    v_mul_f32 v37, s34, v37
    v_cvt_pk_bf16_f32 v192, v36, v37
    v_lshlrev_b32 v38, 16, v193
    v_and_b32 v39, s35, v193
    v_mul_f32 v38, s34, v38
    v_mul_f32 v39, s34, v39
    v_cvt_pk_bf16_f32 v193, v38, v39
    v_lshlrev_b32 v36, 16, v194
    v_and_b32 v37, s35, v194
    v_mul_f32 v36, s34, v36
    v_mul_f32 v37, s34, v37
    v_cvt_pk_bf16_f32 v194, v36, v37
    v_lshlrev_b32 v38, 16, v195
    v_and_b32 v39, s35, v195
    v_mul_f32 v38, s34, v38
    v_mul_f32 v39, s34, v39
    v_cvt_pk_bf16_f32 v195, v38, v39
    s_nop 1
    v_mfma_f32_32x32x16_bf16 v[56:71], a[216:219], v[192:195], v[56:71]
    ds_read_b128 a[200:203], v3 offset:24576
    s_waitcnt lgkmcnt(3)
    v_lshlrev_b32 v36, 16, v196
    v_and_b32 v37, s35, v196
    v_mul_f32 v36, s34, v36
    v_mul_f32 v37, s34, v37
    v_cvt_pk_bf16_f32 v196, v36, v37
    v_lshlrev_b32 v38, 16, v197
    v_and_b32 v39, s35, v197
    v_mul_f32 v38, s34, v38
    v_mul_f32 v39, s34, v39
    v_cvt_pk_bf16_f32 v197, v38, v39
    v_lshlrev_b32 v36, 16, v198
    v_and_b32 v37, s35, v198
    v_mul_f32 v36, s34, v36
    v_mul_f32 v37, s34, v37
    v_cvt_pk_bf16_f32 v198, v36, v37
    v_lshlrev_b32 v38, 16, v199
    v_and_b32 v39, s35, v199
    v_mul_f32 v38, s34, v38
    v_mul_f32 v39, s34, v39
    v_cvt_pk_bf16_f32 v199, v38, v39
    s_nop 1
    v_mfma_f32_32x32x16_bf16 v[56:71], a[220:223], v[196:199], v[56:71]
    s_waitcnt lgkmcnt(2)
    ds_read_b128 a[204:207], v4 offset:24576
    ds_read_b128 a[208:211], v5 offset:24576
    ds_read_b128 a[212:215], v6 offset:24576
    s_nop 2
    v_mfma_f32_32x32x16_bf16 v[40:55], a[192:195], v[136:139], v[88:103]
    s_waitcnt lgkmcnt(4)
    ds_read_b128 a[216:219], v7 offset:24576
    ds_read_b128 a[220:223], v8 offset:24576
    s_nop 0
    v_max3_f32 v22, v56, v57, v58
    v_max3_f32 v23, v59, v60, v61
    v_max3_f32 v22, v22, v62, v63
    v_mfma_f32_32x32x16_bf16 v[40:55], a[196:199], v[140:143], v[40:55]
    s_waitcnt lgkmcnt(5)
    buffer_load_dwordx4 v241, s[12:15], s40 offen offset:1024 nt lds
    v_max3_f32 v23, v23, v64, v65
    v_max3_f32 v22, v22, v66, v67
    v_mfma_f32_32x32x16_bf16 v[40:55], a[200:203], v[144:147], v[40:55]
    s_waitcnt lgkmcnt(4)
    buffer_load_dwordx4 v242, s[12:15], s40 offen offset:2048 nt lds
    v_max3_f32 v23, v23, v68, v69
    v_max3_f32 v22, v22, v70, v71
    v_mfma_f32_32x32x16_bf16 v[40:55], a[204:207], v[148:151], v[40:55]
    s_waitcnt lgkmcnt(3)
    v_max_f32 v22, v22, v23
    v_mov_b32 v23, v22
    s_nop 1
    v_permlane32_swap_b32 v22, v23
    v_mfma_f32_32x32x16_bf16 v[40:55], a[208:211], v[152:155], v[40:55]
    s_waitcnt lgkmcnt(2)
    v_max_f32 v22, v22, v23
    v_sub_f32 v104, 0, v22
    v_mov_b32 v105, v104
    v_mov_b32 v106, v104
    v_mov_b32 v107, v104
    v_mov_b32 v108, v104
    v_mfma_f32_32x32x16_bf16 v[40:55], a[212:215], v[156:159], v[40:55]
    s_waitcnt lgkmcnt(1)
    v_mov_b32 v109, v104
    v_mov_b32 v110, v104
    v_mov_b32 v111, v104
    v_mov_b32 v112, v104
    v_mov_b32 v113, v104
    v_mov_b32 v114, v104
    v_mfma_f32_32x32x16_bf16 v[40:55], a[216:219], v[160:163], v[40:55]
    s_waitcnt lgkmcnt(0)
    v_mov_b32 v115, v104
    v_mov_b32 v116, v104
    v_mov_b32 v117, v104
    v_mov_b32 v118, v104
    v_mov_b32 v119, v104
    v_add_f32 v56, v104, v56
    v_mfma_f32_32x32x16_bf16 v[40:55], a[220:223], v[164:167], v[40:55]
    v_exp_f32 v28, v56
    v_add_f32 v57, v104, v57
    v_exp_f32 v29, v57
    s_nop 0
    v_add_f32 v21, v28, v29
    v_cvt_pk_bf16_f32 v80, v28, v29
    v_add_f32 v58, v104, v58
    v_exp_f32 v30, v58
    v_add_f32 v59, v104, v59
    v_exp_f32 v31, v59
    v_add_f32 v21, v21, v30
    v_add_f32 v21, v21, v31
    v_cvt_pk_bf16_f32 v81, v30, v31
    v_add_f32 v60, v104, v60
    v_exp_f32 v32, v60
    v_add_f32 v61, v104, v61
    v_exp_f32 v33, v61
    v_add_f32 v21, v21, v32
    v_add_f32 v21, v21, v33
    v_cvt_pk_bf16_f32 v82, v32, v33
    v_add_f32 v62, v104, v62
    v_exp_f32 v34, v62
    v_add_f32 v63, v104, v63
    v_exp_f32 v35, v63
    v_add_f32 v21, v21, v34
    v_add_f32 v21, v21, v35
    v_cvt_pk_bf16_f32 v83, v34, v35
    v_add_f32 v64, v104, v64
    v_exp_f32 v28, v64
    v_add_f32 v65, v104, v65
    v_exp_f32 v29, v65
    v_add_f32 v66, v104, v66
    v_exp_f32 v30, v66
    v_add_f32 v67, v104, v67
    v_exp_f32 v31, v67
    v_add_f32 v68, v104, v68
    v_exp_f32 v32, v68
    v_add_f32 v69, v104, v69
    v_exp_f32 v33, v69
    v_add_f32 v70, v104, v70
    v_exp_f32 v34, v70
    v_add_f32 v71, v104, v71
    v_exp_f32 v35, v71
    v_mfma_f32_32x32x16_bf16 v[56:71], a[192:195], v[168:171], v[104:119]
    v_cvt_pk_bf16_f32 v84, v28, v29
    v_cvt_pk_bf16_f32 v85, v30, v31
    v_cvt_pk_bf16_f32 v86, v32, v33
    v_cvt_pk_bf16_f32 v87, v34, v35
    v_add_f32 v21, v21, v28
    v_add_f32 v21, v21, v29
    v_mfma_f32_32x32x16_bf16 v[56:71], a[196:199], v[172:175], v[56:71]
    v_add_f32 v21, v21, v30
    v_add_f32 v21, v21, v31
    v_add_f32 v21, v21, v32
    v_add_f32 v21, v21, v33
    v_add_f32 v21, v21, v34
    v_add_f32 v21, v21, v35
    v_mfma_f32_32x32x16_bf16 a[64:79], a[224:227], v[80:83], 0
    s_waitcnt vmcnt(11)
    s_barrier
    v_exp_f32 v28, v40
    v_mfma_f32_32x32x16_bf16 v[56:71], a[200:203], v[176:179], v[56:71]
    ds_read_b128 a[192:195], v1 offset:32768
    ds_read_b128 a[196:199], v2 offset:32768
    v_exp_f32 v29, v41
    v_exp_f32 v30, v42
    v_mfma_f32_32x32x16_bf16 v[56:71], a[204:207], v[180:183], v[56:71]
    v_add_f32 v20, v28, v29
    v_cvt_pk_bf16_f32 v72, v28, v29
    v_exp_f32 v31, v43
    v_add_f32 v20, v20, v30
    v_add_f32 v20, v20, v31
    v_mfma_f32_32x32x16_bf16 a[80:95], a[228:231], v[80:83], 0
    ds_read_b128 a[200:203], v3 offset:32768
    v_cvt_pk_bf16_f32 v73, v30, v31
    v_exp_f32 v32, v44
    v_exp_f32 v33, v45
    v_mfma_f32_32x32x16_bf16 v[56:71], a[208:211], v[184:187], v[56:71]
    ds_read_b128 a[204:207], v4 offset:32768
    v_add_f32 v20, v20, v32
    v_add_f32 v20, v20, v33
    v_cvt_pk_bf16_f32 v74, v32, v33
    v_exp_f32 v34, v46
    v_mfma_f32_32x32x16_bf16 v[56:71], a[212:215], v[188:191], v[56:71]
    buffer_load_dwordx4 v243, s[12:15], s40 offen offset:3072 nt lds
    v_exp_f32 v35, v47
    v_mfma_f32_32x32x16_bf16 a[96:111], a[232:235], v[80:83], 0
    s_waitcnt vmcnt(10)
    s_barrier
    v_add_f32 v20, v20, v34
    v_add_f32 v20, v20, v35
    v_mfma_f32_32x32x16_bf16 v[56:71], a[216:219], v[192:195], v[56:71]
    ds_read_b64_tr_b16 a[224:225], v9 offset:24576
    ds_read_b64_tr_b16 a[226:227], v9 offset:26624
    s_add_u32 m0, s28, 106496
    v_cvt_pk_bf16_f32 v75, v34, v35
    v_exp_f32 v28, v48
    v_mfma_f32_32x32x16_bf16 v[56:71], a[220:223], v[196:199], v[56:71]
    ds_read_b64_tr_b16 a[228:229], v10 offset:24576
    ds_read_b64_tr_b16 a[230:231], v10 offset:26624
    v_exp_f32 v29, v49
    v_add_f32 v20, v20, v28
    v_add_f32 v20, v20, v29
    v_mfma_f32_32x32x16_bf16 a[112:127], a[236:239], v[80:83], 0
    ds_read_b128 a[208:211], v5 offset:32768
    ds_read_b128 a[212:215], v6 offset:32768
    v_cvt_pk_bf16_f32 v76, v28, v29
    v_exp_f32 v30, v50
    v_mov_b32 v18, v21
    v_mfma_f32_32x32x16_bf16 a[64:79], a[240:243], v[84:87], a[64:79]
    ds_read_b64_tr_b16 a[232:233], v11 offset:24576
    ds_read_b64_tr_b16 a[234:235], v11 offset:26624
    v_exp_f32 v31, v51
    v_add_f32 v20, v20, v30
    v_add_f32 v20, v20, v31
    v_mfma_f32_32x32x16_bf16 a[80:95], a[244:247], v[84:87], a[80:95]
    ds_read_b128 a[216:219], v7 offset:32768
    ds_read_b128 a[220:223], v8 offset:32768
    v_cvt_pk_bf16_f32 v77, v30, v31
    v_exp_f32 v32, v52
    v_mfma_f32_32x32x16_bf16 a[96:111], a[248:251], v[84:87], a[96:111]
    v_exp_f32 v33, v53
    v_add_f32 v20, v20, v32
    v_add_f32 v20, v20, v33
    v_cvt_pk_bf16_f32 v78, v32, v33
    v_exp_f32 v34, v54
    v_exp_f32 v35, v55
    v_add_f32 v20, v20, v34
    v_add_f32 v20, v20, v35
    v_cvt_pk_bf16_f32 v79, v34, v35
    v_cmp_lt_f32 vcc, s29, v20
    v_mfma_f32_32x32x16_bf16 a[112:127], a[252:255], v[84:87], a[112:127]
    s_waitcnt lgkmcnt(13)
    s_cbranch_vccnz L_tr4
L_bk4:
    ds_read_b64_tr_b16 a[236:237], v12 offset:24576
    v_exp_f32 v28, v56
    v_exp_f32 v29, v57
    v_mfma_f32_32x32x16_bf16 v[40:55], a[192:195], v[136:139], v[88:103]
    s_waitcnt lgkmcnt(13)
    ds_read_b64_tr_b16 a[238:239], v12 offset:26624
    ds_read_b64_tr_b16 a[240:241], v9 offset:28672
    v_add_f32 v21, v28, v29
    v_cvt_pk_bf16_f32 v80, v28, v29
    v_exp_f32 v30, v58
    v_mfma_f32_32x32x16_bf16 v[40:55], a[196:199], v[140:143], v[40:55]
    s_waitcnt lgkmcnt(11)
    ds_read_b64_tr_b16 a[242:243], v9 offset:30720
    ds_read_b64_tr_b16 a[244:245], v10 offset:28672
    v_exp_f32 v31, v59
    v_add_f32 v21, v21, v30
    v_add_f32 v21, v21, v31
    v_mfma_f32_32x32x16_bf16 a[0:15], a[224:227], v[72:75], a[0:15]
    ds_read_b64_tr_b16 a[246:247], v10 offset:30720
    ds_read_b64_tr_b16 a[248:249], v11 offset:28672
    v_cvt_pk_bf16_f32 v81, v30, v31
    v_exp_f32 v32, v60
    v_add_f32 v17, v17, v20
    v_mfma_f32_32x32x16_bf16 v[40:55], a[200:203], v[144:147], v[40:55]
    ds_read_b64_tr_b16 a[250:251], v11 offset:30720
    ds_read_b64_tr_b16 a[252:253], v12 offset:28672
    v_exp_f32 v33, v61
    v_add_f32 v21, v21, v32
    v_add_f32 v21, v21, v33
    v_mfma_f32_32x32x16_bf16 v[40:55], a[204:207], v[148:151], v[40:55]
    s_waitcnt lgkmcnt(15)
    ds_read_b64_tr_b16 a[254:255], v12 offset:30720
    buffer_load_dwordx4 v15, s[20:23], s49 offen offset:0 nt lds
    v_cvt_pk_bf16_f32 v82, v32, v33
    v_mfma_f32_32x32x16_bf16 a[16:31], a[228:231], v[72:75], a[16:31]
    s_waitcnt lgkmcnt(15)
    buffer_load_dwordx4 v15, s[20:23], s49 offen offset:1024 nt lds
    s_add_u32 m0, s42, 4096
    v_mfma_f32_32x32x16_bf16 v[40:55], a[208:211], v[152:155], v[40:55]
    s_waitcnt lgkmcnt(14)
    buffer_load_dwordx4 v240, s[12:15], s41 offen offset:0 nt lds
    v_exp_f32 v34, v62
    v_mfma_f32_32x32x16_bf16 v[40:55], a[212:215], v[156:159], v[40:55]
    s_waitcnt lgkmcnt(12)
    v_exp_f32 v35, v63
    v_add_f32 v21, v21, v34
    v_add_f32 v21, v21, v35
    v_cvt_pk_bf16_f32 v83, v34, v35
    v_mfma_f32_32x32x16_bf16 a[32:47], a[232:235], v[72:75], a[32:47]
    s_waitcnt lgkmcnt(11)
    v_exp_f32 v28, v64
    v_exp_f32 v29, v65
    v_add_f32 v21, v21, v28
    v_add_f32 v21, v21, v29
    v_mfma_f32_32x32x16_bf16 v[40:55], a[216:219], v[160:163], v[40:55]
    s_waitcnt lgkmcnt(10)
    v_cvt_pk_bf16_f32 v84, v28, v29
    v_exp_f32 v30, v66
    v_exp_f32 v31, v67
    v_add_f32 v21, v21, v30
    v_mfma_f32_32x32x16_bf16 v[40:55], a[220:223], v[164:167], v[40:55]
    s_waitcnt lgkmcnt(8)
    v_add_f32 v21, v21, v31
    v_cvt_pk_bf16_f32 v85, v30, v31
    v_exp_f32 v32, v68
    v_exp_f32 v33, v69
    v_mfma_f32_32x32x16_bf16 a[48:63], a[236:239], v[72:75], a[48:63]
    s_waitcnt lgkmcnt(6)
    v_add_f32 v21, v21, v32
    v_add_f32 v21, v21, v33
    v_cvt_pk_bf16_f32 v86, v32, v33
    v_exp_f32 v34, v70
    v_mfma_f32_32x32x16_bf16 a[0:15], a[240:243], v[76:79], a[0:15]
    s_waitcnt lgkmcnt(4)
    v_exp_f32 v35, v71
    v_add_f32 v21, v21, v34
    v_add_f32 v21, v21, v35
    v_cvt_pk_bf16_f32 v87, v34, v35
    v_cmp_lt_f32 vcc, s29, v21
    v_mfma_f32_32x32x16_bf16 a[16:31], a[244:247], v[76:79], a[16:31]
    s_waitcnt lgkmcnt(2)
    s_cbranch_vccnz L_tr5
L_bk5:
    v_exp_f32 v28, v40
    v_exp_f32 v29, v41
    v_add_f32 v18, v18, v21
    v_mfma_f32_32x32x16_bf16 a[32:47], a[248:251], v[76:79], a[32:47]
    s_waitcnt lgkmcnt(0)
    v_add_f32 v20, v28, v29
    v_cvt_pk_bf16_f32 v72, v28, v29
    v_exp_f32 v30, v42
    v_exp_f32 v31, v43
    v_mfma_f32_32x32x16_bf16 a[48:63], a[252:255], v[76:79], a[48:63]
    s_waitcnt vmcnt(9)
    s_barrier
    v_add_f32 v20, v20, v30
    v_add_f32 v20, v20, v31
    v_mfma_f32_32x32x16_bf16 v[56:71], a[192:195], v[168:171], v[104:119]
    v_cvt_pk_bf16_f32 v73, v30, v31
    v_exp_f32 v32, v44
    v_exp_f32 v33, v45
    v_add_f32 v20, v20, v32
    v_mfma_f32_32x32x16_bf16 v[56:71], a[196:199], v[172:175], v[56:71]
    buffer_load_dwordx4 v241, s[12:15], s41 offen offset:1024 nt lds
    v_add_f32 v20, v20, v33
    v_cvt_pk_bf16_f32 v74, v32, v33
    v_mfma_f32_32x32x16_bf16 a[64:79], a[224:227], v[80:83], a[64:79]
    ds_read_b128 a[192:195], v1 offset:40960
    v_exp_f32 v34, v46
    v_exp_f32 v35, v47
    v_add_f32 v20, v20, v34
    v_mfma_f32_32x32x16_bf16 v[56:71], a[200:203], v[176:179], v[56:71]
    ds_read_b128 a[196:199], v2 offset:40960
    v_add_f32 v20, v20, v35
    v_cvt_pk_bf16_f32 v75, v34, v35
    v_exp_f32 v28, v48
    v_mfma_f32_32x32x16_bf16 v[56:71], a[204:207], v[180:183], v[56:71]
    ds_read_b64_tr_b16 a[224:225], v9 offset:32768
    ds_read_b64_tr_b16 a[226:227], v9 offset:34816
    v_exp_f32 v29, v49
    v_add_f32 v20, v20, v28
    v_add_f32 v20, v20, v29
    v_mfma_f32_32x32x16_bf16 a[80:95], a[228:231], v[80:83], a[80:95]
    ds_read_b128 a[200:203], v3 offset:40960
    v_cvt_pk_bf16_f32 v76, v28, v29
    v_exp_f32 v30, v50
    v_exp_f32 v31, v51
    v_mfma_f32_32x32x16_bf16 v[56:71], a[208:211], v[184:187], v[56:71]
    ds_read_b128 a[204:207], v4 offset:40960
    v_add_f32 v20, v20, v30
    v_add_f32 v20, v20, v31
    v_cvt_pk_bf16_f32 v77, v30, v31
    v_exp_f32 v32, v52
    v_mfma_f32_32x32x16_bf16 v[56:71], a[212:215], v[188:191], v[56:71]
    ds_read_b64_tr_b16 a[228:229], v10 offset:32768
    ds_read_b64_tr_b16 a[230:231], v10 offset:34816
    v_exp_f32 v33, v53
    v_add_f32 v20, v20, v32
    v_add_f32 v20, v20, v33
    v_mfma_f32_32x32x16_bf16 a[96:111], a[232:235], v[80:83], a[96:111]
    ds_read_b128 a[208:211], v5 offset:40960
    v_cvt_pk_bf16_f32 v78, v32, v33
    v_exp_f32 v34, v54
    v_exp_f32 v35, v55
    v_mfma_f32_32x32x16_bf16 v[56:71], a[216:219], v[192:195], v[56:71]
    ds_read_b128 a[212:215], v6 offset:40960
    v_add_f32 v20, v20, v34
    v_add_f32 v20, v20, v35
    v_cvt_pk_bf16_f32 v79, v34, v35
    v_cmp_lt_f32 vcc, s29, v20
    v_mfma_f32_32x32x16_bf16 v[56:71], a[220:223], v[196:199], v[56:71]
    s_cbranch_vccnz L_tr6
L_bk6:
    ds_read_b64_tr_b16 a[232:233], v11 offset:32768
    ds_read_b64_tr_b16 a[234:235], v11 offset:34816
    v_add_f32 v17, v17, v20
    s_nop 2
    v_mfma_f32_32x32x16_bf16 a[112:127], a[236:239], v[80:83], a[112:127]
    ds_read_b128 a[216:219], v7 offset:40960
    s_nop 2
    v_exp_f32 v28, v56
    v_mfma_f32_32x32x16_bf16 a[64:79], a[240:243], v[84:87], a[64:79]
    ds_read_b128 a[220:223], v8 offset:40960
    v_exp_f32 v29, v57
    v_exp_f32 v30, v58
    v_add_f32 v21, v28, v29
    v_mfma_f32_32x32x16_bf16 a[80:95], a[244:247], v[84:87], a[80:95]
    ds_read_b64_tr_b16 a[236:237], v12 offset:32768
    ds_read_b64_tr_b16 a[238:239], v12 offset:34816
    v_cvt_pk_bf16_f32 v80, v28, v29
    v_exp_f32 v31, v59
    v_add_f32 v21, v21, v30
    v_mfma_f32_32x32x16_bf16 a[96:111], a[248:251], v[84:87], a[96:111]
    ds_read_b64_tr_b16 a[240:241], v9 offset:36864
    ds_read_b64_tr_b16 a[242:243], v9 offset:38912
    v_add_f32 v21, v21, v31
    v_cvt_pk_bf16_f32 v81, v30, v31
    v_exp_f32 v32, v60
    v_mfma_f32_32x32x16_bf16 a[112:127], a[252:255], v[84:87], a[112:127]
    s_waitcnt lgkmcnt(15)
    ds_read_b64_tr_b16 a[244:245], v10 offset:36864
    ds_read_b64_tr_b16 a[246:247], v10 offset:38912
    v_exp_f32 v33, v61
    v_add_f32 v21, v21, v32
    v_add_f32 v21, v21, v33
    v_mfma_f32_32x32x16_bf16 v[40:55], a[192:195], v[136:139], v[88:103]
    ds_read_b64_tr_b16 a[248:249], v11 offset:36864
    ds_read_b64_tr_b16 a[250:251], v11 offset:38912
    v_cvt_pk_bf16_f32 v82, v32, v33
    v_exp_f32 v34, v62
    v_mfma_f32_32x32x16_bf16 v[40:55], a[196:199], v[140:143], v[40:55]
    s_waitcnt lgkmcnt(15)
    ds_read_b64_tr_b16 a[252:253], v12 offset:36864
    ds_read_b64_tr_b16 a[254:255], v12 offset:38912
    v_exp_f32 v35, v63
    v_add_f32 v21, v21, v34
    v_add_f32 v21, v21, v35
    v_mfma_f32_32x32x16_bf16 a[0:15], a[224:227], v[72:75], a[0:15]
    buffer_load_dwordx4 v242, s[12:15], s41 offen offset:2048 nt lds
    v_cvt_pk_bf16_f32 v83, v34, v35
    v_mfma_f32_32x32x16_bf16 v[40:55], a[200:203], v[144:147], v[40:55]
    v_exp_f32 v28, v64
    v_exp_f32 v29, v65
    v_add_f32 v21, v21, v28
    v_add_f32 v21, v21, v29
    v_mfma_f32_32x32x16_bf16 v[40:55], a[204:207], v[148:151], v[40:55]
    s_waitcnt lgkmcnt(15)
    v_cvt_pk_bf16_f32 v84, v28, v29
    v_exp_f32 v30, v66
    v_exp_f32 v31, v67
    v_add_f32 v21, v21, v30
    v_mfma_f32_32x32x16_bf16 a[16:31], a[228:231], v[72:75], a[16:31]
    v_add_f32 v21, v21, v31
    v_cvt_pk_bf16_f32 v85, v30, v31
    v_exp_f32 v32, v68
    v_exp_f32 v33, v69
    v_mfma_f32_32x32x16_bf16 v[40:55], a[208:211], v[152:155], v[40:55]
    s_waitcnt lgkmcnt(14)
    v_add_f32 v21, v21, v32
    v_add_f32 v21, v21, v33
    v_cvt_pk_bf16_f32 v86, v32, v33
    v_exp_f32 v34, v70
    v_mfma_f32_32x32x16_bf16 v[40:55], a[212:215], v[156:159], v[40:55]
    s_waitcnt lgkmcnt(12)
    v_exp_f32 v35, v71
    v_add_f32 v21, v21, v34
    v_add_f32 v21, v21, v35
    v_cvt_pk_bf16_f32 v87, v34, v35
    v_cmp_lt_f32 vcc, s29, v21
    v_mfma_f32_32x32x16_bf16 a[32:47], a[232:235], v[72:75], a[32:47]
    s_waitcnt lgkmcnt(11)
    s_cbranch_vccnz L_tr7
L_bk7:
    v_add_f32 v18, v18, v21
    v_mfma_f32_32x32x16_bf16 v[40:55], a[216:219], v[160:163], v[40:55]
    s_waitcnt lgkmcnt(10)
    v_mfma_f32_32x32x16_bf16 v[40:55], a[220:223], v[164:167], v[40:55]
    s_waitcnt lgkmcnt(8)
    buffer_load_dwordx4 v243, s[12:15], s41 offen offset:3072 nt lds
    s_add_u32 m0, s28, 57344
    s_nop 0
    v_mfma_f32_32x32x16_bf16 a[48:63], a[236:239], v[72:75], a[48:63]
    s_waitcnt lgkmcnt(6)
    buffer_load_dwordx4 v13, s[16:19], s51 offen offset:0 nt lds
    s_nop 1
    v_mfma_f32_32x32x16_bf16 a[0:15], a[240:243], v[76:79], a[0:15]
    s_waitcnt lgkmcnt(4)
    s_nop 0
    v_exp_f32 v28, v40
    v_exp_f32 v29, v41
    v_mfma_f32_32x32x16_bf16 a[16:31], a[244:247], v[76:79], a[16:31]
    s_waitcnt lgkmcnt(2)
    v_add_f32 v20, v28, v29
    v_cvt_pk_bf16_f32 v72, v28, v29
    v_exp_f32 v30, v42
    v_exp_f32 v31, v43
    v_mfma_f32_32x32x16_bf16 a[32:47], a[248:251], v[76:79], a[32:47]
    s_waitcnt lgkmcnt(0)
    v_add_f32 v20, v20, v30
    v_add_f32 v20, v20, v31
    v_cvt_pk_bf16_f32 v73, v30, v31
    v_exp_f32 v32, v44
    v_mfma_f32_32x32x16_bf16 a[48:63], a[252:255], v[76:79], a[48:63]
    s_waitcnt vmcnt(11)
    s_barrier
    v_exp_f32 v33, v45
    v_mfma_f32_32x32x16_bf16 v[56:71], a[192:195], v[168:171], v[104:119]
    v_add_f32 v20, v20, v32
    v_add_f32 v20, v20, v33
    v_cvt_pk_bf16_f32 v74, v32, v33
    v_exp_f32 v34, v46
    v_mfma_f32_32x32x16_bf16 v[56:71], a[196:199], v[172:175], v[56:71]
    v_exp_f32 v35, v47
    v_add_f32 v20, v20, v34
    v_add_f32 v20, v20, v35
    v_cvt_pk_bf16_f32 v75, v34, v35
    v_mfma_f32_32x32x16_bf16 a[64:79], a[224:227], v[80:83], a[64:79]
    ds_read_b128 a[192:195], v1 offset:49152
    v_exp_f32 v28, v48
    v_exp_f32 v29, v49
    v_add_f32 v20, v20, v28
    v_mfma_f32_32x32x16_bf16 v[56:71], a[200:203], v[176:179], v[56:71]
    ds_read_b128 a[196:199], v2 offset:49152
    v_add_f32 v20, v20, v29
    v_cvt_pk_bf16_f32 v76, v28, v29
    v_exp_f32 v30, v50
    v_mfma_f32_32x32x16_bf16 v[56:71], a[204:207], v[180:183], v[56:71]
    v_exp_f32 v31, v51
    v_add_f32 v20, v20, v30
    v_add_f32 v20, v20, v31
    v_cvt_pk_bf16_f32 v77, v30, v31
    v_mfma_f32_32x32x16_bf16 a[80:95], a[228:231], v[80:83], a[80:95]
    ds_read_b128 a[200:203], v3 offset:49152
    v_exp_f32 v32, v52
    v_exp_f32 v33, v53
    v_add_f32 v20, v20, v32
    v_mfma_f32_32x32x16_bf16 v[56:71], a[208:211], v[184:187], v[56:71]
    ds_read_b128 a[204:207], v4 offset:49152
    v_add_f32 v20, v20, v33
    v_cvt_pk_bf16_f32 v78, v32, v33
    v_exp_f32 v34, v54
    v_mfma_f32_32x32x16_bf16 v[56:71], a[212:215], v[188:191], v[56:71]
    buffer_load_dwordx4 v14, s[16:19], s51 offen offset:1024 nt lds
    v_exp_f32 v35, v55
    v_mfma_f32_32x32x16_bf16 a[96:111], a[232:235], v[80:83], a[96:111]
    ds_read_b128 a[208:211], v5 offset:49152
    v_add_f32 v20, v20, v34
    v_add_f32 v20, v20, v35
    v_cvt_pk_bf16_f32 v79, v34, v35
    v_cmp_lt_f32 vcc, s29, v20
    v_mfma_f32_32x32x16_bf16 v[56:71], a[216:219], v[192:195], v[56:71]
    s_cbranch_vccnz L_tr8
L_bk8:
    ds_read_b128 a[212:215], v6 offset:49152
    v_add_f32 v17, v17, v20
    v_mfma_f32_32x32x16_bf16 v[56:71], a[220:223], v[196:199], v[56:71]
    s_add_u32 m0, s28, 114688
    s_nop 5
    v_mfma_f32_32x32x16_bf16 a[112:127], a[236:239], v[80:83], a[112:127]
    ds_read_b128 a[216:219], v7 offset:49152
    buffer_load_dwordx4 v15, s[20:23], s50 offen offset:0 nt lds
    s_nop 0
    v_mfma_f32_32x32x16_bf16 a[64:79], a[240:243], v[84:87], a[64:79]
    ds_read_b128 a[220:223], v8 offset:49152
    s_waitcnt vmcnt(9)
    ds_read_b128 v[200:203], v232 offset:0
    v_exp_f32 v28, v56
    v_mfma_f32_32x32x16_bf16 a[80:95], a[244:247], v[84:87], a[80:95]
    buffer_load_dwordx4 v15, s[20:23], s50 offen offset:1024 nt lds
    s_waitcnt vmcnt(8)
    s_barrier
L_stub0_1:
    s_cbranch_scc1 L_walk_done
    v_mfma_f32_32x32x16_bf16 a[96:111], a[248:251], v[84:87], a[96:111]
    ds_read_b64_tr_b16 a[224:225], v9 offset:40960
    ds_read_b64_tr_b16 a[226:227], v9 offset:43008
    s_add_u32 m0, s28, 40960
    v_exp_f32 v29, v57
    v_mfma_f32_32x32x16_bf16 a[112:127], a[252:255], v[84:87], a[112:127]
    s_waitcnt lgkmcnt(10)
    ds_read_b64_tr_b16 a[228:229], v10 offset:40960
    ds_read_b64_tr_b16 a[230:231], v10 offset:43008
    v_add_f32 v21, v28, v29
    v_cvt_pk_bf16_f32 v80, v28, v29
    v_exp_f32 v30, v58
    v_mfma_f32_32x32x16_bf16 v[40:55], a[192:195], v[136:139], v[88:103]
    s_waitcnt lgkmcnt(11)
    ds_read_b64_tr_b16 a[232:233], v11 offset:40960
    ds_read_b64_tr_b16 a[234:235], v11 offset:43008
    v_exp_f32 v31, v59
    v_add_f32 v21, v21, v30
    v_add_f32 v21, v21, v31
    v_mfma_f32_32x32x16_bf16 v[40:55], a[196:199], v[140:143], v[40:55]
    s_waitcnt lgkmcnt(4)
    ds_read_b64_tr_b16 a[236:237], v12 offset:40960
    ds_read_b64_tr_b16 a[238:239], v12 offset:43008
    v_cvt_pk_bf16_f32 v81, v30, v31
    v_exp_f32 v32, v60
    v_lshlrev_b32 v36, 16, v200
    v_mfma_f32_32x32x16_bf16 a[0:15], a[224:227], v[72:75], a[0:15]
    ds_read_b64_tr_b16 a[240:241], v9 offset:45056
    ds_read_b64_tr_b16 a[242:243], v9 offset:47104
    v_exp_f32 v33, v61
    v_add_f32 v21, v21, v32
    v_add_f32 v21, v21, v33
    v_mfma_f32_32x32x16_bf16 v[40:55], a[200:203], v[144:147], v[40:55]
    ds_read_b64_tr_b16 a[244:245], v10 offset:45056
    ds_read_b64_tr_b16 a[246:247], v10 offset:47104
    v_cvt_pk_bf16_f32 v82, v32, v33
    v_exp_f32 v34, v62
    v_and_b32 v37, s35, v200
    v_mfma_f32_32x32x16_bf16 v[40:55], a[204:207], v[148:151], v[40:55]
    s_waitcnt lgkmcnt(8)
    ds_read_b64_tr_b16 a[248:249], v11 offset:45056
    ds_read_b64_tr_b16 a[250:251], v11 offset:47104
    v_exp_f32 v35, v63
    v_add_f32 v21, v21, v34
    v_add_f32 v21, v21, v35
    v_mfma_f32_32x32x16_bf16 a[16:31], a[228:231], v[72:75], a[16:31]
    ds_read_b64_tr_b16 a[252:253], v12 offset:45056
    ds_read_b64_tr_b16 a[254:255], v12 offset:47104
    v_cvt_pk_bf16_f32 v83, v34, v35
    v_exp_f32 v28, v64
    v_mul_f32 v36, s34, v36
    v_mfma_f32_32x32x16_bf16 v[40:55], a[208:211], v[152:155], v[40:55]
    buffer_load_dwordx4 v13, s[16:19], s52 offen offset:0 nt lds
    v_exp_f32 v29, v65
    v_mfma_f32_32x32x16_bf16 v[40:55], a[212:215], v[156:159], v[40:55]
    s_waitcnt lgkmcnt(10)
    buffer_load_dwordx4 v14, s[16:19], s52 offen offset:1024 nt lds
    s_add_u32 m0, s28, 122880
    v_add_f32 v21, v21, v28
    v_mfma_f32_32x32x16_bf16 a[32:47], a[232:235], v[72:75], a[32:47]
    buffer_load_dwordx4 v15, s[20:23], s51 offen offset:0 nt lds
    v_add_f32 v21, v21, v29
    v_cvt_pk_bf16_f32 v84, v28, v29
    v_mfma_f32_32x32x16_bf16 v[40:55], a[216:219], v[160:163], v[40:55]
    ds_read_b128 v[204:207], v233 offset:0
    ds_read_b128 v[208:211], v234 offset:0
    v_exp_f32 v30, v66
    v_exp_f32 v31, v67
    v_mfma_f32_32x32x16_bf16 v[40:55], a[220:223], v[164:167], v[40:55]
    s_waitcnt lgkmcnt(10)
    buffer_load_dwordx4 v15, s[20:23], s51 offen offset:1024 nt lds
    v_add_f32 v21, v21, v30
    v_add_f32 v21, v21, v31
    v_mfma_f32_32x32x16_bf16 a[48:63], a[236:239], v[72:75], a[48:63]
    s_waitcnt lgkmcnt(8)
    ds_read_b128 v[212:215], v235 offset:0
    v_cvt_pk_bf16_f32 v85, v30, v31
    v_exp_f32 v32, v68
    v_exp_f32 v33, v69
    v_mfma_f32_32x32x16_bf16 a[0:15], a[240:243], v[76:79], a[0:15]
    s_waitcnt lgkmcnt(7)
    v_add_f32 v21, v21, v32
    v_add_f32 v21, v21, v33
    v_cvt_pk_bf16_f32 v86, v32, v33
    v_exp_f32 v34, v70
    v_mul_f32 v37, s34, v37
    v_mfma_f32_32x32x16_bf16 a[16:31], a[244:247], v[76:79], a[16:31]
    s_waitcnt lgkmcnt(5)
    v_exp_f32 v35, v71
    v_add_f32 v21, v21, v34
    v_add_f32 v21, v21, v35
    v_cvt_pk_bf16_f32 v87, v34, v35
    v_cmp_lt_f32 vcc, s29, v21
    v_mfma_f32_32x32x16_bf16 a[32:47], a[248:251], v[76:79], a[32:47]
    s_waitcnt lgkmcnt(3)
    s_cbranch_vccnz L_tr9
L_bk9:
    v_exp_f32 v28, v40
    v_exp_f32 v29, v41
    v_add_f32 v18, v18, v21
    v_mfma_f32_32x32x16_bf16 a[48:63], a[252:255], v[76:79], a[48:63]
    v_add_f32 v20, v28, v29
    v_cvt_pk_bf16_f32 v72, v28, v29
    v_exp_f32 v30, v42
    v_exp_f32 v31, v43
    v_mfma_f32_32x32x16_bf16 v[56:71], a[192:195], v[168:171], v[104:119]
    s_waitcnt vmcnt(8)
    ds_read_b128 v[216:219], v232 offset:4096
    v_add_f32 v20, v20, v30
    v_add_f32 v20, v20, v31
    v_cvt_pk_bf16_f32 v73, v30, v31
    v_cvt_pk_bf16_f32 v200, v36, v37
    v_mfma_f32_32x32x16_bf16 v[56:71], a[196:199], v[172:175], v[56:71]
    ds_read_b128 v[220:223], v233 offset:4096
    ds_read_b128 v[224:227], v234 offset:4096
    v_exp_f32 v32, v44
    v_exp_f32 v33, v45
    v_mfma_f32_32x32x16_bf16 a[64:79], a[224:227], v[80:83], a[64:79]
    ds_read_b128 v[228:231], v235 offset:4096
    v_add_f32 v20, v20, v32
    v_add_f32 v20, v20, v33
    v_cvt_pk_bf16_f32 v74, v32, v33
    v_exp_f32 v34, v46
    v_mfma_f32_32x32x16_bf16 v[56:71], a[200:203], v[176:179], v[56:71]
    v_exp_f32 v35, v47
    v_add_f32 v20, v20, v34
    v_add_f32 v20, v20, v35
    v_cvt_pk_bf16_f32 v75, v34, v35
    v_lshlrev_b32 v38, 16, v201
    v_mfma_f32_32x32x16_bf16 v[56:71], a[204:207], v[180:183], v[56:71]
    v_exp_f32 v28, v48
    v_exp_f32 v29, v49
    v_add_f32 v20, v20, v28
    v_add_f32 v20, v20, v29
    v_mfma_f32_32x32x16_bf16 a[80:95], a[228:231], v[80:83], a[80:95]
    v_cvt_pk_bf16_f32 v76, v28, v29
    v_exp_f32 v30, v50
    v_exp_f32 v31, v51
    v_add_f32 v20, v20, v30
    v_mfma_f32_32x32x16_bf16 v[56:71], a[208:211], v[184:187], v[56:71]
    v_add_f32 v20, v20, v31
    v_cvt_pk_bf16_f32 v77, v30, v31
    v_exp_f32 v32, v52
    v_exp_f32 v33, v53
    v_mfma_f32_32x32x16_bf16 v[56:71], a[212:215], v[188:191], v[56:71]
    v_add_f32 v20, v20, v32
    v_add_f32 v20, v20, v33
    v_cvt_pk_bf16_f32 v78, v32, v33
    v_exp_f32 v34, v54
    v_and_b32 v39, s35, v201
    v_mfma_f32_32x32x16_bf16 a[96:111], a[232:235], v[80:83], a[96:111]
    v_exp_f32 v35, v55
    v_add_f32 v20, v20, v34
    v_add_f32 v20, v20, v35
    v_cvt_pk_bf16_f32 v79, v34, v35
    v_cmp_lt_f32 vcc, s29, v20
    v_mfma_f32_32x32x16_bf16 v[56:71], a[216:219], v[192:195], v[56:71]
    s_cbranch_vccnz L_tr10
L_bk10:
    v_add_f32 v17, v17, v20
    v_mul_f32 v38, s34, v38
    v_mul_f32 v39, s34, v39
    v_cvt_pk_bf16_f32 v201, v38, v39
    v_lshlrev_b32 v36, 16, v202
    v_and_b32 v37, s35, v202
    v_mfma_f32_32x32x16_bf16 v[56:71], a[220:223], v[196:199], v[56:71]
    v_mul_f32 v36, s34, v36
    v_mul_f32 v37, s34, v37
    v_cvt_pk_bf16_f32 v202, v36, v37
    v_lshlrev_b32 v38, 16, v203
    v_and_b32 v39, s35, v203
    v_mul_f32 v38, s34, v38
    v_mfma_f32_32x32x16_bf16 a[112:127], a[236:239], v[80:83], a[112:127]
    s_waitcnt vmcnt(6)
    s_barrier
    ds_read_b128 a[192:195], v1 offset:57344
    ds_read_b128 a[196:199], v2 offset:57344
    v_mfma_f32_32x32x16_bf16 a[64:79], a[240:243], v[84:87], a[64:79]
    ds_read_b128 a[200:203], v3 offset:57344
    ds_read_b128 a[204:207], v4 offset:57344
    s_add_u32 m0, s28, 106496
    v_exp_f32 v28, v56
    v_mul_f32 v39, s34, v39
    v_mfma_f32_32x32x16_bf16 a[80:95], a[244:247], v[84:87], a[80:95]
    buffer_load_dwordx4 v15, s[20:23], s52 offen offset:0 nt lds
    buffer_load_dwordx4 v15, s[20:23], s52 offen offset:1024 nt lds
    s_add_u32 m0, s28, 49152
    s_nop 0
    buffer_load_dwordx4 v13, s[16:19], s53 offen offset:0 nt lds
    buffer_load_dwordx4 v14, s[16:19], s53 offen offset:1024 nt lds
    s_waitcnt vmcnt(8)
    s_barrier
    v_mfma_f32_32x32x16_bf16 a[96:111], a[248:251], v[84:87], a[96:111]
    ds_read_b64_tr_b16 a[224:225], v9 offset:49152
    ds_read_b64_tr_b16 a[226:227], v9 offset:51200
    v_exp_f32 v29, v57
    v_exp_f32 v30, v58
    v_mfma_f32_32x32x16_bf16 a[112:127], a[252:255], v[84:87], a[112:127]
    s_waitcnt lgkmcnt(5)
    ds_read_b64_tr_b16 a[228:229], v10 offset:49152
    ds_read_b64_tr_b16 a[230:231], v10 offset:51200
    v_add_f32 v21, v28, v29
    v_cvt_pk_bf16_f32 v80, v28, v29
    v_exp_f32 v31, v59
    v_mfma_f32_32x32x16_bf16 v[40:55], a[192:195], v[136:139], v[88:103]
    s_waitcnt lgkmcnt(6)
    ds_read_b128 a[208:211], v5 offset:57344
    ds_read_b128 a[212:215], v6 offset:57344
    v_add_f32 v21, v21, v30
    v_add_f32 v21, v21, v31
    v_cvt_pk_bf16_f32 v81, v30, v31
    v_cvt_pk_bf16_f32 v203, v38, v39
    v_mfma_f32_32x32x16_bf16 v[40:55], a[196:199], v[140:143], v[40:55]
    s_waitcnt lgkmcnt(4)
    ds_read_b64_tr_b16 a[232:233], v11 offset:49152
    ds_read_b64_tr_b16 a[234:235], v11 offset:51200
    v_exp_f32 v32, v60
    v_exp_f32 v33, v61
    v_mfma_f32_32x32x16_bf16 a[0:15], a[224:227], v[72:75], a[0:15]
    ds_read_b128 a[216:219], v7 offset:57344
    ds_read_b128 a[220:223], v8 offset:57344
    v_add_f32 v21, v21, v32
    v_add_f32 v21, v21, v33
    v_cvt_pk_bf16_f32 v82, v32, v33
    v_lshlrev_b32 v36, 16, v204
    v_mfma_f32_32x32x16_bf16 v[40:55], a[200:203], v[144:147], v[40:55]
    ds_read_b64_tr_b16 a[236:237], v12 offset:49152
    ds_read_b64_tr_b16 a[238:239], v12 offset:51200
    v_exp_f32 v34, v62
    v_exp_f32 v35, v63
    v_mfma_f32_32x32x16_bf16 v[40:55], a[204:207], v[148:151], v[40:55]
    s_waitcnt lgkmcnt(8)
    ds_read_b64_tr_b16 a[240:241], v9 offset:53248
    ds_read_b64_tr_b16 a[242:243], v9 offset:55296
    v_add_f32 v21, v21, v34
    v_add_f32 v21, v21, v35
    v_cvt_pk_bf16_f32 v83, v34, v35
    v_and_b32 v37, s35, v204
    v_mfma_f32_32x32x16_bf16 a[16:31], a[228:231], v[72:75], a[16:31]
    s_waitcnt lgkmcnt(9)
    ds_read_b64_tr_b16 a[244:245], v10 offset:53248
    ds_read_b64_tr_b16 a[246:247], v10 offset:55296
    v_exp_f32 v28, v64
    v_exp_f32 v29, v65
    v_mfma_f32_32x32x16_bf16 v[40:55], a[208:211], v[152:155], v[40:55]
    s_waitcnt lgkmcnt(10)
    ds_read_b64_tr_b16 a[248:249], v11 offset:53248
    ds_read_b64_tr_b16 a[250:251], v11 offset:55296
    v_add_f32 v21, v21, v28
    v_add_f32 v21, v21, v29
    v_cvt_pk_bf16_f32 v84, v28, v29
    v_mul_f32 v36, s34, v36
    v_mfma_f32_32x32x16_bf16 v[40:55], a[212:215], v[156:159], v[40:55]
    s_waitcnt lgkmcnt(10)
    ds_read_b64_tr_b16 a[252:253], v12 offset:53248
    ds_read_b64_tr_b16 a[254:255], v12 offset:55296
    v_exp_f32 v30, v66
    v_exp_f32 v31, v67
    v_mfma_f32_32x32x16_bf16 a[32:47], a[232:235], v[72:75], a[32:47]
    s_waitcnt lgkmcnt(11)
    v_add_f32 v21, v21, v30
    v_add_f32 v21, v21, v31
    v_cvt_pk_bf16_f32 v85, v30, v31
    v_exp_f32 v32, v68
    v_mul_f32 v37, s34, v37
    v_mfma_f32_32x32x16_bf16 v[40:55], a[216:219], v[160:163], v[40:55]
    s_waitcnt lgkmcnt(10)
    v_exp_f32 v33, v69
    v_add_f32 v21, v21, v32
    v_add_f32 v21, v21, v33
    v_cvt_pk_bf16_f32 v86, v32, v33
    v_cvt_pk_bf16_f32 v204, v36, v37
    v_mfma_f32_32x32x16_bf16 v[40:55], a[220:223], v[164:167], v[40:55]
    s_waitcnt lgkmcnt(8)
    v_exp_f32 v34, v70
    v_exp_f32 v35, v71
    v_add_f32 v21, v21, v34
    v_add_f32 v21, v21, v35
    v_mfma_f32_32x32x16_bf16 a[48:63], a[236:239], v[72:75], a[48:63]
    s_waitcnt lgkmcnt(6)
    v_cvt_pk_bf16_f32 v87, v34, v35
    v_cmp_lt_f32 vcc, s29, v21
    v_lshlrev_b32 v38, 16, v205
    v_and_b32 v39, s35, v205
    v_mul_f32 v38, s34, v38
    v_mul_f32 v39, s34, v39
    v_mfma_f32_32x32x16_bf16 a[0:15], a[240:243], v[76:79], a[0:15]
    s_waitcnt lgkmcnt(4)
    s_cbranch_vccnz L_tr11
L_bk11:
    v_exp_f32 v28, v40
    v_exp_f32 v29, v41
    v_add_f32 v18, v18, v21
    v_mfma_f32_32x32x16_bf16 a[16:31], a[244:247], v[76:79], a[16:31]
    s_waitcnt lgkmcnt(2)
    v_add_f32 v20, v28, v29
    v_cvt_pk_bf16_f32 v72, v28, v29
    v_exp_f32 v30, v42
    v_exp_f32 v31, v43
    v_mfma_f32_32x32x16_bf16 a[32:47], a[248:251], v[76:79], a[32:47]
    s_waitcnt lgkmcnt(0)
    v_add_f32 v20, v20, v30
    v_add_f32 v20, v20, v31
    v_cvt_pk_bf16_f32 v73, v30, v31
    v_exp_f32 v32, v44
    v_cvt_pk_bf16_f32 v205, v38, v39
    v_mfma_f32_32x32x16_bf16 a[48:63], a[252:255], v[76:79], a[48:63]
    s_waitcnt vmcnt(6)
    s_barrier
    s_add_u32 m0, s28, 114688
    v_add_f32 v20, v20, v32
    v_mfma_f32_32x32x16_bf16 v[56:71], a[192:195], v[168:171], v[104:119]
    buffer_load_dwordx4 v15, s[20:23], s53 offen offset:0 nt lds
    v_exp_f32 v33, v45
    v_mfma_f32_32x32x16_bf16 v[56:71], a[196:199], v[172:175], v[56:71]
    buffer_load_dwordx4 v15, s[20:23], s53 offen offset:1024 nt lds
    s_add_u32 m0, s28, 57344
    v_add_f32 v20, v20, v33
    v_mfma_f32_32x32x16_bf16 a[64:79], a[224:227], v[80:83], a[64:79]
    ds_read_b128 a[192:195], v1 offset:40960
    s_waitcnt vmcnt(6)
    s_barrier
    v_cvt_pk_bf16_f32 v74, v32, v33
    v_mfma_f32_32x32x16_bf16 v[56:71], a[200:203], v[176:179], v[56:71]
    ds_read_b128 a[196:199], v2 offset:40960
    buffer_load_dwordx4 v13, s[16:19], s54 offen offset:0 nt lds
    v_lshlrev_b32 v36, 16, v206
    v_mfma_f32_32x32x16_bf16 v[56:71], a[204:207], v[180:183], v[56:71]
    ds_read_b64_tr_b16 a[224:225], v9 offset:57344
    ds_read_b64_tr_b16 a[226:227], v9 offset:59392
    v_exp_f32 v34, v46
    v_exp_f32 v35, v47
    v_mfma_f32_32x32x16_bf16 a[80:95], a[228:231], v[80:83], a[80:95]
    ds_read_b128 a[200:203], v3 offset:40960
    buffer_load_dwordx4 v14, s[16:19], s54 offen offset:1024 nt lds
    v_add_f32 v20, v20, v34
    v_mfma_f32_32x32x16_bf16 v[56:71], a[208:211], v[184:187], v[56:71]
    ds_read_b128 a[204:207], v4 offset:40960
    v_add_f32 v20, v20, v35
    v_cvt_pk_bf16_f32 v75, v34, v35
    v_exp_f32 v28, v48
    v_and_b32 v37, s35, v206
    v_mfma_f32_32x32x16_bf16 v[56:71], a[212:215], v[188:191], v[56:71]
    ds_read_b64_tr_b16 a[228:229], v10 offset:57344
    ds_read_b64_tr_b16 a[230:231], v10 offset:59392
    v_exp_f32 v29, v49
    v_add_f32 v20, v20, v28
    v_add_f32 v20, v20, v29
    v_mfma_f32_32x32x16_bf16 a[96:111], a[232:235], v[80:83], a[96:111]
    ds_read_b128 a[208:211], v5 offset:40960
    v_cvt_pk_bf16_f32 v76, v28, v29
    v_exp_f32 v30, v50
    v_exp_f32 v31, v51
    v_mfma_f32_32x32x16_bf16 v[56:71], a[216:219], v[192:195], v[56:71]
    ds_read_b128 a[212:215], v6 offset:40960
    v_add_f32 v20, v20, v30
    v_add_f32 v20, v20, v31
    v_cvt_pk_bf16_f32 v77, v30, v31
    v_exp_f32 v32, v52
    v_mfma_f32_32x32x16_bf16 v[56:71], a[220:223], v[196:199], v[56:71]
    ds_read_b64_tr_b16 a[232:233], v11 offset:57344
    ds_read_b64_tr_b16 a[234:235], v11 offset:59392
    v_exp_f32 v33, v53
    v_add_f32 v20, v20, v32
    v_add_f32 v20, v20, v33
    v_mfma_f32_32x32x16_bf16 a[112:127], a[236:239], v[80:83], a[112:127]
    ds_read_b128 a[216:219], v7 offset:40960
    v_cvt_pk_bf16_f32 v78, v32, v33
    v_exp_f32 v34, v54
    v_exp_f32 v35, v55
    v_mfma_f32_32x32x16_bf16 a[64:79], a[240:243], v[84:87], a[64:79]
    ds_read_b128 a[220:223], v8 offset:40960
    v_add_f32 v20, v20, v34
    v_add_f32 v20, v20, v35
    v_cvt_pk_bf16_f32 v79, v34, v35
    v_cmp_lt_f32 vcc, s29, v20
    v_mul_f32 v36, s34, v36
    v_mfma_f32_32x32x16_bf16 a[80:95], a[244:247], v[84:87], a[80:95]
    s_cbranch_vccnz L_tr12
L_bk12:
    ds_read_b64_tr_b16 a[236:237], v12 offset:57344
    ds_read_b64_tr_b16 a[238:239], v12 offset:59392
    v_exp_f32 v28, v56
    v_exp_f32 v29, v57
    v_mfma_f32_32x32x16_bf16 a[96:111], a[248:251], v[84:87], a[96:111]
    ds_read_b64_tr_b16 a[240:241], v9 offset:61440
    ds_read_b64_tr_b16 a[242:243], v9 offset:63488
    v_add_f32 v21, v28, v29
    v_cvt_pk_bf16_f32 v80, v28, v29
    v_exp_f32 v30, v58
    v_mfma_f32_32x32x16_bf16 a[112:127], a[252:255], v[84:87], a[112:127]
    s_waitcnt lgkmcnt(15)
    ds_read_b64_tr_b16 a[244:245], v10 offset:61440
    ds_read_b64_tr_b16 a[246:247], v10 offset:63488
    v_exp_f32 v31, v59
    v_add_f32 v21, v21, v30
    v_add_f32 v21, v21, v31
    v_mfma_f32_32x32x16_bf16 v[40:55], a[192:195], v[136:139], v[88:103]
    ds_read_b64_tr_b16 a[248:249], v11 offset:61440
    ds_read_b64_tr_b16 a[250:251], v11 offset:63488
    v_cvt_pk_bf16_f32 v81, v30, v31
    v_exp_f32 v32, v60
    v_add_f32 v17, v17, v20
    v_mfma_f32_32x32x16_bf16 v[40:55], a[196:199], v[140:143], v[40:55]
    s_waitcnt lgkmcnt(15)
    ds_read_b64_tr_b16 a[252:253], v12 offset:61440
    ds_read_b64_tr_b16 a[254:255], v12 offset:63488
    v_exp_f32 v33, v61
    v_add_f32 v21, v21, v32
    v_add_f32 v21, v21, v33
    v_mfma_f32_32x32x16_bf16 a[0:15], a[224:227], v[72:75], a[0:15]
    v_cvt_pk_bf16_f32 v82, v32, v33
    v_exp_f32 v34, v62
    v_exp_f32 v35, v63
    v_add_f32 v21, v21, v34
    v_mfma_f32_32x32x16_bf16 v[40:55], a[200:203], v[144:147], v[40:55]
    v_add_f32 v21, v21, v35
    v_cvt_pk_bf16_f32 v83, v34, v35
    v_exp_f32 v28, v64
    v_exp_f32 v29, v65
    v_mfma_f32_32x32x16_bf16 v[40:55], a[204:207], v[148:151], v[40:55]
    s_waitcnt lgkmcnt(15)
    v_add_f32 v21, v21, v28
    v_add_f32 v21, v21, v29
    v_cvt_pk_bf16_f32 v84, v28, v29
    v_exp_f32 v30, v66
    v_mul_f32 v37, s34, v37
    v_mfma_f32_32x32x16_bf16 a[16:31], a[228:231], v[72:75], a[16:31]
    v_exp_f32 v31, v67
    v_add_f32 v21, v21, v30
    v_add_f32 v21, v21, v31
    v_cvt_pk_bf16_f32 v85, v30, v31
    v_cvt_pk_bf16_f32 v206, v36, v37
    v_mfma_f32_32x32x16_bf16 v[40:55], a[208:211], v[152:155], v[40:55]
    s_waitcnt lgkmcnt(14)
    v_exp_f32 v32, v68
    v_exp_f32 v33, v69
    v_add_f32 v21, v21, v32
    v_add_f32 v21, v21, v33
    v_mfma_f32_32x32x16_bf16 v[40:55], a[212:215], v[156:159], v[40:55]
    s_waitcnt lgkmcnt(12)
    v_cvt_pk_bf16_f32 v86, v32, v33
    v_exp_f32 v34, v70
    v_exp_f32 v35, v71
    v_add_f32 v21, v21, v34
    v_mfma_f32_32x32x16_bf16 a[32:47], a[232:235], v[72:75], a[32:47]
    s_waitcnt lgkmcnt(11)
    v_add_f32 v21, v21, v35
    v_cvt_pk_bf16_f32 v87, v34, v35
    v_cmp_lt_f32 vcc, s29, v21
    v_lshlrev_b32 v38, 16, v207
    v_and_b32 v39, s35, v207
    v_mul_f32 v38, s34, v38
    v_mfma_f32_32x32x16_bf16 v[40:55], a[216:219], v[160:163], v[40:55]
    s_waitcnt lgkmcnt(10)
    s_cbranch_vccnz L_tr13
L_bk13:
    v_mul_f32 v39, s34, v39
    v_cvt_pk_bf16_f32 v207, v38, v39
    v_lshlrev_b32 v36, 16, v208
    v_and_b32 v37, s35, v208
    v_mul_f32 v36, s34, v36
    v_mfma_f32_32x32x16_bf16 v[40:55], a[220:223], v[164:167], v[40:55]
    s_waitcnt lgkmcnt(8)
    v_mul_f32 v37, s34, v37
    v_cvt_pk_bf16_f32 v208, v36, v37
    v_lshlrev_b32 v38, 16, v209
    v_and_b32 v39, s35, v209
    v_mul_f32 v38, s34, v38
    v_mul_f32 v39, s34, v39
    v_mfma_f32_32x32x16_bf16 a[48:63], a[236:239], v[72:75], a[48:63]
    s_waitcnt lgkmcnt(6)
    v_cvt_pk_bf16_f32 v209, v38, v39
    v_lshlrev_b32 v36, 16, v210
    v_and_b32 v37, s35, v210
    v_exp_f32 v28, v40
    v_mul_f32 v36, s34, v36
    v_mfma_f32_32x32x16_bf16 a[0:15], a[240:243], v[76:79], a[0:15]
    s_waitcnt lgkmcnt(4)
    v_exp_f32 v29, v41
    v_exp_f32 v30, v42
    v_add_f32 v20, v28, v29
    v_cvt_pk_bf16_f32 v72, v28, v29
    v_mfma_f32_32x32x16_bf16 a[16:31], a[244:247], v[76:79], a[16:31]
    s_waitcnt lgkmcnt(2)
    v_exp_f32 v31, v43
    v_add_f32 v20, v20, v30
    v_add_f32 v20, v20, v31
    v_cvt_pk_bf16_f32 v73, v30, v31
    v_mul_f32 v37, s34, v37
    v_mfma_f32_32x32x16_bf16 a[32:47], a[248:251], v[76:79], a[32:47]
    s_waitcnt lgkmcnt(0)
    v_exp_f32 v32, v44
    v_exp_f32 v33, v45
    v_add_f32 v20, v20, v32
    v_add_f32 v20, v20, v33
    v_mfma_f32_32x32x16_bf16 a[48:63], a[252:255], v[76:79], a[48:63]
    v_cvt_pk_bf16_f32 v74, v32, v33
    v_exp_f32 v34, v46
    v_exp_f32 v35, v47
    v_add_f32 v20, v20, v34
    v_mfma_f32_32x32x16_bf16 v[56:71], a[192:195], v[168:171], v[104:119]
    v_add_f32 v20, v20, v35
    v_cvt_pk_bf16_f32 v75, v34, v35
    v_exp_f32 v28, v48
    v_exp_f32 v29, v49
    v_mfma_f32_32x32x16_bf16 v[56:71], a[196:199], v[172:175], v[56:71]
    s_waitcnt vmcnt(4)
    s_barrier
    s_add_u32 m0, s28, 122880
    v_add_f32 v20, v20, v28
    v_mfma_f32_32x32x16_bf16 a[64:79], a[224:227], v[80:83], a[64:79]
    buffer_load_dwordx4 v15, s[20:23], s54 offen offset:0 nt lds
    v_add_f32 v20, v20, v29
    v_cvt_pk_bf16_f32 v76, v28, v29
    v_mfma_f32_32x32x16_bf16 v[56:71], a[200:203], v[176:179], v[56:71]
    buffer_load_dwordx4 v15, s[20:23], s54 offen offset:1024 nt lds
    s_add_u32 m0, s28, 40960
    v_cvt_pk_bf16_f32 v210, v36, v37
    v_mfma_f32_32x32x16_bf16 v[56:71], a[204:207], v[180:183], v[56:71]
    ds_read_b64_tr_b16 a[224:225], v9 offset:40960
    ds_read_b64_tr_b16 a[226:227], v9 offset:43008
    v_exp_f32 v30, v50
    v_exp_f32 v31, v51
    v_mfma_f32_32x32x16_bf16 a[80:95], a[228:231], v[80:83], a[80:95]
    buffer_load_dwordx4 v13, s[16:19], s55 offen offset:0 nt lds
    v_add_f32 v20, v20, v30
    v_add_f32 v20, v20, v31
    v_mfma_f32_32x32x16_bf16 v[56:71], a[208:211], v[184:187], v[56:71]
    buffer_load_dwordx4 v14, s[16:19], s55 offen offset:1024 nt lds
    v_cvt_pk_bf16_f32 v77, v30, v31
    v_lshlrev_b32 v38, 16, v211
    v_mfma_f32_32x32x16_bf16 v[56:71], a[212:215], v[188:191], v[56:71]
    ds_read_b64_tr_b16 a[228:229], v10 offset:40960
    ds_read_b64_tr_b16 a[230:231], v10 offset:43008
    v_exp_f32 v32, v52
    v_exp_f32 v33, v53
    v_mfma_f32_32x32x16_bf16 a[96:111], a[232:235], v[80:83], a[96:111]
    v_add_f32 v20, v20, v32
    v_add_f32 v20, v20, v33
    v_cvt_pk_bf16_f32 v78, v32, v33
    v_exp_f32 v34, v54
    v_and_b32 v39, s35, v211
    v_mfma_f32_32x32x16_bf16 v[56:71], a[216:219], v[192:195], v[56:71]
    v_exp_f32 v35, v55
    v_add_f32 v20, v20, v34
    v_add_f32 v20, v20, v35
    v_cvt_pk_bf16_f32 v79, v34, v35
    v_cmp_lt_f32 vcc, s29, v20
    v_mfma_f32_32x32x16_bf16 v[56:71], a[220:223], v[196:199], v[56:71]
    s_cbranch_vccnz L_tr14
L_bk14:
    ds_read_b64_tr_b16 a[232:233], v11 offset:40960
    ds_read_b64_tr_b16 a[234:235], v11 offset:43008
    v_mul_f32 v38, s34, v38
    v_mul_f32 v39, s34, v39
    v_cvt_pk_bf16_f32 v211, v38, v39
    v_lshlrev_b32 v36, 16, v212
    v_mfma_f32_32x32x16_bf16 a[112:127], a[236:239], v[80:83], a[112:127]
    v_and_b32 v37, s35, v212
    v_mul_f32 v36, s34, v36
    v_mul_f32 v37, s34, v37
    v_cvt_pk_bf16_f32 v212, v36, v37
    v_lshlrev_b32 v38, 16, v213
    v_and_b32 v39, s35, v213
    v_mfma_f32_32x32x16_bf16 a[64:79], a[240:243], v[84:87], a[64:79]
    v_mul_f32 v38, s34, v38
    v_mul_f32 v39, s34, v39
    v_cvt_pk_bf16_f32 v213, v38, v39
    v_lshlrev_b32 v36, 16, v214
    v_and_b32 v37, s35, v214
    v_mul_f32 v36, s34, v36
    v_mfma_f32_32x32x16_bf16 a[80:95], a[244:247], v[84:87], a[80:95]
    ds_read_b64_tr_b16 a[236:237], v12 offset:40960
    ds_read_b64_tr_b16 a[238:239], v12 offset:43008
    v_mul_f32 v37, s34, v37
    v_cvt_pk_bf16_f32 v214, v36, v37
    v_lshlrev_b32 v38, 16, v215
    v_and_b32 v39, s35, v215
    v_mfma_f32_32x32x16_bf16 a[96:111], a[248:251], v[84:87], a[96:111]
    ds_read_b64_tr_b16 a[240:241], v9 offset:45056
    ds_read_b64_tr_b16 a[242:243], v9 offset:47104
    v_mul_f32 v38, s34, v38
    v_mul_f32 v39, s34, v39
    v_cvt_pk_bf16_f32 v215, v38, v39
    v_lshlrev_b32 v36, 16, v216
    v_mfma_f32_32x32x16_bf16 a[112:127], a[252:255], v[84:87], a[112:127]
    ds_read_b64_tr_b16 a[244:245], v10 offset:45056
    ds_read_b64_tr_b16 a[246:247], v10 offset:47104
    v_and_b32 v37, s35, v216
    v_mul_f32 v36, s34, v36
    v_mul_f32 v37, s34, v37
    v_cvt_pk_bf16_f32 v216, v36, v37
    v_mfma_f32_32x32x16_bf16 v[40:55], a[192:195], v[200:203], 0
    ds_read_b64_tr_b16 a[248:249], v11 offset:45056
    ds_read_b64_tr_b16 a[250:251], v11 offset:47104
    v_lshlrev_b32 v38, 16, v217
    v_and_b32 v39, s35, v217
    v_mul_f32 v38, s34, v38
    v_mul_f32 v39, s34, v39
    v_mfma_f32_32x32x16_bf16 v[40:55], a[196:199], v[204:207], v[40:55]
    s_waitcnt lgkmcnt(12)
    ds_read_b64_tr_b16 a[252:253], v12 offset:45056
    ds_read_b64_tr_b16 a[254:255], v12 offset:47104
    v_cvt_pk_bf16_f32 v217, v38, v39
    v_lshlrev_b32 v36, 16, v218
    v_and_b32 v37, s35, v218
    v_mul_f32 v36, s34, v36
    v_mfma_f32_32x32x16_bf16 a[0:15], a[224:227], v[72:75], a[0:15]
    ds_read_b128 a[192:195], v1 offset:49152
    v_mul_f32 v37, s34, v37
    v_cvt_pk_bf16_f32 v218, v36, v37
    v_lshlrev_b32 v38, 16, v219
    v_and_b32 v39, s35, v219
    v_mul_f32 v38, s34, v38
    v_mfma_f32_32x32x16_bf16 v[40:55], a[200:203], v[208:211], v[40:55]
    ds_read_b128 a[196:199], v2 offset:49152
    v_mul_f32 v39, s34, v39
    v_cvt_pk_bf16_f32 v219, v38, v39
    v_lshlrev_b32 v36, 16, v220
    v_and_b32 v37, s35, v220
    v_mul_f32 v36, s34, v36
    v_mfma_f32_32x32x16_bf16 v[40:55], a[204:207], v[212:215], v[40:55]
    s_waitcnt lgkmcnt(14)
    v_mul_f32 v37, s34, v37
    v_cvt_pk_bf16_f32 v220, v36, v37
    v_lshlrev_b32 v38, 16, v221
    v_and_b32 v39, s35, v221
    v_mul_f32 v38, s34, v38
    v_mul_f32 v39, s34, v39
    v_mfma_f32_32x32x16_bf16 a[16:31], a[228:231], v[72:75], a[16:31]
    ds_read_b128 a[200:203], v3 offset:49152
    v_cvt_pk_bf16_f32 v221, v38, v39
    v_lshlrev_b32 v36, 16, v222
    v_and_b32 v37, s35, v222
    v_mul_f32 v36, s34, v36
    v_mul_f32 v37, s34, v37
    v_mfma_f32_32x32x16_bf16 v[40:55], a[208:211], v[216:219], v[40:55]
    v_cvt_pk_bf16_f32 v222, v36, v37
    v_lshlrev_b32 v38, 16, v223
    v_and_b32 v39, s35, v223
    v_mul_f32 v38, s34, v38
    v_mul_f32 v39, s34, v39
    v_cvt_pk_bf16_f32 v223, v38, v39
    s_nop 1
    v_mfma_f32_32x32x16_bf16 v[40:55], a[212:215], v[220:223], v[40:55]
    s_waitcnt lgkmcnt(13)
    ds_read_b128 a[204:207], v4 offset:49152
    v_lshlrev_b32 v36, 16, v224
    v_and_b32 v37, s35, v224
    v_mul_f32 v36, s34, v36
    v_mul_f32 v37, s34, v37
    v_cvt_pk_bf16_f32 v224, v36, v37
    v_mfma_f32_32x32x16_bf16 a[32:47], a[232:235], v[72:75], a[32:47]
    v_lshlrev_b32 v38, 16, v225
    v_and_b32 v39, s35, v225
    v_mul_f32 v38, s34, v38
    v_mul_f32 v39, s34, v39
    v_cvt_pk_bf16_f32 v225, v38, v39
    v_lshlrev_b32 v36, 16, v226
    v_and_b32 v37, s35, v226
    v_mul_f32 v36, s34, v36
    v_mul_f32 v37, s34, v37
    v_cvt_pk_bf16_f32 v226, v36, v37
    v_lshlrev_b32 v38, 16, v227
    v_and_b32 v39, s35, v227
    v_mul_f32 v38, s34, v38
    v_mul_f32 v39, s34, v39
    v_cvt_pk_bf16_f32 v227, v38, v39
    s_nop 1
    v_mfma_f32_32x32x16_bf16 v[40:55], a[216:219], v[224:227], v[40:55]
    v_lshlrev_b32 v36, 16, v228
    v_and_b32 v37, s35, v228
    v_mul_f32 v36, s34, v36
    v_mul_f32 v37, s34, v37
    v_cvt_pk_bf16_f32 v228, v36, v37
    v_lshlrev_b32 v38, 16, v229
    v_and_b32 v39, s35, v229
    v_mul_f32 v38, s34, v38
    v_mul_f32 v39, s34, v39
    v_cvt_pk_bf16_f32 v229, v38, v39
    v_lshlrev_b32 v36, 16, v230
    v_and_b32 v37, s35, v230
    v_mul_f32 v36, s34, v36
    v_mul_f32 v37, s34, v37
    v_cvt_pk_bf16_f32 v230, v36, v37
    v_lshlrev_b32 v38, 16, v231
    v_and_b32 v39, s35, v231
    v_mul_f32 v38, s34, v38
    v_mul_f32 v39, s34, v39
    v_cvt_pk_bf16_f32 v231, v38, v39
    s_nop 1
    v_mfma_f32_32x32x16_bf16 v[40:55], a[220:223], v[228:231], v[40:55]
    s_waitcnt lgkmcnt(12)
    ds_read_b128 a[208:211], v5 offset:49152
    ds_read_b128 a[212:215], v6 offset:49152
    v_add_f32 v18, v18, v21
    v_exp_f32 v28, v56
    v_add_f32 v17, v17, v20
    v_mfma_f32_32x32x16_bf16 a[48:63], a[236:239], v[72:75], a[48:63]
    s_waitcnt lgkmcnt(12)
    ds_read_b128 a[216:219], v7 offset:49152
    v_exp_f32 v29, v57
    v_exp_f32 v30, v58
    v_add_f32 v21, v28, v29
    v_mfma_f32_32x32x16_bf16 a[0:15], a[240:243], v[76:79], a[0:15]
    s_waitcnt lgkmcnt(11)
    ds_read_b128 a[220:223], v8 offset:49152
    v_cvt_pk_bf16_f32 v80, v28, v29
    v_exp_f32 v31, v59
    v_add_f32 v21, v21, v30
    v_add_f32 v21, v21, v31
    v_mfma_f32_32x32x16_bf16 a[16:31], a[244:247], v[76:79], a[16:31]
    s_waitcnt lgkmcnt(10)
    v_cvt_pk_bf16_f32 v81, v30, v31
    v_exp_f32 v32, v60
L_stub1_0:
    s_cbranch_scc1 L_stub1_1
    v_exp_f32 v33, v61
    v_add_f32 v21, v21, v32
    v_mfma_f32_32x32x16_bf16 a[32:47], a[248:251], v[76:79], a[32:47]
    s_waitcnt lgkmcnt(8)
    v_add_f32 v21, v21, v33
    v_cvt_pk_bf16_f32 v82, v32, v33
    v_exp_f32 v34, v62
    v_exp_f32 v35, v63
    v_add_f32 v21, v21, v34
    v_add_f32 v21, v21, v35
    v_cvt_pk_bf16_f32 v83, v34, v35
    v_exp_f32 v28, v64
    v_exp_f32 v29, v65
    v_add_f32 v21, v21, v28
    v_add_f32 v21, v21, v29
    v_cvt_pk_bf16_f32 v84, v28, v29
    v_exp_f32 v30, v66
    v_exp_f32 v31, v67
    v_add_f32 v21, v21, v30
    v_add_f32 v21, v21, v31
    v_cvt_pk_bf16_f32 v85, v30, v31
    v_exp_f32 v32, v68
    v_exp_f32 v33, v69
    v_add_f32 v21, v21, v32
    v_add_f32 v21, v21, v33
    v_cvt_pk_bf16_f32 v86, v32, v33
    v_exp_f32 v34, v70
    v_exp_f32 v35, v71
    v_add_f32 v21, v21, v34
    v_add_f32 v21, v21, v35
    v_cvt_pk_bf16_f32 v87, v34, v35
    v_cmp_lt_f32 vcc, s29, v21
    v_mfma_f32_32x32x16_bf16 a[48:63], a[252:255], v[76:79], a[48:63]
    s_waitcnt lgkmcnt(7)
    s_cbranch_vccnz L_tr15
L_bk15:
    v_max3_f32 v22, v40, v41, v42
    v_max3_f32 v23, v43, v44, v45
    v_max3_f32 v22, v22, v46, v47
    v_max3_f32 v23, v23, v48, v49
    v_max3_f32 v22, v22, v50, v51
    v_mfma_f32_32x32x16_bf16 v[56:71], a[192:195], v[136:139], v[88:103]
    s_waitcnt lgkmcnt(6)
    v_max3_f32 v23, v23, v52, v53
    v_max3_f32 v22, v22, v54, v55
    v_max_f32 v22, v22, v23
    v_mov_b32 v23, v22
    v_add_f32 v18, v18, v21
    v_mfma_f32_32x32x16_bf16 v[56:71], a[196:199], v[140:143], v[56:71]
    v_permlane32_swap_b32 v22, v23
    v_max_f32 v22, v22, v23
    v_sub_f32 v120, 0, v22
    v_add_f32 v40, v120, v40
    v_add_f32 v41, v120, v41
    v_mfma_f32_32x32x16_bf16 a[64:79], a[224:227], v[80:83], a[64:79]
    s_waitcnt lgkmcnt(5)
    v_exp_f32 v28, v40
    v_exp_f32 v29, v41
    v_add_f32 v42, v120, v42
    v_add_f32 v20, v28, v29
    v_mfma_f32_32x32x16_bf16 v[56:71], a[200:203], v[144:147], v[56:71]
    s_waitcnt lgkmcnt(4)
    v_cvt_pk_bf16_f32 v72, v28, v29
    v_exp_f32 v30, v42
    v_add_f32 v43, v120, v43
    v_exp_f32 v31, v43
    v_mfma_f32_32x32x16_bf16 v[56:71], a[204:207], v[148:151], v[56:71]
    v_add_f32 v20, v20, v30
    v_add_f32 v20, v20, v31
    v_cvt_pk_bf16_f32 v73, v30, v31
    v_add_f32 v44, v120, v44
    v_exp_f32 v32, v44
    v_mfma_f32_32x32x16_bf16 a[80:95], a[228:231], v[80:83], a[80:95]
    s_waitcnt lgkmcnt(3)
    v_add_f32 v45, v120, v45
    v_exp_f32 v33, v45
    v_add_f32 v20, v20, v32
    v_add_f32 v20, v20, v33
    v_cvt_pk_bf16_f32 v74, v32, v33
    v_mfma_f32_32x32x16_bf16 v[56:71], a[208:211], v[152:155], v[56:71]
    s_waitcnt lgkmcnt(2)
    v_add_f32 v46, v120, v46
    v_exp_f32 v34, v46
    v_add_f32 v47, v120, v47
    v_exp_f32 v35, v47
    v_mfma_f32_32x32x16_bf16 v[56:71], a[212:215], v[156:159], v[56:71]
    v_add_f32 v20, v20, v34
    v_add_f32 v20, v20, v35
    v_cvt_pk_bf16_f32 v75, v34, v35
    v_add_f32 v48, v120, v48
    v_exp_f32 v28, v48
    v_mfma_f32_32x32x16_bf16 a[96:111], a[232:235], v[80:83], a[96:111]
    s_waitcnt lgkmcnt(1)
    v_add_f32 v49, v120, v49
    v_exp_f32 v29, v49
    v_add_f32 v50, v120, v50
    v_exp_f32 v30, v50
    v_mfma_f32_32x32x16_bf16 v[56:71], a[216:219], v[160:163], v[56:71]
    s_waitcnt lgkmcnt(0)
    v_add_f32 v51, v120, v51
    v_exp_f32 v31, v51
    v_add_f32 v52, v120, v52
    v_exp_f32 v32, v52
    v_mfma_f32_32x32x16_bf16 v[56:71], a[220:223], v[164:167], v[56:71]
    v_add_f32 v53, v120, v53
    v_exp_f32 v33, v53
    v_add_f32 v54, v120, v54
    v_exp_f32 v34, v54
    v_mfma_f32_32x32x16_bf16 a[112:127], a[236:239], v[80:83], a[112:127]
    v_add_f32 v55, v120, v55
    v_exp_f32 v35, v55
    v_cvt_pk_bf16_f32 v76, v28, v29
    v_cvt_pk_bf16_f32 v77, v30, v31
    v_cvt_pk_bf16_f32 v78, v32, v33
    v_mfma_f32_32x32x16_bf16 a[64:79], a[240:243], v[84:87], a[64:79]
    v_cvt_pk_bf16_f32 v79, v34, v35
    v_add_f32 v20, v20, v28
    v_add_f32 v20, v20, v29
    v_add_f32 v20, v20, v30
    v_add_f32 v20, v20, v31
    v_add_f32 v20, v20, v32
    v_mfma_f32_32x32x16_bf16 a[80:95], a[244:247], v[84:87], a[80:95]
    v_add_f32 v20, v20, v33
    v_add_f32 v20, v20, v34
    v_add_f32 v20, v20, v35
    v_exp_f32 v28, v56
    v_mov_b32 v121, v120
    v_mfma_f32_32x32x16_bf16 a[96:111], a[248:251], v[84:87], a[96:111]
    v_exp_f32 v29, v57
    v_exp_f32 v30, v58
    v_add_f32 v21, v28, v29
    v_cvt_pk_bf16_f32 v80, v28, v29
    v_mfma_f32_32x32x16_bf16 a[112:127], a[252:255], v[84:87], a[112:127]
    v_exp_f32 v31, v59
    v_add_f32 v21, v21, v30
    v_add_f32 v21, v21, v31
    v_cvt_pk_bf16_f32 v81, v30, v31
    v_mov_b32 v122, v120
    v_mfma_f32_32x32x16_bf16 v[40:55], a[192:195], v[168:171], v[104:119]
    v_exp_f32 v32, v60
    v_exp_f32 v33, v61
    v_add_f32 v21, v21, v32
    v_add_f32 v21, v21, v33
    v_mfma_f32_32x32x16_bf16 v[40:55], a[196:199], v[172:175], v[40:55]
    s_waitcnt vmcnt(4)
    s_barrier
    s_add_u32 m0, s28, 106496
    v_cvt_pk_bf16_f32 v82, v32, v33
    v_mfma_f32_32x32x16_bf16 a[128:143], a[224:227], v[72:75], 0
    buffer_load_dwordx4 v15, s[20:23], s55 offen offset:0 nt lds
    v_exp_f32 v34, v62
    v_mfma_f32_32x32x16_bf16 v[40:55], a[200:203], v[176:179], v[40:55]
    buffer_load_dwordx4 v15, s[20:23], s55 offen offset:1024 nt lds
    s_add_u32 m0, s28, 49152
    v_add_f32 v21, v21, v34
    v_mfma_f32_32x32x16_bf16 v[40:55], a[204:207], v[180:183], v[40:55]
    ds_read_b64_tr_b16 a[224:225], v9 offset:49152
    ds_read_b64_tr_b16 a[226:227], v9 offset:51200
    v_exp_f32 v35, v63
    v_exp_f32 v28, v64
    v_mfma_f32_32x32x16_bf16 a[144:159], a[228:231], v[72:75], 0
    buffer_load_dwordx4 v13, s[16:19], s56 offen offset:0 nt lds
    v_add_f32 v21, v21, v35
    v_cvt_pk_bf16_f32 v83, v34, v35
    v_mfma_f32_32x32x16_bf16 v[40:55], a[208:211], v[184:187], v[40:55]
    buffer_load_dwordx4 v14, s[16:19], s56 offen offset:1024 nt lds
    v_exp_f32 v29, v65
    v_mfma_f32_32x32x16_bf16 v[40:55], a[212:215], v[188:191], v[40:55]
    ds_read_b64_tr_b16 a[228:229], v10 offset:49152
    ds_read_b64_tr_b16 a[230:231], v10 offset:51200
    v_add_f32 v21, v21, v28
    v_add_f32 v21, v21, v29
    v_cvt_pk_bf16_f32 v84, v28, v29
    v_mov_b32 v123, v120
    v_mfma_f32_32x32x16_bf16 a[160:175], a[232:235], v[72:75], 0
    v_exp_f32 v30, v66
    v_exp_f32 v31, v67
    v_add_f32 v21, v21, v30
    v_add_f32 v21, v21, v31
    v_mfma_f32_32x32x16_bf16 v[40:55], a[216:219], v[192:195], v[40:55]
    v_cvt_pk_bf16_f32 v85, v30, v31
    v_exp_f32 v32, v68
    v_exp_f32 v33, v69
    v_add_f32 v21, v21, v32
    v_mfma_f32_32x32x16_bf16 v[40:55], a[220:223], v[196:199], v[40:55]
    ds_read_b64_tr_b16 a[232:233], v11 offset:49152
    ds_read_b64_tr_b16 a[234:235], v11 offset:51200
    v_add_f32 v21, v21, v33
    v_cvt_pk_bf16_f32 v86, v32, v33
    v_exp_f32 v34, v70
    v_mfma_f32_32x32x16_bf16 a[176:191], a[236:239], v[72:75], 0
    v_exp_f32 v35, v71
    v_add_f32 v21, v21, v34
    v_add_f32 v21, v21, v35
    v_cvt_pk_bf16_f32 v87, v34, v35
    v_cmp_lt_f32 vcc, s29, v21
    v_mfma_f32_32x32x16_bf16 a[128:143], a[240:243], v[76:79], a[128:143]
    s_cbranch_vccnz L_tr17
L_bk17:
    v_mov_b32 v124, v120
    v_mov_b32 v125, v120
    v_mov_b32 v126, v120
    v_mov_b32 v127, v120
    v_mov_b32 v128, v120
    v_mov_b32 v129, v120
    v_mfma_f32_32x32x16_bf16 a[144:159], a[244:247], v[76:79], a[144:159]
    ds_read_b64_tr_b16 a[236:237], v12 offset:49152
    ds_read_b64_tr_b16 a[238:239], v12 offset:51200
    v_mov_b32 v130, v120
    v_mov_b32 v131, v120
    v_mov_b32 v132, v120
    v_mov_b32 v133, v120
    v_mfma_f32_32x32x16_bf16 a[160:175], a[248:251], v[76:79], a[160:175]
    ds_read_b64_tr_b16 a[240:241], v9 offset:53248
    ds_read_b64_tr_b16 a[242:243], v9 offset:55296
    v_mov_b32 v134, v120
    v_mov_b32 v135, v120
    v_mov_b32 v19, v20
    v_add_f32 v17, v17, v21
    v_mfma_f32_32x32x16_bf16 a[176:191], a[252:255], v[76:79], a[176:191]
    ds_read_b64_tr_b16 a[244:245], v10 offset:53248
    ds_read_b64_tr_b16 a[246:247], v10 offset:55296
    v_exp_f32 v28, v40
    v_exp_f32 v29, v41
    v_mfma_f32_32x32x16_bf16 v[56:71], a[192:195], v[200:203], v[120:135]
    ds_read_b64_tr_b16 a[248:249], v11 offset:53248
    ds_read_b64_tr_b16 a[250:251], v11 offset:55296
    v_add_f32 v20, v28, v29
    v_cvt_pk_bf16_f32 v72, v28, v29
    v_exp_f32 v30, v42
    v_mfma_f32_32x32x16_bf16 v[56:71], a[196:199], v[204:207], v[56:71]
    s_waitcnt lgkmcnt(12)
    ds_read_b64_tr_b16 a[252:253], v12 offset:53248
    ds_read_b64_tr_b16 a[254:255], v12 offset:55296
    v_exp_f32 v31, v43
    v_add_f32 v20, v20, v30
    v_add_f32 v20, v20, v31
    v_mfma_f32_32x32x16_bf16 a[0:15], a[224:227], v[80:83], a[0:15]
    ds_read_b128 a[192:195], v1 offset:57344
    v_cvt_pk_bf16_f32 v73, v30, v31
    v_exp_f32 v32, v44
    v_mfma_f32_32x32x16_bf16 v[56:71], a[200:203], v[208:211], v[56:71]
    ds_read_b128 a[196:199], v2 offset:57344
    v_exp_f32 v33, v45
    v_add_f32 v20, v20, v32
    v_add_f32 v20, v20, v33
    v_mfma_f32_32x32x16_bf16 v[56:71], a[204:207], v[212:215], v[56:71]
    s_waitcnt lgkmcnt(14)
    v_cvt_pk_bf16_f32 v74, v32, v33
    v_exp_f32 v34, v46
    v_exp_f32 v35, v47
    v_mfma_f32_32x32x16_bf16 a[16:31], a[228:231], v[80:83], a[16:31]
    ds_read_b128 a[200:203], v3 offset:57344
    v_add_f32 v20, v20, v34
    v_add_f32 v20, v20, v35
    v_cvt_pk_bf16_f32 v75, v34, v35
    v_mfma_f32_32x32x16_bf16 v[56:71], a[208:211], v[216:219], v[56:71]
    ds_read_b128 a[204:207], v4 offset:57344
    v_exp_f32 v28, v48
    v_exp_f32 v29, v49
    v_mfma_f32_32x32x16_bf16 v[56:71], a[212:215], v[220:223], v[56:71]
    s_waitcnt lgkmcnt(14)
    v_add_f32 v20, v20, v28
    v_add_f32 v20, v20, v29
    v_cvt_pk_bf16_f32 v76, v28, v29
    v_exp_f32 v30, v50
    v_mfma_f32_32x32x16_bf16 a[32:47], a[232:235], v[80:83], a[32:47]
    ds_read_b128 a[208:211], v5 offset:57344
    v_exp_f32 v31, v51
    v_add_f32 v20, v20, v30
    v_add_f32 v20, v20, v31
    v_mfma_f32_32x32x16_bf16 v[56:71], a[216:219], v[224:227], v[56:71]
    ds_read_b128 a[212:215], v6 offset:57344
    v_cvt_pk_bf16_f32 v77, v30, v31
    v_exp_f32 v32, v52
    v_mfma_f32_32x32x16_bf16 v[56:71], a[220:223], v[228:231], v[56:71]
    s_waitcnt lgkmcnt(14)
    v_exp_f32 v33, v53
    v_add_f32 v20, v20, v32
    v_add_f32 v20, v20, v33
    v_cvt_pk_bf16_f32 v78, v32, v33
    v_mfma_f32_32x32x16_bf16 a[48:63], a[236:239], v[80:83], a[48:63]
    s_waitcnt lgkmcnt(12)
    ds_read_b128 a[216:219], v7 offset:57344
    v_exp_f32 v34, v54
    v_exp_f32 v35, v55
    v_mfma_f32_32x32x16_bf16 a[0:15], a[240:243], v[84:87], a[0:15]
    s_waitcnt lgkmcnt(11)
    ds_read_b128 a[220:223], v8 offset:57344
    v_add_f32 v20, v20, v34
    v_add_f32 v20, v20, v35
    v_cvt_pk_bf16_f32 v79, v34, v35
    v_cmp_lt_f32 vcc, s29, v20
    v_mfma_f32_32x32x16_bf16 a[16:31], a[244:247], v[84:87], a[16:31]
    s_waitcnt lgkmcnt(10)
    s_cbranch_vccnz L_tr18
L_bk18:
    v_exp_f32 v28, v56
    v_exp_f32 v29, v57
    v_mfma_f32_32x32x16_bf16 a[32:47], a[248:251], v[84:87], a[32:47]
    s_waitcnt lgkmcnt(8)
    v_add_f32 v21, v28, v29
    v_cvt_pk_bf16_f32 v80, v28, v29
    v_exp_f32 v30, v58
    v_add_f32 v18, v18, v20
    v_mfma_f32_32x32x16_bf16 a[48:63], a[252:255], v[84:87], a[48:63]
    s_waitcnt lgkmcnt(7)
    v_exp_f32 v31, v59
    v_add_f32 v21, v21, v30
    v_add_f32 v21, v21, v31
    v_cvt_pk_bf16_f32 v81, v30, v31
    v_mfma_f32_32x32x16_bf16 v[40:55], a[192:195], v[136:139], v[88:103]
    s_waitcnt lgkmcnt(6)
    v_exp_f32 v32, v60
    v_exp_f32 v33, v61
    v_add_f32 v21, v21, v32
    v_mfma_f32_32x32x16_bf16 v[40:55], a[196:199], v[140:143], v[40:55]
    v_add_f32 v21, v21, v33
    v_cvt_pk_bf16_f32 v82, v32, v33
    v_exp_f32 v34, v62
    v_mfma_f32_32x32x16_bf16 a[64:79], a[224:227], v[72:75], a[64:79]
    s_waitcnt lgkmcnt(5)
    v_exp_f32 v35, v63
    v_add_f32 v21, v21, v34
    v_add_f32 v21, v21, v35
    v_cvt_pk_bf16_f32 v83, v34, v35
    v_mfma_f32_32x32x16_bf16 v[40:55], a[200:203], v[144:147], v[40:55]
    s_waitcnt lgkmcnt(4)
    v_exp_f32 v28, v64
    v_exp_f32 v29, v65
    v_add_f32 v21, v21, v28
    v_mfma_f32_32x32x16_bf16 v[40:55], a[204:207], v[148:151], v[40:55]
    v_add_f32 v21, v21, v29
    v_cvt_pk_bf16_f32 v84, v28, v29
    v_exp_f32 v30, v66
    v_mfma_f32_32x32x16_bf16 a[80:95], a[228:231], v[72:75], a[80:95]
    s_waitcnt lgkmcnt(3)
    v_exp_f32 v31, v67
    v_add_f32 v21, v21, v30
    v_add_f32 v21, v21, v31
    v_cvt_pk_bf16_f32 v85, v30, v31
    v_mfma_f32_32x32x16_bf16 v[40:55], a[208:211], v[152:155], v[40:55]
    s_waitcnt lgkmcnt(2)
    v_exp_f32 v32, v68
    v_exp_f32 v33, v69
    v_add_f32 v21, v21, v32
    v_mfma_f32_32x32x16_bf16 v[40:55], a[212:215], v[156:159], v[40:55]
    v_add_f32 v21, v21, v33
    v_cvt_pk_bf16_f32 v86, v32, v33
    v_exp_f32 v34, v70
    v_mfma_f32_32x32x16_bf16 a[96:111], a[232:235], v[72:75], a[96:111]
    s_waitcnt lgkmcnt(1)
    v_exp_f32 v35, v71
    v_add_f32 v21, v21, v34
    v_add_f32 v21, v21, v35
    v_cvt_pk_bf16_f32 v87, v34, v35
    v_mfma_f32_32x32x16_bf16 v[40:55], a[216:219], v[160:163], v[40:55]
    s_waitcnt lgkmcnt(0)
    v_cmp_lt_f32 vcc, s29, v21
    v_mfma_f32_32x32x16_bf16 v[40:55], a[220:223], v[164:167], v[40:55]
    s_cbranch_vccnz L_tr19
L_bk19:
    v_add_f32 v19, v19, v21
    s_nop 3
    v_mfma_f32_32x32x16_bf16 a[112:127], a[236:239], v[72:75], a[112:127]
    s_nop 3
    v_mfma_f32_32x32x16_bf16 a[64:79], a[240:243], v[76:79], a[64:79]
    v_exp_f32 v28, v40
    v_exp_f32 v29, v41
    v_exp_f32 v30, v42
    v_mfma_f32_32x32x16_bf16 a[80:95], a[244:247], v[76:79], a[80:95]
    v_add_f32 v20, v28, v29
    v_cvt_pk_bf16_f32 v72, v28, v29
    v_exp_f32 v31, v43
    v_add_f32 v20, v20, v30
    v_add_f32 v20, v20, v31
    v_mfma_f32_32x32x16_bf16 a[96:111], a[248:251], v[76:79], a[96:111]
    v_cvt_pk_bf16_f32 v73, v30, v31
    v_exp_f32 v32, v44
    v_exp_f32 v33, v45
    v_mfma_f32_32x32x16_bf16 a[112:127], a[252:255], v[76:79], a[112:127]
    v_add_f32 v20, v20, v32
    v_add_f32 v20, v20, v33
    v_cvt_pk_bf16_f32 v74, v32, v33
    v_exp_f32 v34, v46
    v_mfma_f32_32x32x16_bf16 v[56:71], a[192:195], v[168:171], v[104:119]
    v_exp_f32 v35, v47
    v_add_f32 v20, v20, v34
    v_add_f32 v20, v20, v35
    v_cvt_pk_bf16_f32 v75, v34, v35
    v_mfma_f32_32x32x16_bf16 v[56:71], a[196:199], v[172:175], v[56:71]
    s_waitcnt vmcnt(4)
    s_barrier
    s_add_u32 m0, s28, 114688
    v_mfma_f32_32x32x16_bf16 a[128:143], a[224:227], v[80:83], a[128:143]
    buffer_load_dwordx4 v15, s[20:23], s56 offen offset:0 nt lds
    v_mfma_f32_32x32x16_bf16 v[56:71], a[200:203], v[176:179], v[56:71]
    buffer_load_dwordx4 v15, s[20:23], s56 offen offset:1024 nt lds
    s_add_u32 m0, s28, 57344
    v_mfma_f32_32x32x16_bf16 v[56:71], a[204:207], v[180:183], v[56:71]
    ds_read_b64_tr_b16 a[224:225], v9 offset:57344
    ds_read_b64_tr_b16 a[226:227], v9 offset:59392
    v_exp_f32 v28, v48
    v_exp_f32 v29, v49
    v_mfma_f32_32x32x16_bf16 a[144:159], a[228:231], v[80:83], a[144:159]
    buffer_load_dwordx4 v13, s[16:19], s57 offen offset:0 nt lds
    v_add_f32 v20, v20, v28
    v_add_f32 v20, v20, v29
    v_mfma_f32_32x32x16_bf16 v[56:71], a[208:211], v[184:187], v[56:71]
    buffer_load_dwordx4 v14, s[16:19], s57 offen offset:1024 nt lds
    v_cvt_pk_bf16_f32 v76, v28, v29
    v_mfma_f32_32x32x16_bf16 v[56:71], a[212:215], v[188:191], v[56:71]
    ds_read_b64_tr_b16 a[228:229], v10 offset:57344
    ds_read_b64_tr_b16 a[230:231], v10 offset:59392
    v_exp_f32 v30, v50
    v_exp_f32 v31, v51
    v_mfma_f32_32x32x16_bf16 a[160:175], a[232:235], v[80:83], a[160:175]
    v_add_f32 v20, v20, v30
    v_add_f32 v20, v20, v31
    v_cvt_pk_bf16_f32 v77, v30, v31
    v_exp_f32 v32, v52
    v_mfma_f32_32x32x16_bf16 v[56:71], a[216:219], v[192:195], v[56:71]
    v_exp_f32 v33, v53
    v_add_f32 v20, v20, v32
    v_add_f32 v20, v20, v33
    v_cvt_pk_bf16_f32 v78, v32, v33
    v_mfma_f32_32x32x16_bf16 v[56:71], a[220:223], v[196:199], v[56:71]
    ds_read_b64_tr_b16 a[232:233], v11 offset:57344
    ds_read_b64_tr_b16 a[234:235], v11 offset:59392
    v_exp_f32 v34, v54
    s_nop 0
    v_mfma_f32_32x32x16_bf16 a[176:191], a[236:239], v[80:83], a[176:191]
    v_exp_f32 v35, v55
    v_add_f32 v20, v20, v34
    v_add_f32 v20, v20, v35
    v_cvt_pk_bf16_f32 v79, v34, v35
    v_mfma_f32_32x32x16_bf16 a[128:143], a[240:243], v[84:87], a[128:143]
    v_cmp_lt_f32 vcc, s29, v20
    s_nop 0
    v_exp_f32 v28, v56
    v_mfma_f32_32x32x16_bf16 a[144:159], a[244:247], v[84:87], a[144:159]
    s_cbranch_vccnz L_tr20
L_bk20:
    ds_read_b64_tr_b16 a[236:237], v12 offset:57344
    ds_read_b64_tr_b16 a[238:239], v12 offset:59392
    v_exp_f32 v29, v57
    v_add_f32 v17, v17, v20
    v_mfma_f32_32x32x16_bf16 a[160:175], a[248:251], v[84:87], a[160:175]
    ds_read_b64_tr_b16 a[240:241], v9 offset:61440
    ds_read_b64_tr_b16 a[242:243], v9 offset:63488
    v_add_f32 v21, v28, v29
    v_cvt_pk_bf16_f32 v80, v28, v29
    v_mfma_f32_32x32x16_bf16 a[176:191], a[252:255], v[84:87], a[176:191]
    ds_read_b64_tr_b16 a[244:245], v10 offset:61440
    ds_read_b64_tr_b16 a[246:247], v10 offset:63488
    v_exp_f32 v30, v58
    v_mfma_f32_32x32x16_bf16 v[40:55], a[192:195], v[200:203], v[120:135]
    ds_read_b64_tr_b16 a[248:249], v11 offset:61440
    ds_read_b64_tr_b16 a[250:251], v11 offset:63488
    v_exp_f32 v31, v59
    v_add_f32 v21, v21, v30
    v_mfma_f32_32x32x16_bf16 v[40:55], a[196:199], v[204:207], v[40:55]
    s_waitcnt lgkmcnt(12)
    ds_read_b64_tr_b16 a[252:253], v12 offset:61440
    ds_read_b64_tr_b16 a[254:255], v12 offset:63488
    v_add_f32 v21, v21, v31
    v_cvt_pk_bf16_f32 v81, v30, v31
    v_mfma_f32_32x32x16_bf16 a[0:15], a[224:227], v[72:75], a[0:15]
    ds_read_b128 a[192:195], v1 offset:40960
    v_exp_f32 v32, v60
    v_exp_f32 v33, v61
    v_mfma_f32_32x32x16_bf16 v[40:55], a[200:203], v[208:211], v[40:55]
    ds_read_b128 a[196:199], v2 offset:40960
    v_add_f32 v21, v21, v32
    v_add_f32 v21, v21, v33
    v_cvt_pk_bf16_f32 v82, v32, v33
    v_mfma_f32_32x32x16_bf16 v[40:55], a[204:207], v[212:215], v[40:55]
    s_waitcnt lgkmcnt(14)
    v_exp_f32 v34, v62
    v_exp_f32 v35, v63
    v_add_f32 v21, v21, v34
    v_mfma_f32_32x32x16_bf16 a[16:31], a[228:231], v[72:75], a[16:31]
    ds_read_b128 a[200:203], v3 offset:40960
    v_add_f32 v21, v21, v35
    v_cvt_pk_bf16_f32 v83, v34, v35
    v_exp_f32 v28, v64
    v_mfma_f32_32x32x16_bf16 v[40:55], a[208:211], v[216:219], v[40:55]
    ds_read_b128 a[204:207], v4 offset:40960
    v_exp_f32 v29, v65
    v_add_f32 v21, v21, v28
    v_add_f32 v21, v21, v29
    v_mfma_f32_32x32x16_bf16 v[40:55], a[212:215], v[220:223], v[40:55]
    s_waitcnt lgkmcnt(14)
    v_cvt_pk_bf16_f32 v84, v28, v29
    v_exp_f32 v30, v66
    v_exp_f32 v31, v67
    v_mfma_f32_32x32x16_bf16 a[32:47], a[232:235], v[72:75], a[32:47]
    ds_read_b128 a[208:211], v5 offset:40960
    v_add_f32 v21, v21, v30
    v_add_f32 v21, v21, v31
    v_cvt_pk_bf16_f32 v85, v30, v31
    v_mfma_f32_32x32x16_bf16 v[40:55], a[216:219], v[224:227], v[40:55]
    ds_read_b128 a[212:215], v6 offset:40960
    v_exp_f32 v32, v68
    v_exp_f32 v33, v69
    v_mfma_f32_32x32x16_bf16 v[40:55], a[220:223], v[228:231], v[40:55]
    s_waitcnt lgkmcnt(14)
    v_add_f32 v21, v21, v32
    v_add_f32 v21, v21, v33
    v_cvt_pk_bf16_f32 v86, v32, v33
    v_exp_f32 v34, v70
    v_mfma_f32_32x32x16_bf16 a[48:63], a[236:239], v[72:75], a[48:63]
    s_waitcnt lgkmcnt(12)
    ds_read_b128 a[216:219], v7 offset:40960
    v_exp_f32 v35, v71
    v_add_f32 v21, v21, v34
    v_add_f32 v21, v21, v35
    v_mfma_f32_32x32x16_bf16 a[0:15], a[240:243], v[76:79], a[0:15]
    s_waitcnt lgkmcnt(11)
    ds_read_b128 a[220:223], v8 offset:40960
    v_cvt_pk_bf16_f32 v87, v34, v35
    v_cmp_lt_f32 vcc, s29, v21
    v_exp_f32 v28, v40
    v_mfma_f32_32x32x16_bf16 a[16:31], a[244:247], v[76:79], a[16:31]
    s_waitcnt lgkmcnt(10)
    s_cbranch_vccnz L_tr21
L_bk21:
    v_exp_f32 v29, v41
    v_exp_f32 v30, v42
    v_mfma_f32_32x32x16_bf16 a[32:47], a[248:251], v[76:79], a[32:47]
    s_waitcnt lgkmcnt(8)
    v_add_f32 v20, v28, v29
    v_cvt_pk_bf16_f32 v72, v28, v29
    v_exp_f32 v31, v43
    v_add_f32 v20, v20, v30
    v_mfma_f32_32x32x16_bf16 a[48:63], a[252:255], v[76:79], a[48:63]
    s_waitcnt lgkmcnt(7)
    v_add_f32 v20, v20, v31
    v_cvt_pk_bf16_f32 v73, v30, v31
    v_exp_f32 v32, v44
    v_add_f32 v18, v18, v21
    v_mfma_f32_32x32x16_bf16 v[56:71], a[192:195], v[136:139], v[88:103]
    s_waitcnt lgkmcnt(6)
    v_exp_f32 v33, v45
    v_add_f32 v20, v20, v32
    v_add_f32 v20, v20, v33
    v_cvt_pk_bf16_f32 v74, v32, v33
    v_mfma_f32_32x32x16_bf16 v[56:71], a[196:199], v[140:143], v[56:71]
    v_exp_f32 v34, v46
    v_exp_f32 v35, v47
    v_add_f32 v20, v20, v34
    v_mfma_f32_32x32x16_bf16 a[64:79], a[224:227], v[80:83], a[64:79]
    s_waitcnt lgkmcnt(5)
    v_add_f32 v20, v20, v35
    v_cvt_pk_bf16_f32 v75, v34, v35
    v_exp_f32 v28, v48
    v_mfma_f32_32x32x16_bf16 v[56:71], a[200:203], v[144:147], v[56:71]
    s_waitcnt lgkmcnt(4)
    v_exp_f32 v29, v49
    v_add_f32 v20, v20, v28
    v_add_f32 v20, v20, v29
    v_cvt_pk_bf16_f32 v76, v28, v29
    v_mfma_f32_32x32x16_bf16 v[56:71], a[204:207], v[148:151], v[56:71]
    v_exp_f32 v30, v50
    v_exp_f32 v31, v51
    v_add_f32 v20, v20, v30
    v_mfma_f32_32x32x16_bf16 a[80:95], a[228:231], v[80:83], a[80:95]
    s_waitcnt lgkmcnt(3)
    v_add_f32 v20, v20, v31
    v_cvt_pk_bf16_f32 v77, v30, v31
    v_exp_f32 v32, v52
    v_mfma_f32_32x32x16_bf16 v[56:71], a[208:211], v[152:155], v[56:71]
    s_waitcnt lgkmcnt(2)
    v_exp_f32 v33, v53
    v_add_f32 v20, v20, v32
    v_add_f32 v20, v20, v33
    v_cvt_pk_bf16_f32 v78, v32, v33
    v_mfma_f32_32x32x16_bf16 v[56:71], a[212:215], v[156:159], v[56:71]
    v_exp_f32 v34, v54
    v_exp_f32 v35, v55
    v_add_f32 v20, v20, v34
    v_mfma_f32_32x32x16_bf16 a[96:111], a[232:235], v[80:83], a[96:111]
    s_waitcnt lgkmcnt(1)
    v_add_f32 v20, v20, v35
    v_cvt_pk_bf16_f32 v79, v34, v35
    v_cmp_lt_f32 vcc, s29, v20
    v_mfma_f32_32x32x16_bf16 v[56:71], a[216:219], v[160:163], v[56:71]
    s_waitcnt lgkmcnt(0)
    s_cbranch_vccnz L_tr22
L_bk22:
    v_add_f32 v19, v19, v20
    v_mfma_f32_32x32x16_bf16 v[56:71], a[220:223], v[164:167], v[56:71]
    s_nop 4
    v_mfma_f32_32x32x16_bf16 a[112:127], a[236:239], v[80:83], a[112:127]
    s_nop 4
    v_mfma_f32_32x32x16_bf16 a[64:79], a[240:243], v[84:87], a[64:79]
    v_exp_f32 v28, v56
    v_exp_f32 v29, v57
    v_exp_f32 v30, v58
    v_mfma_f32_32x32x16_bf16 a[80:95], a[244:247], v[84:87], a[80:95]
    v_add_f32 v21, v28, v29
    v_cvt_pk_bf16_f32 v80, v28, v29
    v_exp_f32 v31, v59
    v_add_f32 v21, v21, v30
    v_add_f32 v21, v21, v31
    v_mfma_f32_32x32x16_bf16 a[96:111], a[248:251], v[84:87], a[96:111]
    v_cvt_pk_bf16_f32 v81, v30, v31
    v_exp_f32 v32, v60
    v_exp_f32 v33, v61
    v_mfma_f32_32x32x16_bf16 a[112:127], a[252:255], v[84:87], a[112:127]
    v_add_f32 v21, v21, v32
    v_add_f32 v21, v21, v33
    v_cvt_pk_bf16_f32 v82, v32, v33
    v_exp_f32 v34, v62
    v_mfma_f32_32x32x16_bf16 v[40:55], a[192:195], v[168:171], v[104:119]
    v_exp_f32 v35, v63
    v_add_f32 v21, v21, v34
    v_add_f32 v21, v21, v35
    v_cvt_pk_bf16_f32 v83, v34, v35
    v_mfma_f32_32x32x16_bf16 v[40:55], a[196:199], v[172:175], v[40:55]
    s_waitcnt vmcnt(4)
    s_barrier
    s_add_u32 m0, s28, 122880
    v_mfma_f32_32x32x16_bf16 a[128:143], a[224:227], v[72:75], a[128:143]
    buffer_load_dwordx4 v15, s[20:23], s57 offen offset:0 nt lds
    v_mfma_f32_32x32x16_bf16 v[40:55], a[200:203], v[176:179], v[40:55]
    buffer_load_dwordx4 v15, s[20:23], s57 offen offset:1024 nt lds
    s_add_u32 m0, s28, 40960
    v_mfma_f32_32x32x16_bf16 v[40:55], a[204:207], v[180:183], v[40:55]
    ds_read_b64_tr_b16 a[224:225], v9 offset:40960
    ds_read_b64_tr_b16 a[226:227], v9 offset:43008
    v_exp_f32 v28, v64
    v_exp_f32 v29, v65
    v_mfma_f32_32x32x16_bf16 a[144:159], a[228:231], v[72:75], a[144:159]
    buffer_load_dwordx4 v13, s[16:19], s58 offen offset:0 nt lds
    v_add_f32 v21, v21, v28
    v_add_f32 v21, v21, v29
    v_mfma_f32_32x32x16_bf16 v[40:55], a[208:211], v[184:187], v[40:55]
    buffer_load_dwordx4 v14, s[16:19], s58 offen offset:1024 nt lds
    v_cvt_pk_bf16_f32 v84, v28, v29
    v_mfma_f32_32x32x16_bf16 v[40:55], a[212:215], v[188:191], v[40:55]
    ds_read_b64_tr_b16 a[228:229], v10 offset:40960
    ds_read_b64_tr_b16 a[230:231], v10 offset:43008
    v_exp_f32 v30, v66
    v_exp_f32 v31, v67
    v_mfma_f32_32x32x16_bf16 a[160:175], a[232:235], v[72:75], a[160:175]
    v_add_f32 v21, v21, v30
    v_add_f32 v21, v21, v31
    v_cvt_pk_bf16_f32 v85, v30, v31
    v_exp_f32 v32, v68
    v_mfma_f32_32x32x16_bf16 v[40:55], a[216:219], v[192:195], v[40:55]
    v_exp_f32 v33, v69
    v_add_f32 v21, v21, v32
    v_add_f32 v21, v21, v33
    v_cvt_pk_bf16_f32 v86, v32, v33
    v_mfma_f32_32x32x16_bf16 v[40:55], a[220:223], v[196:199], v[40:55]
    ds_read_b64_tr_b16 a[232:233], v11 offset:40960
    ds_read_b64_tr_b16 a[234:235], v11 offset:43008
    v_exp_f32 v34, v70
    s_nop 0
    v_mfma_f32_32x32x16_bf16 a[176:191], a[236:239], v[72:75], a[176:191]
    v_exp_f32 v35, v71
    v_add_f32 v21, v21, v34
    v_add_f32 v21, v21, v35
    v_cvt_pk_bf16_f32 v87, v34, v35
    v_mfma_f32_32x32x16_bf16 a[128:143], a[240:243], v[76:79], a[128:143]
    v_cmp_lt_f32 vcc, s29, v21
    s_nop 0
    v_exp_f32 v28, v40
    v_mfma_f32_32x32x16_bf16 a[144:159], a[244:247], v[76:79], a[144:159]
    s_cbranch_vccnz L_tr23
L_bk23:
    ds_read_b64_tr_b16 a[236:237], v12 offset:40960
    ds_read_b64_tr_b16 a[238:239], v12 offset:43008
    v_exp_f32 v29, v41
    v_add_f32 v17, v17, v21
    v_mfma_f32_32x32x16_bf16 a[160:175], a[248:251], v[76:79], a[160:175]
    ds_read_b64_tr_b16 a[240:241], v9 offset:45056
    ds_read_b64_tr_b16 a[242:243], v9 offset:47104
    v_add_f32 v20, v28, v29
    v_cvt_pk_bf16_f32 v72, v28, v29
    v_mfma_f32_32x32x16_bf16 a[176:191], a[252:255], v[76:79], a[176:191]
    ds_read_b64_tr_b16 a[244:245], v10 offset:45056
    ds_read_b64_tr_b16 a[246:247], v10 offset:47104
    v_exp_f32 v30, v42
    v_mfma_f32_32x32x16_bf16 v[56:71], a[192:195], v[200:203], v[120:135]
    ds_read_b64_tr_b16 a[248:249], v11 offset:45056
    ds_read_b64_tr_b16 a[250:251], v11 offset:47104
    v_exp_f32 v31, v43
    v_add_f32 v20, v20, v30
    v_mfma_f32_32x32x16_bf16 v[56:71], a[196:199], v[204:207], v[56:71]
    s_waitcnt lgkmcnt(12)
    ds_read_b64_tr_b16 a[252:253], v12 offset:45056
    ds_read_b64_tr_b16 a[254:255], v12 offset:47104
    v_add_f32 v20, v20, v31
    v_cvt_pk_bf16_f32 v73, v30, v31
    v_mfma_f32_32x32x16_bf16 a[0:15], a[224:227], v[80:83], a[0:15]
    ds_read_b128 a[192:195], v1 offset:49152
    v_exp_f32 v32, v44
    v_exp_f32 v33, v45
    v_mfma_f32_32x32x16_bf16 v[56:71], a[200:203], v[208:211], v[56:71]
    ds_read_b128 a[196:199], v2 offset:49152
    v_add_f32 v20, v20, v32
    v_add_f32 v20, v20, v33
    v_cvt_pk_bf16_f32 v74, v32, v33
    v_mfma_f32_32x32x16_bf16 v[56:71], a[204:207], v[212:215], v[56:71]
    s_waitcnt lgkmcnt(14)
    v_exp_f32 v34, v46
    v_exp_f32 v35, v47
    v_add_f32 v20, v20, v34
    v_mfma_f32_32x32x16_bf16 a[16:31], a[228:231], v[80:83], a[16:31]
    ds_read_b128 a[200:203], v3 offset:49152
    v_add_f32 v20, v20, v35
    v_cvt_pk_bf16_f32 v75, v34, v35
    v_exp_f32 v28, v48
    v_mfma_f32_32x32x16_bf16 v[56:71], a[208:211], v[216:219], v[56:71]
    ds_read_b128 a[204:207], v4 offset:49152
    v_exp_f32 v29, v49
    v_add_f32 v20, v20, v28
    v_add_f32 v20, v20, v29
    v_mfma_f32_32x32x16_bf16 v[56:71], a[212:215], v[220:223], v[56:71]
    s_waitcnt lgkmcnt(14)
    v_cvt_pk_bf16_f32 v76, v28, v29
    v_exp_f32 v30, v50
    v_exp_f32 v31, v51
L_stub1_1:
    s_cbranch_scc1 L_walk_done
    v_mfma_f32_32x32x16_bf16 a[32:47], a[232:235], v[80:83], a[32:47]
    ds_read_b128 a[208:211], v5 offset:49152
    v_add_f32 v20, v20, v30
    v_add_f32 v20, v20, v31
    v_cvt_pk_bf16_f32 v77, v30, v31
    v_mfma_f32_32x32x16_bf16 v[56:71], a[216:219], v[224:227], v[56:71]
    ds_read_b128 a[212:215], v6 offset:49152
    v_exp_f32 v32, v52
    v_exp_f32 v33, v53
    v_mfma_f32_32x32x16_bf16 v[56:71], a[220:223], v[228:231], v[56:71]
    s_waitcnt lgkmcnt(14)
    v_add_f32 v20, v20, v32
    v_add_f32 v20, v20, v33
    v_cvt_pk_bf16_f32 v78, v32, v33
    v_exp_f32 v34, v54
    v_mfma_f32_32x32x16_bf16 a[48:63], a[236:239], v[80:83], a[48:63]
    s_waitcnt lgkmcnt(12)
    ds_read_b128 a[216:219], v7 offset:49152
    v_exp_f32 v35, v55
    v_add_f32 v20, v20, v34
    v_add_f32 v20, v20, v35
    v_mfma_f32_32x32x16_bf16 a[0:15], a[240:243], v[84:87], a[0:15]
    s_waitcnt lgkmcnt(11)
    ds_read_b128 a[220:223], v8 offset:49152
    v_cvt_pk_bf16_f32 v79, v34, v35
    v_cmp_lt_f32 vcc, s29, v20
    v_exp_f32 v28, v56
    v_mfma_f32_32x32x16_bf16 a[16:31], a[244:247], v[84:87], a[16:31]
    s_waitcnt lgkmcnt(10)
    s_cbranch_vccnz L_tr24
L_bk24:
    v_exp_f32 v29, v57
    v_exp_f32 v30, v58
    v_mfma_f32_32x32x16_bf16 a[32:47], a[248:251], v[84:87], a[32:47]
    s_waitcnt lgkmcnt(8)
    v_add_f32 v21, v28, v29
    v_cvt_pk_bf16_f32 v80, v28, v29
    v_exp_f32 v31, v59
    v_add_f32 v21, v21, v30
    v_mfma_f32_32x32x16_bf16 a[48:63], a[252:255], v[84:87], a[48:63]
    s_waitcnt lgkmcnt(7)
    v_add_f32 v21, v21, v31
    v_cvt_pk_bf16_f32 v81, v30, v31
    v_exp_f32 v32, v60
    v_add_f32 v18, v18, v20
    v_mfma_f32_32x32x16_bf16 v[40:55], a[192:195], v[136:139], v[88:103]
    s_waitcnt lgkmcnt(6)
    v_exp_f32 v33, v61
    v_add_f32 v21, v21, v32
    v_add_f32 v21, v21, v33
    v_cvt_pk_bf16_f32 v82, v32, v33
    v_mfma_f32_32x32x16_bf16 v[40:55], a[196:199], v[140:143], v[40:55]
    v_exp_f32 v34, v62
    v_exp_f32 v35, v63
    v_add_f32 v21, v21, v34
    v_mfma_f32_32x32x16_bf16 a[64:79], a[224:227], v[72:75], a[64:79]
    s_waitcnt lgkmcnt(5)
    v_add_f32 v21, v21, v35
    v_cvt_pk_bf16_f32 v83, v34, v35
    v_exp_f32 v28, v64
    v_mfma_f32_32x32x16_bf16 v[40:55], a[200:203], v[144:147], v[40:55]
    s_waitcnt lgkmcnt(4)
    v_exp_f32 v29, v65
    v_add_f32 v21, v21, v28
    v_add_f32 v21, v21, v29
    v_cvt_pk_bf16_f32 v84, v28, v29
    v_mfma_f32_32x32x16_bf16 v[40:55], a[204:207], v[148:151], v[40:55]
    v_exp_f32 v30, v66
    v_exp_f32 v31, v67
    v_add_f32 v21, v21, v30
    v_add_f32 v21, v21, v31
    v_mfma_f32_32x32x16_bf16 a[80:95], a[228:231], v[72:75], a[80:95]
    s_waitcnt lgkmcnt(3)
    v_cvt_pk_bf16_f32 v85, v30, v31
    v_exp_f32 v32, v68
    v_exp_f32 v33, v69
    v_add_f32 v21, v21, v32
    v_mfma_f32_32x32x16_bf16 v[40:55], a[208:211], v[152:155], v[40:55]
    s_waitcnt lgkmcnt(2)
    v_add_f32 v21, v21, v33
    v_cvt_pk_bf16_f32 v86, v32, v33
    v_exp_f32 v34, v70
    v_exp_f32 v35, v71
    v_mfma_f32_32x32x16_bf16 v[40:55], a[212:215], v[156:159], v[40:55]
    v_add_f32 v21, v21, v34
    v_add_f32 v21, v21, v35
    v_cvt_pk_bf16_f32 v87, v34, v35
    v_cmp_lt_f32 vcc, s29, v21
    v_mfma_f32_32x32x16_bf16 a[96:111], a[232:235], v[72:75], a[96:111]
    s_waitcnt lgkmcnt(1)
    s_cbranch_vccnz L_tr25
L_bk25:
    v_add_f32 v19, v19, v21
    v_mfma_f32_32x32x16_bf16 v[40:55], a[216:219], v[160:163], v[40:55]
    s_waitcnt lgkmcnt(0)
    v_mfma_f32_32x32x16_bf16 v[40:55], a[220:223], v[164:167], v[40:55]
    s_nop 5
    v_mfma_f32_32x32x16_bf16 a[112:127], a[236:239], v[72:75], a[112:127]
    s_nop 3
    v_mfma_f32_32x32x16_bf16 a[64:79], a[240:243], v[76:79], a[64:79]
    v_exp_f32 v28, v40
    v_exp_f32 v29, v41
    v_exp_f32 v30, v42
    v_mfma_f32_32x32x16_bf16 a[80:95], a[244:247], v[76:79], a[80:95]
    v_add_f32 v20, v28, v29
    v_cvt_pk_bf16_f32 v72, v28, v29
    v_exp_f32 v31, v43
    v_add_f32 v20, v20, v30
    v_add_f32 v20, v20, v31
    v_mfma_f32_32x32x16_bf16 a[96:111], a[248:251], v[76:79], a[96:111]
    v_cvt_pk_bf16_f32 v73, v30, v31
    v_exp_f32 v32, v44
    v_exp_f32 v33, v45
    v_add_f32 v20, v20, v32
    v_mfma_f32_32x32x16_bf16 a[112:127], a[252:255], v[76:79], a[112:127]
    v_add_f32 v20, v20, v33
    v_cvt_pk_bf16_f32 v74, v32, v33
    v_exp_f32 v34, v46
    v_exp_f32 v35, v47
    v_mfma_f32_32x32x16_bf16 v[56:71], a[192:195], v[168:171], v[104:119]
    v_add_f32 v20, v20, v34
    v_add_f32 v20, v20, v35
    v_cvt_pk_bf16_f32 v75, v34, v35
    v_exp_f32 v28, v48
    v_mfma_f32_32x32x16_bf16 v[56:71], a[196:199], v[172:175], v[56:71]
    s_waitcnt vmcnt(4)
    s_barrier
    s_add_u32 m0, s28, 106496
    v_add_f32 v20, v20, v28
    v_mfma_f32_32x32x16_bf16 a[128:143], a[224:227], v[80:83], a[128:143]
    buffer_load_dwordx4 v15, s[20:23], s58 offen offset:0 nt lds
    v_exp_f32 v29, v49
    v_mfma_f32_32x32x16_bf16 v[56:71], a[200:203], v[176:179], v[56:71]
    buffer_load_dwordx4 v15, s[20:23], s58 offen offset:1024 nt lds
    s_add_u32 m0, s28, 49152
    v_add_f32 v20, v20, v29
    v_mfma_f32_32x32x16_bf16 v[56:71], a[204:207], v[180:183], v[56:71]
    ds_read_b64_tr_b16 a[224:225], v9 offset:49152
    ds_read_b64_tr_b16 a[226:227], v9 offset:51200
    v_cvt_pk_bf16_f32 v76, v28, v29
    v_exp_f32 v30, v50
    v_mfma_f32_32x32x16_bf16 a[144:159], a[228:231], v[80:83], a[144:159]
    buffer_load_dwordx4 v13, s[16:19], s59 offen offset:0 nt lds
    v_exp_f32 v31, v51
    v_mfma_f32_32x32x16_bf16 v[56:71], a[208:211], v[184:187], v[56:71]
    buffer_load_dwordx4 v14, s[16:19], s59 offen offset:1024 nt lds
    v_add_f32 v20, v20, v30
    v_add_f32 v20, v20, v31
    v_mfma_f32_32x32x16_bf16 v[56:71], a[212:215], v[188:191], v[56:71]
    ds_read_b64_tr_b16 a[228:229], v10 offset:49152
    ds_read_b64_tr_b16 a[230:231], v10 offset:51200
    v_cvt_pk_bf16_f32 v77, v30, v31
    v_exp_f32 v32, v52
    v_mfma_f32_32x32x16_bf16 a[160:175], a[232:235], v[80:83], a[160:175]
    v_exp_f32 v33, v53
    v_add_f32 v20, v20, v32
    v_add_f32 v20, v20, v33
    v_cvt_pk_bf16_f32 v78, v32, v33
    v_mfma_f32_32x32x16_bf16 v[56:71], a[216:219], v[192:195], v[56:71]
    v_exp_f32 v34, v54
    v_exp_f32 v35, v55
    v_add_f32 v20, v20, v34
    v_add_f32 v20, v20, v35
    v_mfma_f32_32x32x16_bf16 v[56:71], a[220:223], v[196:199], v[56:71]
    ds_read_b64_tr_b16 a[232:233], v11 offset:49152
    ds_read_b64_tr_b16 a[234:235], v11 offset:51200
    v_cvt_pk_bf16_f32 v79, v34, v35
    v_cmp_lt_f32 vcc, s29, v20
    s_nop 1
    v_mfma_f32_32x32x16_bf16 a[176:191], a[236:239], v[80:83], a[176:191]
    s_cbranch_vccnz L_tr26
L_bk26:
    v_add_f32 v17, v17, v20
    s_nop 2
    v_exp_f32 v28, v56
    v_mfma_f32_32x32x16_bf16 a[128:143], a[240:243], v[84:87], a[128:143]
    v_exp_f32 v29, v57
    v_exp_f32 v30, v58
    v_add_f32 v21, v28, v29
    v_cvt_pk_bf16_f32 v80, v28, v29
    v_mfma_f32_32x32x16_bf16 a[144:159], a[244:247], v[84:87], a[144:159]
    ds_read_b64_tr_b16 a[236:237], v12 offset:49152
    ds_read_b64_tr_b16 a[238:239], v12 offset:51200
    v_exp_f32 v31, v59
    v_add_f32 v21, v21, v30
    v_add_f32 v21, v21, v31
    v_mfma_f32_32x32x16_bf16 a[160:175], a[248:251], v[84:87], a[160:175]
    ds_read_b64_tr_b16 a[240:241], v9 offset:53248
    ds_read_b64_tr_b16 a[242:243], v9 offset:55296
    v_cvt_pk_bf16_f32 v81, v30, v31
    v_exp_f32 v32, v60
    v_mfma_f32_32x32x16_bf16 a[176:191], a[252:255], v[84:87], a[176:191]
    ds_read_b64_tr_b16 a[244:245], v10 offset:53248
    ds_read_b64_tr_b16 a[246:247], v10 offset:55296
    v_exp_f32 v33, v61
    v_add_f32 v21, v21, v32
    v_add_f32 v21, v21, v33
    v_mfma_f32_32x32x16_bf16 v[40:55], a[192:195], v[200:203], v[120:135]
    ds_read_b64_tr_b16 a[248:249], v11 offset:53248
    ds_read_b64_tr_b16 a[250:251], v11 offset:55296
    v_cvt_pk_bf16_f32 v82, v32, v33
    v_exp_f32 v34, v62
    v_mfma_f32_32x32x16_bf16 v[40:55], a[196:199], v[204:207], v[40:55]
    s_waitcnt lgkmcnt(12)
    ds_read_b64_tr_b16 a[252:253], v12 offset:53248
    ds_read_b64_tr_b16 a[254:255], v12 offset:55296
    v_exp_f32 v35, v63
    v_add_f32 v21, v21, v34
    v_add_f32 v21, v21, v35
    v_mfma_f32_32x32x16_bf16 a[0:15], a[224:227], v[72:75], a[0:15]
    ds_read_b128 a[192:195], v1 offset:57344
    v_cvt_pk_bf16_f32 v83, v34, v35
    v_exp_f32 v28, v64
    v_exp_f32 v29, v65
    v_mfma_f32_32x32x16_bf16 v[40:55], a[200:203], v[208:211], v[40:55]
    ds_read_b128 a[196:199], v2 offset:57344
    v_add_f32 v21, v21, v28
    v_add_f32 v21, v21, v29
    v_cvt_pk_bf16_f32 v84, v28, v29
    v_exp_f32 v30, v66
    v_mfma_f32_32x32x16_bf16 v[40:55], a[204:207], v[212:215], v[40:55]
    s_waitcnt lgkmcnt(14)
    v_exp_f32 v31, v67
    v_add_f32 v21, v21, v30
    v_add_f32 v21, v21, v31
    v_cvt_pk_bf16_f32 v85, v30, v31
    v_mfma_f32_32x32x16_bf16 a[16:31], a[228:231], v[72:75], a[16:31]
    ds_read_b128 a[200:203], v3 offset:57344
    v_exp_f32 v32, v68
    v_exp_f32 v33, v69
    v_add_f32 v21, v21, v32
    v_mfma_f32_32x32x16_bf16 v[40:55], a[208:211], v[216:219], v[40:55]
    ds_read_b128 a[204:207], v4 offset:57344
    v_add_f32 v21, v21, v33
    v_cvt_pk_bf16_f32 v86, v32, v33
    v_exp_f32 v34, v70
    v_mfma_f32_32x32x16_bf16 v[40:55], a[212:215], v[220:223], v[40:55]
    s_waitcnt lgkmcnt(14)
    v_exp_f32 v35, v71
    v_add_f32 v21, v21, v34
    v_add_f32 v21, v21, v35
    v_cvt_pk_bf16_f32 v87, v34, v35
    v_cmp_lt_f32 vcc, s29, v21
    v_mfma_f32_32x32x16_bf16 a[32:47], a[232:235], v[72:75], a[32:47]
    s_cbranch_vccnz L_tr27
L_bk27:
    ds_read_b128 a[208:211], v5 offset:57344
    v_add_f32 v18, v18, v21
    v_mfma_f32_32x32x16_bf16 v[40:55], a[216:219], v[224:227], v[40:55]
    ds_read_b128 a[212:215], v6 offset:57344
    v_mfma_f32_32x32x16_bf16 v[40:55], a[220:223], v[228:231], v[40:55]
    s_waitcnt lgkmcnt(14)
    s_nop 5
    v_mfma_f32_32x32x16_bf16 a[48:63], a[236:239], v[72:75], a[48:63]
    s_waitcnt lgkmcnt(12)
    ds_read_b128 a[216:219], v7 offset:57344
    s_nop 1
    v_exp_f32 v28, v40
    v_mfma_f32_32x32x16_bf16 a[0:15], a[240:243], v[76:79], a[0:15]
    s_waitcnt lgkmcnt(11)
    ds_read_b128 a[220:223], v8 offset:57344
    v_exp_f32 v29, v41
    v_exp_f32 v30, v42
    v_add_f32 v20, v28, v29
    v_mfma_f32_32x32x16_bf16 a[16:31], a[244:247], v[76:79], a[16:31]
    s_waitcnt lgkmcnt(10)
    v_cvt_pk_bf16_f32 v72, v28, v29
    v_exp_f32 v31, v43
    v_add_f32 v20, v20, v30
    v_add_f32 v20, v20, v31
    v_cvt_pk_bf16_f32 v73, v30, v31
    v_mfma_f32_32x32x16_bf16 a[32:47], a[248:251], v[76:79], a[32:47]
    s_waitcnt lgkmcnt(8)
    v_exp_f32 v32, v44
    v_exp_f32 v33, v45
    v_add_f32 v20, v20, v32
    v_add_f32 v20, v20, v33
    v_mfma_f32_32x32x16_bf16 a[48:63], a[252:255], v[76:79], a[48:63]
    s_waitcnt lgkmcnt(7)
    v_cvt_pk_bf16_f32 v74, v32, v33
    v_exp_f32 v34, v46
    v_exp_f32 v35, v47
    v_add_f32 v20, v20, v34
    v_mfma_f32_32x32x16_bf16 v[56:71], a[192:195], v[136:139], v[88:103]
    s_waitcnt lgkmcnt(6)
    v_add_f32 v20, v20, v35
    v_cvt_pk_bf16_f32 v75, v34, v35
    v_exp_f32 v28, v48
    v_exp_f32 v29, v49
    v_mfma_f32_32x32x16_bf16 v[56:71], a[196:199], v[140:143], v[56:71]
    v_add_f32 v20, v20, v28
    v_add_f32 v20, v20, v29
    v_cvt_pk_bf16_f32 v76, v28, v29
    v_exp_f32 v30, v50
    v_mfma_f32_32x32x16_bf16 a[64:79], a[224:227], v[80:83], a[64:79]
    s_waitcnt lgkmcnt(5)
    v_exp_f32 v31, v51
    v_add_f32 v20, v20, v30
    v_add_f32 v20, v20, v31
    v_cvt_pk_bf16_f32 v77, v30, v31
    v_mfma_f32_32x32x16_bf16 v[56:71], a[200:203], v[144:147], v[56:71]
    s_waitcnt lgkmcnt(4)
    v_exp_f32 v32, v52
    v_exp_f32 v33, v53
    v_add_f32 v20, v20, v32
    v_add_f32 v20, v20, v33
    v_mfma_f32_32x32x16_bf16 v[56:71], a[204:207], v[148:151], v[56:71]
    v_cvt_pk_bf16_f32 v78, v32, v33
    v_exp_f32 v34, v54
    v_exp_f32 v35, v55
    v_add_f32 v20, v20, v34
    v_mfma_f32_32x32x16_bf16 a[80:95], a[228:231], v[80:83], a[80:95]
    s_waitcnt lgkmcnt(3)
    v_add_f32 v20, v20, v35
    v_cvt_pk_bf16_f32 v79, v34, v35
    v_cmp_lt_f32 vcc, s29, v20
    v_mfma_f32_32x32x16_bf16 v[56:71], a[208:211], v[152:155], v[56:71]
    s_waitcnt lgkmcnt(2)
    s_cbranch_vccnz L_tr28
L_bk28:
    v_add_f32 v19, v19, v20
    v_mfma_f32_32x32x16_bf16 v[56:71], a[212:215], v[156:159], v[56:71]
    v_mfma_f32_32x32x16_bf16 a[96:111], a[232:235], v[80:83], a[96:111]
    s_waitcnt lgkmcnt(1)
    v_mfma_f32_32x32x16_bf16 v[56:71], a[216:219], v[160:163], v[56:71]
    s_waitcnt lgkmcnt(0)
    v_mfma_f32_32x32x16_bf16 v[56:71], a[220:223], v[164:167], v[56:71]
    s_nop 5
    v_mfma_f32_32x32x16_bf16 a[112:127], a[236:239], v[80:83], a[112:127]
    s_nop 3
    v_mfma_f32_32x32x16_bf16 a[64:79], a[240:243], v[84:87], a[64:79]
    v_exp_f32 v28, v56
    v_exp_f32 v29, v57
    v_exp_f32 v30, v58
    v_mfma_f32_32x32x16_bf16 a[80:95], a[244:247], v[84:87], a[80:95]
    v_add_f32 v21, v28, v29
    v_cvt_pk_bf16_f32 v80, v28, v29
    v_exp_f32 v31, v59
    v_add_f32 v21, v21, v30
    v_add_f32 v21, v21, v31
    v_mfma_f32_32x32x16_bf16 a[96:111], a[248:251], v[84:87], a[96:111]
    v_cvt_pk_bf16_f32 v81, v30, v31
    v_exp_f32 v32, v60
    v_exp_f32 v33, v61
    v_add_f32 v21, v21, v32
    v_mfma_f32_32x32x16_bf16 a[112:127], a[252:255], v[84:87], a[112:127]
    v_add_f32 v21, v21, v33
    v_cvt_pk_bf16_f32 v82, v32, v33
    v_exp_f32 v34, v62
    v_exp_f32 v35, v63
    v_mfma_f32_32x32x16_bf16 v[40:55], a[192:195], v[168:171], v[104:119]
    v_add_f32 v21, v21, v34
    v_add_f32 v21, v21, v35
    v_cvt_pk_bf16_f32 v83, v34, v35
    v_exp_f32 v28, v64
    v_mfma_f32_32x32x16_bf16 v[40:55], a[196:199], v[172:175], v[40:55]
    s_waitcnt vmcnt(4)
    s_barrier
    s_add_u32 m0, s28, 114688
    v_add_f32 v21, v21, v28
    v_mfma_f32_32x32x16_bf16 a[128:143], a[224:227], v[72:75], a[128:143]
    buffer_load_dwordx4 v15, s[20:23], s59 offen offset:0 nt lds
    v_exp_f32 v29, v65
    v_mfma_f32_32x32x16_bf16 v[40:55], a[200:203], v[176:179], v[40:55]
    buffer_load_dwordx4 v15, s[20:23], s59 offen offset:1024 nt lds
    s_add_u32 m0, s28, 57344
    v_add_f32 v21, v21, v29
    v_mfma_f32_32x32x16_bf16 v[40:55], a[204:207], v[180:183], v[40:55]
    ds_read_b64_tr_b16 a[224:225], v9 offset:57344
    ds_read_b64_tr_b16 a[226:227], v9 offset:59392
    v_cvt_pk_bf16_f32 v84, v28, v29
    v_exp_f32 v30, v66
    v_mfma_f32_32x32x16_bf16 a[144:159], a[228:231], v[72:75], a[144:159]
    buffer_load_dwordx4 v13, s[16:19], s49 offen offset:0 nt lds
    v_exp_f32 v31, v67
    v_mfma_f32_32x32x16_bf16 v[40:55], a[208:211], v[184:187], v[40:55]
    buffer_load_dwordx4 v14, s[16:19], s49 offen offset:1024 nt lds
    v_add_f32 v21, v21, v30
    v_add_f32 v21, v21, v31
    v_mfma_f32_32x32x16_bf16 v[40:55], a[212:215], v[188:191], v[40:55]
    ds_read_b64_tr_b16 a[228:229], v10 offset:57344
    ds_read_b64_tr_b16 a[230:231], v10 offset:59392
    v_cvt_pk_bf16_f32 v85, v30, v31
    v_exp_f32 v32, v68
    v_mfma_f32_32x32x16_bf16 a[160:175], a[232:235], v[72:75], a[160:175]
    v_exp_f32 v33, v69
    v_add_f32 v21, v21, v32
    v_add_f32 v21, v21, v33
    v_cvt_pk_bf16_f32 v86, v32, v33
    v_mfma_f32_32x32x16_bf16 v[40:55], a[216:219], v[192:195], v[40:55]
    v_exp_f32 v34, v70
    v_exp_f32 v35, v71
    v_add_f32 v21, v21, v34
    v_add_f32 v21, v21, v35
    v_mfma_f32_32x32x16_bf16 v[40:55], a[220:223], v[196:199], v[40:55]
    ds_read_b64_tr_b16 a[232:233], v11 offset:57344
    ds_read_b64_tr_b16 a[234:235], v11 offset:59392
    v_cvt_pk_bf16_f32 v87, v34, v35
    v_cmp_lt_f32 vcc, s29, v21
    s_nop 1
    v_mfma_f32_32x32x16_bf16 a[176:191], a[236:239], v[72:75], a[176:191]
    s_cbranch_vccnz L_tr29
L_bk29:
    v_add_f32 v17, v17, v21
    s_nop 2
    v_exp_f32 v28, v40
    v_mfma_f32_32x32x16_bf16 a[128:143], a[240:243], v[76:79], a[128:143]
    v_exp_f32 v29, v41
    v_exp_f32 v30, v42
    v_add_f32 v20, v28, v29
    v_cvt_pk_bf16_f32 v72, v28, v29
    v_mfma_f32_32x32x16_bf16 a[144:159], a[244:247], v[76:79], a[144:159]
    ds_read_b64_tr_b16 a[236:237], v12 offset:57344
    ds_read_b64_tr_b16 a[238:239], v12 offset:59392
    v_exp_f32 v31, v43
    v_add_f32 v20, v20, v30
    v_add_f32 v20, v20, v31
    v_mfma_f32_32x32x16_bf16 a[160:175], a[248:251], v[76:79], a[160:175]
    ds_read_b64_tr_b16 a[240:241], v9 offset:61440
    ds_read_b64_tr_b16 a[242:243], v9 offset:63488
    v_cvt_pk_bf16_f32 v73, v30, v31
    v_exp_f32 v32, v44
    v_mfma_f32_32x32x16_bf16 a[176:191], a[252:255], v[76:79], a[176:191]
    ds_read_b64_tr_b16 a[244:245], v10 offset:61440
    ds_read_b64_tr_b16 a[246:247], v10 offset:63488
    v_exp_f32 v33, v45
    v_add_f32 v20, v20, v32
    v_add_f32 v20, v20, v33
    v_mfma_f32_32x32x16_bf16 v[56:71], a[192:195], v[200:203], v[120:135]
    ds_read_b64_tr_b16 a[248:249], v11 offset:61440
    ds_read_b64_tr_b16 a[250:251], v11 offset:63488
    v_cvt_pk_bf16_f32 v74, v32, v33
    v_exp_f32 v34, v46
    v_mfma_f32_32x32x16_bf16 v[56:71], a[196:199], v[204:207], v[56:71]
    s_waitcnt lgkmcnt(12)
    ds_read_b64_tr_b16 a[252:253], v12 offset:61440
    ds_read_b64_tr_b16 a[254:255], v12 offset:63488
    v_exp_f32 v35, v47
    v_add_f32 v20, v20, v34
    v_add_f32 v20, v20, v35
    v_mfma_f32_32x32x16_bf16 a[0:15], a[224:227], v[80:83], a[0:15]
    ds_read_b128 a[192:195], v1 offset:40960
    v_cvt_pk_bf16_f32 v75, v34, v35
    v_exp_f32 v28, v48
    v_exp_f32 v29, v49
    v_mfma_f32_32x32x16_bf16 v[56:71], a[200:203], v[208:211], v[56:71]
    ds_read_b128 a[196:199], v2 offset:40960
    v_add_f32 v20, v20, v28
    v_add_f32 v20, v20, v29
    v_cvt_pk_bf16_f32 v76, v28, v29
    v_exp_f32 v30, v50
    v_mfma_f32_32x32x16_bf16 v[56:71], a[204:207], v[212:215], v[56:71]
    s_waitcnt lgkmcnt(14)
    v_exp_f32 v31, v51
    v_add_f32 v20, v20, v30
    v_add_f32 v20, v20, v31
    v_cvt_pk_bf16_f32 v77, v30, v31
    v_mfma_f32_32x32x16_bf16 a[16:31], a[228:231], v[80:83], a[16:31]
    ds_read_b128 a[200:203], v3 offset:40960
    v_exp_f32 v32, v52
    v_exp_f32 v33, v53
    v_add_f32 v20, v20, v32
    v_mfma_f32_32x32x16_bf16 v[56:71], a[208:211], v[216:219], v[56:71]
    ds_read_b128 a[204:207], v4 offset:40960
    v_add_f32 v20, v20, v33
    v_cvt_pk_bf16_f32 v78, v32, v33
    v_exp_f32 v34, v54
    v_mfma_f32_32x32x16_bf16 v[56:71], a[212:215], v[220:223], v[56:71]
    s_waitcnt lgkmcnt(14)
    v_exp_f32 v35, v55
    v_add_f32 v20, v20, v34
    v_add_f32 v20, v20, v35
    v_cvt_pk_bf16_f32 v79, v34, v35
    v_cmp_lt_f32 vcc, s29, v20
    v_mfma_f32_32x32x16_bf16 a[32:47], a[232:235], v[80:83], a[32:47]
    s_cbranch_vccnz L_tr30
L_bk30:
    ds_read_b128 a[208:211], v5 offset:40960
    v_add_f32 v18, v18, v20
    v_mfma_f32_32x32x16_bf16 v[56:71], a[216:219], v[224:227], v[56:71]
    ds_read_b128 a[212:215], v6 offset:40960
    v_mfma_f32_32x32x16_bf16 v[56:71], a[220:223], v[228:231], v[56:71]
    s_waitcnt lgkmcnt(14)
    s_nop 5
    v_mfma_f32_32x32x16_bf16 a[48:63], a[236:239], v[80:83], a[48:63]
    s_waitcnt lgkmcnt(12)
    ds_read_b128 a[216:219], v7 offset:40960
    s_nop 1
    v_exp_f32 v28, v56
    v_mfma_f32_32x32x16_bf16 a[0:15], a[240:243], v[84:87], a[0:15]
    s_waitcnt lgkmcnt(11)
    ds_read_b128 a[220:223], v8 offset:40960
    v_exp_f32 v29, v57
    v_exp_f32 v30, v58
    v_add_f32 v21, v28, v29
    v_mfma_f32_32x32x16_bf16 a[16:31], a[244:247], v[84:87], a[16:31]
    s_waitcnt lgkmcnt(10)
    v_cvt_pk_bf16_f32 v80, v28, v29
    v_exp_f32 v31, v59
    v_add_f32 v21, v21, v30
    v_add_f32 v21, v21, v31
    v_cvt_pk_bf16_f32 v81, v30, v31
    v_mfma_f32_32x32x16_bf16 a[32:47], a[248:251], v[84:87], a[32:47]
    s_waitcnt lgkmcnt(8)
    v_exp_f32 v32, v60
    v_exp_f32 v33, v61
    v_add_f32 v21, v21, v32
    v_add_f32 v21, v21, v33
    v_mfma_f32_32x32x16_bf16 a[48:63], a[252:255], v[84:87], a[48:63]
    s_waitcnt lgkmcnt(7)
    v_cvt_pk_bf16_f32 v82, v32, v33
    v_exp_f32 v34, v62
    v_exp_f32 v35, v63
    v_add_f32 v21, v21, v34
    v_mfma_f32_32x32x16_bf16 v[40:55], a[192:195], v[136:139], v[88:103]
    s_waitcnt lgkmcnt(6)
    v_add_f32 v21, v21, v35
    v_cvt_pk_bf16_f32 v83, v34, v35
    v_exp_f32 v28, v64
    v_exp_f32 v29, v65
    v_mfma_f32_32x32x16_bf16 v[40:55], a[196:199], v[140:143], v[40:55]
    s_waitcnt lgkmcnt(0)
    s_barrier
    s_add_u32 m0, s28, 40960
    v_add_f32 v21, v21, v28
    v_mfma_f32_32x32x16_bf16 a[64:79], a[224:227], v[72:75], a[64:79]
    buffer_load_dwordx4 v13, s[16:19], s50 offen offset:0 nt lds
    v_add_f32 v21, v21, v29
    v_cvt_pk_bf16_f32 v84, v28, v29
    v_mfma_f32_32x32x16_bf16 v[40:55], a[200:203], v[144:147], v[40:55]
    buffer_load_dwordx4 v14, s[16:19], s50 offen offset:1024 nt lds
    v_exp_f32 v30, v66
    v_mfma_f32_32x32x16_bf16 v[40:55], a[204:207], v[148:151], v[40:55]
    v_exp_f32 v31, v67
    v_add_f32 v21, v21, v30
    v_add_f32 v21, v21, v31
    v_cvt_pk_bf16_f32 v85, v30, v31
    v_mfma_f32_32x32x16_bf16 a[80:95], a[228:231], v[72:75], a[80:95]
    v_exp_f32 v32, v68
    v_exp_f32 v33, v69
    v_add_f32 v21, v21, v32
    v_add_f32 v21, v21, v33
    v_mfma_f32_32x32x16_bf16 v[40:55], a[208:211], v[152:155], v[40:55]
    v_cvt_pk_bf16_f32 v86, v32, v33
    v_exp_f32 v34, v70
    v_exp_f32 v35, v71
    v_add_f32 v21, v21, v34
    v_mfma_f32_32x32x16_bf16 v[40:55], a[212:215], v[156:159], v[40:55]
    v_add_f32 v21, v21, v35
    v_cvt_pk_bf16_f32 v87, v34, v35
    v_cmp_lt_f32 vcc, s29, v21
    v_mfma_f32_32x32x16_bf16 a[96:111], a[232:235], v[72:75], a[96:111]
    s_cbranch_vccnz L_tr31
L_bk31:
    v_add_f32 v19, v19, v21
    v_mfma_f32_32x32x16_bf16 v[40:55], a[216:219], v[160:163], v[40:55]
    v_mfma_f32_32x32x16_bf16 v[40:55], a[220:223], v[164:167], v[40:55]
    s_nop 5
    v_mfma_f32_32x32x16_bf16 a[112:127], a[236:239], v[72:75], a[112:127]
    s_nop 3
    v_mfma_f32_32x32x16_bf16 a[64:79], a[240:243], v[76:79], a[64:79]
    v_exp_f32 v28, v40
    v_exp_f32 v29, v41
    v_exp_f32 v30, v42
    v_mfma_f32_32x32x16_bf16 a[80:95], a[244:247], v[76:79], a[80:95]
    v_add_f32 v20, v28, v29
    v_cvt_pk_bf16_f32 v72, v28, v29
    v_exp_f32 v31, v43
    v_add_f32 v20, v20, v30
    v_add_f32 v20, v20, v31
    v_mfma_f32_32x32x16_bf16 a[96:111], a[248:251], v[76:79], a[96:111]
    v_cvt_pk_bf16_f32 v73, v30, v31
    v_exp_f32 v32, v44
    v_exp_f32 v33, v45
    v_add_f32 v20, v20, v32
    v_mfma_f32_32x32x16_bf16 a[112:127], a[252:255], v[76:79], a[112:127]
    v_add_f32 v20, v20, v33
    v_cvt_pk_bf16_f32 v74, v32, v33
    v_exp_f32 v34, v46
    v_exp_f32 v35, v47
    v_mfma_f32_32x32x16_bf16 v[56:71], a[192:195], v[168:171], v[104:119]
    v_add_f32 v20, v20, v34
    v_add_f32 v20, v20, v35
    v_cvt_pk_bf16_f32 v75, v34, v35
    v_exp_f32 v28, v48
    v_mfma_f32_32x32x16_bf16 v[56:71], a[196:199], v[172:175], v[56:71]
    s_waitcnt vmcnt(6)
    s_barrier
    v_exp_f32 v29, v49
    v_mfma_f32_32x32x16_bf16 a[128:143], a[224:227], v[80:83], a[128:143]
    v_add_f32 v20, v20, v28
    v_add_f32 v20, v20, v29
    v_cvt_pk_bf16_f32 v76, v28, v29
    v_exp_f32 v30, v50
    v_mfma_f32_32x32x16_bf16 v[56:71], a[200:203], v[176:179], v[56:71]
    v_exp_f32 v31, v51
    v_add_f32 v20, v20, v30
    v_add_f32 v20, v20, v31
    v_cvt_pk_bf16_f32 v77, v30, v31
    v_mfma_f32_32x32x16_bf16 v[56:71], a[204:207], v[180:183], v[56:71]
    ds_read_b64_tr_b16 a[224:225], v9 offset:40960
    ds_read_b64_tr_b16 a[226:227], v9 offset:43008
    v_exp_f32 v32, v52
    v_exp_f32 v33, v53
    v_mfma_f32_32x32x16_bf16 a[144:159], a[228:231], v[80:83], a[144:159]
    v_add_f32 v20, v20, v32
    v_add_f32 v20, v20, v33
    v_cvt_pk_bf16_f32 v78, v32, v33
    v_exp_f32 v34, v54
    v_mfma_f32_32x32x16_bf16 v[56:71], a[208:211], v[184:187], v[56:71]
    v_exp_f32 v35, v55
    v_add_f32 v20, v20, v34
    v_add_f32 v20, v20, v35
    v_cvt_pk_bf16_f32 v79, v34, v35
    v_cmp_lt_f32 vcc, s29, v20
    v_mfma_f32_32x32x16_bf16 v[56:71], a[212:215], v[188:191], v[56:71]
    s_cbranch_vccnz L_tr32
L_bk32:
    ds_read_b64_tr_b16 a[228:229], v10 offset:40960
    ds_read_b64_tr_b16 a[230:231], v10 offset:43008
    v_add_f32 v17, v17, v20
    v_mfma_f32_32x32x16_bf16 a[160:175], a[232:235], v[80:83], a[160:175]
    v_mfma_f32_32x32x16_bf16 v[56:71], a[216:219], v[192:195], v[56:71]
    v_mfma_f32_32x32x16_bf16 v[56:71], a[220:223], v[196:199], v[56:71]
    ds_read_b64_tr_b16 a[232:233], v11 offset:40960
    ds_read_b64_tr_b16 a[234:235], v11 offset:43008
    s_nop 3
    v_mfma_f32_32x32x16_bf16 a[176:191], a[236:239], v[80:83], a[176:191]
    s_nop 3
    v_mfma_f32_32x32x16_bf16 a[128:143], a[240:243], v[84:87], a[128:143]
    v_exp_f32 v28, v56
    v_exp_f32 v29, v57
    v_exp_f32 v30, v58
    v_mfma_f32_32x32x16_bf16 a[144:159], a[244:247], v[84:87], a[144:159]
    ds_read_b64_tr_b16 a[236:237], v12 offset:40960
    ds_read_b64_tr_b16 a[238:239], v12 offset:43008
    v_add_f32 v21, v28, v29
    v_cvt_pk_bf16_f32 v80, v28, v29
    v_exp_f32 v31, v59
    v_mfma_f32_32x32x16_bf16 a[160:175], a[248:251], v[84:87], a[160:175]
    ds_read_b64_tr_b16 a[240:241], v9 offset:45056
    ds_read_b64_tr_b16 a[242:243], v9 offset:47104
    v_add_f32 v21, v21, v30
    v_add_f32 v21, v21, v31
    v_cvt_pk_bf16_f32 v81, v30, v31
    v_mfma_f32_32x32x16_bf16 a[176:191], a[252:255], v[84:87], a[176:191]
    ds_read_b64_tr_b16 a[244:245], v10 offset:45056
    ds_read_b64_tr_b16 a[246:247], v10 offset:47104
    v_exp_f32 v32, v60
    v_exp_f32 v33, v61
    v_mfma_f32_32x32x16_bf16 v[40:55], a[192:195], v[200:203], v[120:135]
    ds_read_b64_tr_b16 a[248:249], v11 offset:45056
    ds_read_b64_tr_b16 a[250:251], v11 offset:47104
    v_add_f32 v21, v21, v32
    v_add_f32 v21, v21, v33
    v_cvt_pk_bf16_f32 v82, v32, v33
    v_mfma_f32_32x32x16_bf16 v[40:55], a[196:199], v[204:207], v[40:55]
    s_waitcnt lgkmcnt(12)
    ds_read_b64_tr_b16 a[252:253], v12 offset:45056
    ds_read_b64_tr_b16 a[254:255], v12 offset:47104
    v_exp_f32 v34, v62
    v_exp_f32 v35, v63
    v_mfma_f32_32x32x16_bf16 a[0:15], a[224:227], v[72:75], a[0:15]
    ds_read_b128 a[192:195], v1 offset:49152
    v_add_f32 v21, v21, v34
    v_add_f32 v21, v21, v35
    v_cvt_pk_bf16_f32 v83, v34, v35
    v_exp_f32 v28, v64
    v_mfma_f32_32x32x16_bf16 v[40:55], a[200:203], v[208:211], v[40:55]
    ds_read_b128 a[196:199], v2 offset:49152
    v_exp_f32 v29, v65
    v_add_f32 v21, v21, v28
    v_add_f32 v21, v21, v29
    v_cvt_pk_bf16_f32 v84, v28, v29
    v_mfma_f32_32x32x16_bf16 v[40:55], a[204:207], v[212:215], v[40:55]
    s_waitcnt lgkmcnt(14)
    v_exp_f32 v30, v66
    v_exp_f32 v31, v67
    v_add_f32 v21, v21, v30
    v_add_f32 v21, v21, v31
    v_mfma_f32_32x32x16_bf16 a[16:31], a[228:231], v[72:75], a[16:31]
    ds_read_b128 a[200:203], v3 offset:49152
    v_cvt_pk_bf16_f32 v85, v30, v31
    v_exp_f32 v32, v68
    v_exp_f32 v33, v69
    v_mfma_f32_32x32x16_bf16 v[40:55], a[208:211], v[216:219], v[40:55]
    ds_read_b128 a[204:207], v4 offset:49152
    v_add_f32 v21, v21, v32
    v_add_f32 v21, v21, v33
    v_cvt_pk_bf16_f32 v86, v32, v33
    v_exp_f32 v34, v70
    v_mfma_f32_32x32x16_bf16 v[40:55], a[212:215], v[220:223], v[40:55]
    s_waitcnt lgkmcnt(14)
    v_exp_f32 v35, v71
    v_add_f32 v21, v21, v34
    v_add_f32 v21, v21, v35
    v_cvt_pk_bf16_f32 v87, v34, v35
    v_cmp_lt_f32 vcc, s29, v21
    v_mfma_f32_32x32x16_bf16 a[32:47], a[232:235], v[72:75], a[32:47]
    s_cbranch_vccnz L_tr33
L_bk33:
    ds_read_b128 a[208:211], v5 offset:49152
    v_add_f32 v18, v18, v21
    v_mfma_f32_32x32x16_bf16 v[40:55], a[216:219], v[224:227], v[40:55]
    ds_read_b128 a[212:215], v6 offset:49152
    v_mfma_f32_32x32x16_bf16 v[40:55], a[220:223], v[228:231], v[40:55]
    s_waitcnt lgkmcnt(14)
    s_nop 5
    v_mfma_f32_32x32x16_bf16 a[48:63], a[236:239], v[72:75], a[48:63]
    s_waitcnt lgkmcnt(12)
    ds_read_b128 a[216:219], v7 offset:49152
    s_nop 1
    v_exp_f32 v28, v40
    v_mfma_f32_32x32x16_bf16 a[0:15], a[240:243], v[76:79], a[0:15]
    s_waitcnt lgkmcnt(11)
    ds_read_b128 a[220:223], v8 offset:49152
    v_exp_f32 v29, v41
    v_exp_f32 v30, v42
L_stub2_0:
    s_cbranch_scc1 L_stub2_1
    v_add_f32 v20, v28, v29
    v_mfma_f32_32x32x16_bf16 a[16:31], a[244:247], v[76:79], a[16:31]
    s_waitcnt lgkmcnt(10)
    v_cvt_pk_bf16_f32 v72, v28, v29
    v_exp_f32 v31, v43
    v_add_f32 v20, v20, v30
    v_add_f32 v20, v20, v31
    v_cvt_pk_bf16_f32 v73, v30, v31
    v_mfma_f32_32x32x16_bf16 a[32:47], a[248:251], v[76:79], a[32:47]
    s_waitcnt lgkmcnt(8)
    v_exp_f32 v32, v44
    v_exp_f32 v33, v45
    v_add_f32 v20, v20, v32
    v_add_f32 v20, v20, v33
    v_mfma_f32_32x32x16_bf16 a[48:63], a[252:255], v[76:79], a[48:63]
    s_waitcnt lgkmcnt(7)
    v_cvt_pk_bf16_f32 v74, v32, v33
    v_exp_f32 v34, v46
    v_exp_f32 v35, v47
    v_add_f32 v20, v20, v34
    v_mfma_f32_32x32x16_bf16 v[56:71], a[192:195], v[136:139], v[88:103]
    s_waitcnt lgkmcnt(6)
    v_add_f32 v20, v20, v35
    v_cvt_pk_bf16_f32 v75, v34, v35
    v_exp_f32 v28, v48
    v_exp_f32 v29, v49
    v_mfma_f32_32x32x16_bf16 v[56:71], a[196:199], v[140:143], v[56:71]
    s_waitcnt lgkmcnt(0)
    s_barrier
    s_add_u32 m0, s28, 49152
    v_add_f32 v20, v20, v28
    v_mfma_f32_32x32x16_bf16 a[64:79], a[224:227], v[80:83], a[64:79]
    buffer_load_dwordx4 v13, s[16:19], s51 offen offset:0 nt lds
    v_add_f32 v20, v20, v29
    v_cvt_pk_bf16_f32 v76, v28, v29
    v_mfma_f32_32x32x16_bf16 v[56:71], a[200:203], v[144:147], v[56:71]
    buffer_load_dwordx4 v14, s[16:19], s51 offen offset:1024 nt lds
    s_add_u32 m0, s28, 122880
    v_mfma_f32_32x32x16_bf16 v[56:71], a[204:207], v[148:151], v[56:71]
    buffer_load_dwordx4 v15, s[20:23], s49 offen offset:0 nt lds
    v_exp_f32 v30, v50
    v_mfma_f32_32x32x16_bf16 a[80:95], a[228:231], v[80:83], a[80:95]
    buffer_load_dwordx4 v15, s[20:23], s49 offen offset:1024 nt lds
    s_add_u32 m0, s28, 106496
    v_add_f32 v20, v20, v30
    v_mfma_f32_32x32x16_bf16 v[56:71], a[208:211], v[152:155], v[56:71]
    buffer_load_dwordx4 v15, s[20:23], s50 offen offset:0 nt lds
    v_exp_f32 v31, v51
    v_mfma_f32_32x32x16_bf16 v[56:71], a[212:215], v[156:159], v[56:71]
    buffer_load_dwordx4 v15, s[20:23], s50 offen offset:1024 nt lds
    v_add_f32 v20, v20, v31
    v_cvt_pk_bf16_f32 v77, v30, v31
    v_mfma_f32_32x32x16_bf16 a[96:111], a[232:235], v[80:83], a[96:111]
    v_exp_f32 v32, v52
    v_exp_f32 v33, v53
    v_add_f32 v20, v20, v32
    v_add_f32 v20, v20, v33
    v_mfma_f32_32x32x16_bf16 v[56:71], a[216:219], v[160:163], v[56:71]
    v_cvt_pk_bf16_f32 v78, v32, v33
    v_exp_f32 v34, v54
    v_exp_f32 v35, v55
    v_add_f32 v20, v20, v34
    v_mfma_f32_32x32x16_bf16 v[56:71], a[220:223], v[164:167], v[56:71]
    v_add_f32 v20, v20, v35
    v_cvt_pk_bf16_f32 v79, v34, v35
    v_cmp_lt_f32 vcc, s29, v20
    s_nop 2
    v_mfma_f32_32x32x16_bf16 a[112:127], a[236:239], v[80:83], a[112:127]
    s_cbranch_vccnz L_tr34
L_bk34:
    v_add_f32 v19, v19, v20
    s_nop 2
    v_exp_f32 v28, v56
    v_mfma_f32_32x32x16_bf16 a[64:79], a[240:243], v[84:87], a[64:79]
    v_exp_f32 v29, v57
    v_exp_f32 v30, v58
    v_add_f32 v21, v28, v29
    v_cvt_pk_bf16_f32 v80, v28, v29
    v_mfma_f32_32x32x16_bf16 a[80:95], a[244:247], v[84:87], a[80:95]
    v_exp_f32 v31, v59
    v_add_f32 v21, v21, v30
    v_add_f32 v21, v21, v31
    v_cvt_pk_bf16_f32 v81, v30, v31
    v_mfma_f32_32x32x16_bf16 a[96:111], a[248:251], v[84:87], a[96:111]
    v_exp_f32 v32, v60
    v_exp_f32 v33, v61
    v_add_f32 v21, v21, v32
    v_add_f32 v21, v21, v33
    v_mfma_f32_32x32x16_bf16 a[112:127], a[252:255], v[84:87], a[112:127]
    v_cvt_pk_bf16_f32 v82, v32, v33
    v_exp_f32 v34, v62
    v_exp_f32 v35, v63
    v_add_f32 v21, v21, v34
    v_mfma_f32_32x32x16_bf16 v[40:55], a[192:195], v[168:171], v[104:119]
    v_add_f32 v21, v21, v35
    v_cvt_pk_bf16_f32 v83, v34, v35
    v_exp_f32 v28, v64
    v_exp_f32 v29, v65
    v_mfma_f32_32x32x16_bf16 v[40:55], a[196:199], v[172:175], v[40:55]
    s_waitcnt vmcnt(10)
    s_barrier
    v_add_f32 v21, v21, v28
    v_add_f32 v21, v21, v29
    v_mfma_f32_32x32x16_bf16 a[128:143], a[224:227], v[72:75], a[128:143]
    v_cvt_pk_bf16_f32 v84, v28, v29
    v_exp_f32 v30, v66
    v_exp_f32 v31, v67
    v_add_f32 v21, v21, v30
    v_mfma_f32_32x32x16_bf16 v[40:55], a[200:203], v[176:179], v[40:55]
    v_add_f32 v21, v21, v31
    v_cvt_pk_bf16_f32 v85, v30, v31
    v_exp_f32 v32, v68
    v_exp_f32 v33, v69
    v_mfma_f32_32x32x16_bf16 v[40:55], a[204:207], v[180:183], v[40:55]
    ds_read_b64_tr_b16 a[224:225], v9 offset:49152
    ds_read_b64_tr_b16 a[226:227], v9 offset:51200
    v_add_f32 v21, v21, v32
    v_add_f32 v21, v21, v33
    v_cvt_pk_bf16_f32 v86, v32, v33
    v_mfma_f32_32x32x16_bf16 a[144:159], a[228:231], v[72:75], a[144:159]
    v_exp_f32 v34, v70
    v_exp_f32 v35, v71
    v_add_f32 v21, v21, v34
    v_add_f32 v21, v21, v35
    v_mfma_f32_32x32x16_bf16 v[40:55], a[208:211], v[184:187], v[40:55]
    v_cvt_pk_bf16_f32 v87, v34, v35
    v_cmp_lt_f32 vcc, s29, v21
    v_mfma_f32_32x32x16_bf16 v[40:55], a[212:215], v[188:191], v[40:55]
    s_cbranch_vccnz L_tr35
L_bk35:
    v_add_f32 v17, v17, v21
    v_mov_b32 v238, v17
    s_nop 1
    v_permlane32_swap_b32 v17, v238
    v_mfma_f32_32x32x16_bf16 a[160:175], a[232:235], v[72:75], a[160:175]
    v_add_f32 v238, v17, v238
    v_rcp_f32 v236, v238
    v_mfma_f32_32x32x16_bf16 v[40:55], a[216:219], v[192:195], v[40:55]
    v_mfma_f32_32x32x16_bf16 v[40:55], a[220:223], v[196:199], v[40:55]
    ds_read_b64_tr_b16 a[228:229], v10 offset:49152
    ds_read_b64_tr_b16 a[230:231], v10 offset:51200
    s_nop 3
    v_mfma_f32_32x32x16_bf16 a[176:191], a[236:239], v[72:75], a[176:191]
    s_nop 3
    v_mfma_f32_32x32x16_bf16 a[128:143], a[240:243], v[76:79], a[128:143]
    ds_read_b64_tr_b16 a[240:241], v9 offset:53248
    ds_read_b64_tr_b16 a[242:243], v9 offset:55296
    v_exp_f32 v28, v40
    v_exp_f32 v29, v41
    v_mfma_f32_32x32x16_bf16 a[144:159], a[244:247], v[76:79], a[144:159]
    ds_read_b64_tr_b16 a[244:245], v10 offset:53248
    ds_read_b64_tr_b16 a[246:247], v10 offset:55296
    v_add_f32 v20, v28, v29
    v_cvt_pk_bf16_f32 v72, v28, v29
    v_exp_f32 v30, v42
    v_mfma_f32_32x32x16_bf16 a[160:175], a[248:251], v[76:79], a[160:175]
    ds_read_b64_tr_b16 a[232:233], v11 offset:49152
    ds_read_b64_tr_b16 a[234:235], v11 offset:51200
    v_exp_f32 v31, v43
    v_add_f32 v20, v20, v30
    v_add_f32 v20, v20, v31
    v_mfma_f32_32x32x16_bf16 a[176:191], a[252:255], v[76:79], a[176:191]
    ds_read_b64_tr_b16 a[248:249], v11 offset:53248
    ds_read_b64_tr_b16 a[250:251], v11 offset:55296
    v_cvt_pk_bf16_f32 v73, v30, v31
    v_exp_f32 v32, v44
    v_mfma_f32_32x32x16_bf16 v[56:71], a[192:195], v[200:203], v[120:135]
    ds_read_b64_tr_b16 a[236:237], v12 offset:49152
    ds_read_b64_tr_b16 a[238:239], v12 offset:51200
    v_exp_f32 v33, v45
    v_add_f32 v20, v20, v32
    v_add_f32 v20, v20, v33
    v_mfma_f32_32x32x16_bf16 v[56:71], a[196:199], v[204:207], v[56:71]
    s_waitcnt lgkmcnt(12)
    ds_read_b64_tr_b16 a[252:253], v12 offset:53248
    ds_read_b64_tr_b16 a[254:255], v12 offset:55296
    s_waitcnt lgkmcnt(0)
    s_barrier
    s_add_u32 m0, s28, 114688
    s_nop 0
    buffer_load_dwordx4 v15, s[20:23], s51 offen offset:0 nt lds
    buffer_load_dwordx4 v15, s[20:23], s51 offen offset:1024 nt lds
    v_mfma_f32_32x32x16_bf16 a[0:15], a[224:227], v[80:83], a[0:15]
    ds_read_b128 a[192:195], v1 offset:0
    v_cvt_pk_bf16_f32 v74, v32, v33
    v_exp_f32 v34, v46
    v_exp_f32 v35, v47
    v_mfma_f32_32x32x16_bf16 v[56:71], a[200:203], v[208:211], v[56:71]
    ds_read_b128 a[196:199], v2 offset:0
    v_add_f32 v20, v20, v34
    v_add_f32 v20, v20, v35
    v_cvt_pk_bf16_f32 v75, v34, v35
    v_exp_f32 v28, v48
    v_mfma_f32_32x32x16_bf16 v[56:71], a[204:207], v[212:215], v[56:71]
    v_exp_f32 v29, v49
    v_add_f32 v20, v20, v28
    v_add_f32 v20, v20, v29
    v_cvt_pk_bf16_f32 v76, v28, v29
    v_mfma_f32_32x32x16_bf16 a[0:15], a[240:243], v[84:87], a[0:15]
    ds_read_b128 a[200:203], v3 offset:0
    v_exp_f32 v30, v50
    v_exp_f32 v31, v51
    v_add_f32 v20, v20, v30
    v_mfma_f32_32x32x16_bf16 v[56:71], a[208:211], v[216:219], v[56:71]
    ds_read_b128 a[204:207], v4 offset:0
    v_add_f32 v20, v20, v31
    v_cvt_pk_bf16_f32 v77, v30, v31
    v_exp_f32 v32, v52
    s_nop 0
    v_mfma_f32_32x32x16_bf16 v[56:71], a[212:215], v[220:223], v[56:71]
    v_exp_f32 v33, v53
    v_add_f32 v20, v20, v32
    v_add_f32 v20, v20, v33
    v_cvt_pk_bf16_f32 v78, v32, v33
    v_accvgpr_read_b32 v136, a0
    v_mfma_f32_32x32x16_bf16 a[16:31], a[228:231], v[80:83], a[16:31]
    ds_read_b128 a[208:211], v5 offset:0
    v_exp_f32 v34, v54
    v_exp_f32 v35, v55
    v_add_f32 v20, v20, v34
    v_mfma_f32_32x32x16_bf16 v[56:71], a[216:219], v[224:227], v[56:71]
    ds_read_b128 a[212:215], v6 offset:0
    v_add_f32 v20, v20, v35
    v_cvt_pk_bf16_f32 v79, v34, v35
    v_cmp_lt_f32 vcc, s29, v20
    v_accvgpr_read_b32 v137, a1
    v_accvgpr_read_b32 v138, a2
    v_mfma_f32_32x32x16_bf16 v[56:71], a[220:223], v[228:231], v[56:71]
    s_cbranch_vccnz L_tr36
L_bk36:
    v_accvgpr_read_b32 v139, a3
    v_accvgpr_read_b32 v140, a4
    v_accvgpr_read_b32 v141, a5
    v_accvgpr_read_b32 v142, a6
    v_accvgpr_read_b32 v143, a7
    v_mul_f32 v136, v236, v136
    v_mfma_f32_32x32x16_bf16 a[16:31], a[244:247], v[84:87], a[16:31]
    ds_read_b128 a[216:219], v7 offset:0
    v_mul_f32 v137, v236, v137
    v_mul_f32 v138, v236, v138
    v_mul_f32 v139, v236, v139
    v_mul_f32 v140, v236, v140
    v_mul_f32 v141, v236, v141
    v_mfma_f32_32x32x16_bf16 a[32:47], a[232:235], v[80:83], a[32:47]
    ds_read_b128 a[220:223], v8 offset:0
    v_mul_f32 v142, v236, v142
    v_mul_f32 v143, v236, v143
    v_cvt_pk_bf16_f32 v152, v136, v137
    v_cvt_pk_bf16_f32 v153, v138, v139
    v_cvt_pk_bf16_f32 v154, v140, v141
    v_mfma_f32_32x32x16_bf16 a[32:47], a[248:251], v[84:87], a[32:47]
    v_cvt_pk_bf16_f32 v155, v142, v143
    v_accvgpr_read_b32 v144, a8
    v_accvgpr_read_b32 v145, a9
    v_accvgpr_read_b32 v146, a10
    v_accvgpr_read_b32 v147, a11
    v_accvgpr_read_b32 v148, a12
    v_mfma_f32_32x32x16_bf16 a[48:63], a[236:239], v[80:83], a[48:63]
    ds_write_b128 v232, v[152:155] offset:0
    v_accvgpr_read_b32 v149, a13
    v_mfma_f32_32x32x16_bf16 a[48:63], a[252:255], v[84:87], a[48:63]
    s_waitcnt lgkmcnt(8)
    v_accvgpr_read_b32 v150, a14
    v_accvgpr_read_b32 v151, a15
    v_mul_f32 v144, v236, v144
    v_mul_f32 v145, v236, v145
    v_mul_f32 v146, v236, v146
    v_mul_f32 v147, v236, v147
    v_mfma_f32_32x32x16_bf16 v[40:55], a[192:195], v[168:171], v[104:119]
    s_waitcnt lgkmcnt(7)
    v_mul_f32 v148, v236, v148
    v_mul_f32 v149, v236, v149
    v_mul_f32 v150, v236, v150
    v_mul_f32 v151, v236, v151
    v_cvt_pk_bf16_f32 v156, v144, v145
    v_cvt_pk_bf16_f32 v157, v146, v147
    v_mfma_f32_32x32x16_bf16 v[40:55], a[196:199], v[172:175], v[40:55]
    v_cvt_pk_bf16_f32 v158, v148, v149
    v_cvt_pk_bf16_f32 v159, v150, v151
    v_accvgpr_read_b32 v136, a16
    v_exp_f32 v28, v56
    v_accvgpr_read_b32 v137, a17
    v_mfma_f32_32x32x16_bf16 a[64:79], a[224:227], v[72:75], a[64:79]
    s_waitcnt lgkmcnt(6)
    ds_write_b128 v233, v[156:159] offset:0
    v_accvgpr_read_b32 v138, a18
    v_mfma_f32_32x32x16_bf16 v[40:55], a[200:203], v[176:179], v[40:55]
    s_waitcnt lgkmcnt(6)
    v_exp_f32 v29, v57
    v_exp_f32 v30, v58
    v_add_f32 v21, v28, v29
    v_cvt_pk_bf16_f32 v80, v28, v29
    v_mfma_f32_32x32x16_bf16 v[40:55], a[204:207], v[180:183], v[40:55]
    v_exp_f32 v31, v59
    v_add_f32 v21, v21, v30
    v_add_f32 v21, v21, v31
    v_cvt_pk_bf16_f32 v81, v30, v31
    v_accvgpr_read_b32 v139, a19
    v_mfma_f32_32x32x16_bf16 a[80:95], a[228:231], v[72:75], a[80:95]
    s_waitcnt lgkmcnt(5)
    v_exp_f32 v32, v60
    v_exp_f32 v33, v61
    v_add_f32 v21, v21, v32
    v_add_f32 v21, v21, v33
    v_mfma_f32_32x32x16_bf16 v[40:55], a[208:211], v[184:187], v[40:55]
    s_waitcnt lgkmcnt(4)
    v_cvt_pk_bf16_f32 v82, v32, v33
    v_exp_f32 v34, v62
    v_exp_f32 v35, v63
    v_add_f32 v21, v21, v34
    v_mfma_f32_32x32x16_bf16 v[40:55], a[212:215], v[188:191], v[40:55]
    v_add_f32 v21, v21, v35
    v_cvt_pk_bf16_f32 v83, v34, v35
    v_exp_f32 v28, v64
    v_exp_f32 v29, v65
    v_mfma_f32_32x32x16_bf16 a[96:111], a[232:235], v[72:75], a[96:111]
    s_waitcnt lgkmcnt(3)
    v_add_f32 v21, v21, v28
    v_add_f32 v21, v21, v29
    v_cvt_pk_bf16_f32 v84, v28, v29
    v_exp_f32 v30, v66
    v_accvgpr_read_b32 v140, a20
    v_mfma_f32_32x32x16_bf16 v[40:55], a[216:219], v[192:195], v[40:55]
    s_waitcnt lgkmcnt(2)
    v_exp_f32 v31, v67
    v_add_f32 v21, v21, v30
    v_add_f32 v21, v21, v31
    v_cvt_pk_bf16_f32 v85, v30, v31
    v_accvgpr_read_b32 v141, a21
    v_mfma_f32_32x32x16_bf16 v[40:55], a[220:223], v[196:199], v[40:55]
    v_exp_f32 v32, v68
    v_exp_f32 v33, v69
    v_add_f32 v21, v21, v32
    v_add_f32 v21, v21, v33
    v_mfma_f32_32x32x16_bf16 a[112:127], a[236:239], v[72:75], a[112:127]
    v_cvt_pk_bf16_f32 v86, v32, v33
    v_exp_f32 v34, v70
    v_exp_f32 v35, v71
    v_add_f32 v21, v21, v34
    v_mfma_f32_32x32x16_bf16 a[64:79], a[240:243], v[76:79], a[64:79]
    v_add_f32 v21, v21, v35
    v_cvt_pk_bf16_f32 v87, v34, v35
    v_cmp_lt_f32 vcc, s29, v21
    v_accvgpr_read_b32 v142, a22
    v_accvgpr_read_b32 v143, a23
    v_mul_f32 v136, v236, v136
    v_mfma_f32_32x32x16_bf16 a[80:95], a[244:247], v[76:79], a[80:95]
    s_cbranch_vccnz L_tr37
L_bk37:
    v_mul_f32 v137, v236, v137
    v_mul_f32 v138, v236, v138
    v_mul_f32 v139, v236, v139
    v_mul_f32 v140, v236, v140
    v_mul_f32 v141, v236, v141
    v_mul_f32 v142, v236, v142
    v_mfma_f32_32x32x16_bf16 a[96:111], a[248:251], v[76:79], a[96:111]
    v_mul_f32 v143, v236, v143
    v_cvt_pk_bf16_f32 v160, v136, v137
    v_cvt_pk_bf16_f32 v161, v138, v139
    v_cvt_pk_bf16_f32 v162, v140, v141
    v_cvt_pk_bf16_f32 v163, v142, v143
    v_accvgpr_read_b32 v144, a24
    v_mfma_f32_32x32x16_bf16 a[112:127], a[252:255], v[76:79], a[112:127]
    ds_write_b128 v234, v[160:163] offset:0
    v_accvgpr_read_b32 v145, a25
    v_mfma_f32_32x32x16_bf16 v[56:71], a[192:195], v[200:203], v[120:135]
    v_accvgpr_read_b32 v146, a26
    v_accvgpr_read_b32 v147, a27
    v_accvgpr_read_b32 v148, a28
    v_accvgpr_read_b32 v149, a29
    v_accvgpr_read_b32 v150, a30
    v_accvgpr_read_b32 v151, a31
    v_mfma_f32_32x32x16_bf16 v[56:71], a[196:199], v[204:207], v[56:71]
    v_mul_f32 v144, v236, v144
    v_mul_f32 v145, v236, v145
    v_mul_f32 v146, v236, v146
    v_mul_f32 v147, v236, v147
    v_mul_f32 v148, v236, v148
    v_mul_f32 v149, v236, v149
    v_mfma_f32_32x32x16_bf16 a[128:143], a[224:227], v[80:83], a[128:143]
    ds_read_b128 a[192:195], v1 offset:8192
    v_mul_f32 v150, v236, v150
    v_mul_f32 v151, v236, v151
    v_cvt_pk_bf16_f32 v164, v144, v145
    v_cvt_pk_bf16_f32 v165, v146, v147
    v_cvt_pk_bf16_f32 v166, v148, v149
    v_mfma_f32_32x32x16_bf16 v[56:71], a[200:203], v[208:211], v[56:71]
    ds_read_b128 a[196:199], v2 offset:8192
    v_cvt_pk_bf16_f32 v167, v150, v151
    v_accvgpr_read_b32 v136, a32
    v_accvgpr_read_b32 v137, a33
    v_add_f32 v18, v18, v20
    v_accvgpr_read_b32 v138, a34
    v_mfma_f32_32x32x16_bf16 v[56:71], a[204:207], v[212:215], v[56:71]
    ds_write_b128 v235, v[164:167] offset:0
    v_accvgpr_read_b32 v139, a35
    v_mfma_f32_32x32x16_bf16 a[144:159], a[228:231], v[80:83], a[144:159]
    ds_read_b128 v[88:91], v16 offset:0
    ds_read_b128 v[92:95], v16 offset:1024
    v_exp_f32 v28, v40
    v_exp_f32 v29, v41
    v_mfma_f32_32x32x16_bf16 v[56:71], a[208:211], v[216:219], v[56:71]
    ds_read_b128 v[96:99], v16 offset:2048
    ds_read_b128 v[100:103], v16 offset:3072
    v_add_f32 v20, v28, v29
    v_cvt_pk_bf16_f32 v72, v28, v29
    v_exp_f32 v30, v42
    v_mfma_f32_32x32x16_bf16 v[56:71], a[212:215], v[220:223], v[56:71]
    ds_read_b64_tr_b16 a[224:225], v9 offset:0
    ds_read_b64_tr_b16 a[226:227], v9 offset:2048
    v_exp_f32 v31, v43
    v_add_f32 v20, v20, v30
    v_add_f32 v20, v20, v31
    v_mfma_f32_32x32x16_bf16 a[160:175], a[232:235], v[80:83], a[160:175]
    ds_read_b128 a[200:203], v3 offset:8192
    ds_read_b128 a[204:207], v4 offset:8192
    v_cvt_pk_bf16_f32 v73, v30, v31
    v_exp_f32 v32, v44
    v_accvgpr_read_b32 v140, a36
    v_mfma_f32_32x32x16_bf16 v[56:71], a[216:219], v[224:227], v[56:71]
    ds_read_b64_tr_b16 a[228:229], v10 offset:0
    ds_read_b64_tr_b16 a[230:231], v10 offset:2048
    v_exp_f32 v33, v45
    v_add_f32 v20, v20, v32
    v_add_f32 v20, v20, v33
    v_mfma_f32_32x32x16_bf16 v[56:71], a[220:223], v[228:231], v[56:71]
    ds_read_b128 a[208:211], v5 offset:8192
    ds_read_b128 a[212:215], v6 offset:8192
    v_cvt_pk_bf16_f32 v74, v32, v33
    v_exp_f32 v34, v46
    v_accvgpr_read_b32 v141, a37
    v_mfma_f32_32x32x16_bf16 a[176:191], a[236:239], v[80:83], a[176:191]
    s_waitcnt vmcnt(0)
    s_barrier
    v_exp_f32 v35, v47
    v_mfma_f32_32x32x16_bf16 a[128:143], a[240:243], v[84:87], a[128:143]
    s_waitcnt lgkmcnt(11)
    buffer_store_dwordx4 v[88:91], v240, s[24:27], s36 offen offset:0 nt
    v_add_f32 v20, v20, v34
    v_mfma_f32_32x32x16_bf16 a[144:159], a[244:247], v[84:87], a[144:159]
    ds_read_b64_tr_b16 a[232:233], v11 offset:0
    ds_read_b64_tr_b16 a[234:235], v11 offset:2048
    v_add_f32 v20, v20, v35
    v_cvt_pk_bf16_f32 v75, v34, v35
    v_exp_f32 v28, v48
    v_mfma_f32_32x32x16_bf16 a[160:175], a[248:251], v[84:87], a[160:175]
    v_exp_f32 v29, v49
    v_add_f32 v20, v20, v28
    v_add_f32 v20, v20, v29
    v_cvt_pk_bf16_f32 v76, v28, v29
    v_exp_f32 v30, v50
    v_exp_f32 v31, v51
    v_add_f32 v20, v20, v30
    v_add_f32 v20, v20, v31
    v_cvt_pk_bf16_f32 v77, v30, v31
    v_exp_f32 v32, v52
    v_exp_f32 v33, v53
    v_add_f32 v20, v20, v32
    v_add_f32 v20, v20, v33
    v_cvt_pk_bf16_f32 v78, v32, v33
    v_exp_f32 v34, v54
    v_exp_f32 v35, v55
    v_add_f32 v20, v20, v34
    v_add_f32 v20, v20, v35
    v_cvt_pk_bf16_f32 v79, v34, v35
    v_cmp_lt_f32 vcc, s29, v20
    v_mfma_f32_32x32x16_bf16 a[176:191], a[252:255], v[84:87], a[176:191]
    s_waitcnt lgkmcnt(12)
    buffer_store_dwordx4 v[92:95], v241, s[24:27], s36 offen offset:1024 nt
    s_cbranch_vccnz L_tr38
L_bk38:
    v_mfma_f32_32x32x16_bf16 v[40:55], a[192:195], v[168:171], v[104:119]
    ds_read_b128 a[216:219], v7 offset:8192
    ds_read_b128 a[220:223], v8 offset:8192
    v_accvgpr_read_b32 v142, a38
    v_accvgpr_read_b32 v143, a39
    v_mul_f32 v136, v236, v136
    v_mul_f32 v137, v236, v137
    v_mfma_f32_32x32x16_bf16 v[40:55], a[196:199], v[172:175], v[40:55]
    s_waitcnt lgkmcnt(10)
    ds_read_b64_tr_b16 a[236:237], v12 offset:0
    ds_read_b64_tr_b16 a[238:239], v12 offset:2048
    v_mul_f32 v138, v236, v138
    v_mul_f32 v139, v236, v139
    v_mul_f32 v140, v236, v140
    v_mul_f32 v141, v236, v141
    v_mfma_f32_32x32x16_bf16 a[64:79], a[224:227], v[72:75], a[64:79]
    s_waitcnt lgkmcnt(11)
    buffer_store_dwordx4 v[96:99], v242, s[24:27], s36 offen offset:2048 nt
    v_mul_f32 v142, v236, v142
    v_mul_f32 v143, v236, v143
    v_mfma_f32_32x32x16_bf16 v[40:55], a[200:203], v[176:179], v[40:55]
    s_waitcnt lgkmcnt(10)
    ds_read_b64_tr_b16 a[240:241], v9 offset:4096
    ds_read_b64_tr_b16 a[242:243], v9 offset:6144
    v_cvt_pk_bf16_f32 v152, v136, v137
    v_cvt_pk_bf16_f32 v153, v138, v139
    v_cvt_pk_bf16_f32 v154, v140, v141
    v_cvt_pk_bf16_f32 v155, v142, v143
    v_mfma_f32_32x32x16_bf16 v[40:55], a[204:207], v[180:183], v[40:55]
    s_waitcnt lgkmcnt(10)
    ds_write_b128 v232, v[152:155] offset:4096
    v_accvgpr_read_b32 v144, a40
    v_mfma_f32_32x32x16_bf16 a[80:95], a[228:231], v[72:75], a[80:95]
    s_waitcnt lgkmcnt(10)
    buffer_store_dwordx4 v[100:103], v243, s[24:27], s36 offen offset:3072 nt
    v_accvgpr_read_b32 v145, a41
    v_accvgpr_read_b32 v146, a42
    v_mfma_f32_32x32x16_bf16 v[40:55], a[208:211], v[184:187], v[40:55]
    s_waitcnt lgkmcnt(9)
    ds_read_b64_tr_b16 a[244:245], v10 offset:4096
    ds_read_b64_tr_b16 a[246:247], v10 offset:6144
    v_accvgpr_read_b32 v147, a43
    v_accvgpr_read_b32 v148, a44
    v_accvgpr_read_b32 v149, a45
    v_accvgpr_read_b32 v150, a46
    v_mfma_f32_32x32x16_bf16 v[40:55], a[212:215], v[188:191], v[40:55]
    s_waitcnt lgkmcnt(9)
    ds_read_b64_tr_b16 a[248:249], v11 offset:4096
    ds_read_b64_tr_b16 a[250:251], v11 offset:6144
    v_accvgpr_read_b32 v151, a47
    v_mul_f32 v144, v236, v144
    v_mul_f32 v145, v236, v145
    v_mul_f32 v146, v236, v146
    v_mfma_f32_32x32x16_bf16 a[96:111], a[232:235], v[72:75], a[96:111]
    s_waitcnt lgkmcnt(10)
    ds_read_b64_tr_b16 a[252:253], v12 offset:4096
    ds_read_b64_tr_b16 a[254:255], v12 offset:6144
    v_mul_f32 v147, v236, v147
    v_mul_f32 v148, v236, v148
    v_mul_f32 v149, v236, v149
    v_mul_f32 v150, v236, v150
    v_mfma_f32_32x32x16_bf16 v[40:55], a[216:219], v[192:195], v[40:55]
    s_waitcnt lgkmcnt(11)
    v_mul_f32 v151, v236, v151
    v_cvt_pk_bf16_f32 v156, v144, v145
    v_cvt_pk_bf16_f32 v157, v146, v147
    v_cvt_pk_bf16_f32 v158, v148, v149
    v_cvt_pk_bf16_f32 v159, v150, v151
    v_accvgpr_read_b32 v136, a48
    v_mfma_f32_32x32x16_bf16 v[40:55], a[220:223], v[196:199], v[40:55]
    s_waitcnt lgkmcnt(9)
    ds_write_b128 v233, v[156:159] offset:4096
    v_accvgpr_read_b32 v137, a49
    v_mfma_f32_32x32x16_bf16 a[112:127], a[236:239], v[72:75], a[112:127]
    s_waitcnt lgkmcnt(8)
    v_accvgpr_read_b32 v138, a50
    v_accvgpr_read_b32 v139, a51
    v_accvgpr_read_b32 v140, a52
    v_accvgpr_read_b32 v141, a53
    v_accvgpr_read_b32 v142, a54
    v_accvgpr_read_b32 v143, a55
    v_mfma_f32_32x32x16_bf16 a[64:79], a[240:243], v[76:79], a[64:79]
    s_waitcnt lgkmcnt(5)
    v_mul_f32 v136, v236, v136
    v_mul_f32 v137, v236, v137
    v_add_f32 v19, v19, v21
    v_exp_f32 v28, v56
    v_mul_f32 v138, v236, v138
    v_mfma_f32_32x32x16_bf16 a[80:95], a[244:247], v[76:79], a[80:95]
    s_waitcnt lgkmcnt(3)
    v_exp_f32 v29, v57
    v_exp_f32 v30, v58
    v_add_f32 v21, v28, v29
    v_cvt_pk_bf16_f32 v80, v28, v29
    v_mfma_f32_32x32x16_bf16 a[96:111], a[248:251], v[76:79], a[96:111]
    s_waitcnt lgkmcnt(1)
    v_exp_f32 v31, v59
    v_add_f32 v21, v21, v30
    v_add_f32 v21, v21, v31
    v_cvt_pk_bf16_f32 v81, v30, v31
    v_exp_f32 v32, v60
    v_exp_f32 v33, v61
    v_add_f32 v21, v21, v32
    v_add_f32 v21, v21, v33
    v_cvt_pk_bf16_f32 v82, v32, v33
    v_exp_f32 v34, v62
    v_exp_f32 v35, v63
    v_add_f32 v21, v21, v34
    v_add_f32 v21, v21, v35
    v_cvt_pk_bf16_f32 v83, v34, v35
    v_exp_f32 v28, v64
    v_exp_f32 v29, v65
    v_add_f32 v21, v21, v28
    v_add_f32 v21, v21, v29
    v_cvt_pk_bf16_f32 v84, v28, v29
    v_exp_f32 v30, v66
    v_exp_f32 v31, v67
    v_add_f32 v21, v21, v30
    v_add_f32 v21, v21, v31
    v_cvt_pk_bf16_f32 v85, v30, v31
    v_exp_f32 v32, v68
    v_exp_f32 v33, v69
    v_add_f32 v21, v21, v32
    v_add_f32 v21, v21, v33
    v_cvt_pk_bf16_f32 v86, v32, v33
    v_exp_f32 v34, v70
    v_exp_f32 v35, v71
    v_add_f32 v21, v21, v34
    v_add_f32 v21, v21, v35
    v_cvt_pk_bf16_f32 v87, v34, v35
    v_cmp_lt_f32 vcc, s29, v21
    v_mfma_f32_32x32x16_bf16 a[112:127], a[252:255], v[76:79], a[112:127]
    s_cbranch_vccnz L_tr39
L_bk39:
    v_mul_f32 v139, v236, v139
    v_mul_f32 v140, v236, v140
    v_mul_f32 v141, v236, v141
    v_mul_f32 v142, v236, v142
    v_mul_f32 v143, v236, v143
    v_cvt_pk_bf16_f32 v160, v136, v137
    v_mfma_f32_32x32x16_bf16 v[56:71], a[192:195], v[200:203], v[120:135]
    v_cvt_pk_bf16_f32 v161, v138, v139
    v_cvt_pk_bf16_f32 v162, v140, v141
    v_cvt_pk_bf16_f32 v163, v142, v143
    v_accvgpr_read_b32 v144, a56
    v_accvgpr_read_b32 v145, a57
    v_accvgpr_read_b32 v146, a58
    v_mfma_f32_32x32x16_bf16 v[56:71], a[196:199], v[204:207], v[56:71]
    ds_write_b128 v234, v[160:163] offset:4096
    v_accvgpr_read_b32 v147, a59
    v_mfma_f32_32x32x16_bf16 a[128:143], a[224:227], v[80:83], a[128:143]
    ds_read_b128 a[192:195], v1 offset:16384
    v_accvgpr_read_b32 v148, a60
    v_accvgpr_read_b32 v149, a61
    v_accvgpr_read_b32 v150, a62
    v_accvgpr_read_b32 v151, a63
    v_mul_f32 v144, v236, v144
    v_mfma_f32_32x32x16_bf16 v[56:71], a[200:203], v[208:211], v[56:71]
    ds_read_b128 a[196:199], v2 offset:16384
    v_mul_f32 v145, v236, v145
    v_mul_f32 v146, v236, v146
    v_mul_f32 v147, v236, v147
    v_mul_f32 v148, v236, v148
    v_mul_f32 v149, v236, v149
    v_mfma_f32_32x32x16_bf16 v[56:71], a[204:207], v[212:215], v[56:71]
    ds_read_b64_tr_b16 a[224:225], v9 offset:8192
    ds_read_b64_tr_b16 a[226:227], v9 offset:10240
    v_mul_f32 v150, v236, v150
    v_mul_f32 v151, v236, v151
    v_cvt_pk_bf16_f32 v164, v144, v145
    v_cvt_pk_bf16_f32 v165, v146, v147
    v_mfma_f32_32x32x16_bf16 a[144:159], a[228:231], v[80:83], a[144:159]
    ds_read_b128 a[200:203], v3 offset:16384
    v_cvt_pk_bf16_f32 v166, v148, v149
    v_cvt_pk_bf16_f32 v167, v150, v151
    v_add_f32 v18, v18, v20
    v_exp_f32 v28, v40
    v_mfma_f32_32x32x16_bf16 v[56:71], a[208:211], v[216:219], v[56:71]
    ds_write_b128 v235, v[164:167] offset:4096
    ds_read_b128 v[136:139], v16 offset:4096
    v_mfma_f32_32x32x16_bf16 v[56:71], a[212:215], v[220:223], v[56:71]
    ds_read_b128 v[140:143], v16 offset:5120
    ds_read_b128 v[144:147], v16 offset:6144
    ds_read_b128 v[148:151], v16 offset:7168
    v_exp_f32 v29, v41
    v_add_f32 v19, v19, v21
    v_mfma_f32_32x32x16_bf16 a[160:175], a[232:235], v[80:83], a[160:175]
    ds_read_b128 a[204:207], v4 offset:16384
    ds_read_b128 a[208:211], v5 offset:16384
    v_add_f32 v20, v28, v29
    v_cvt_pk_bf16_f32 v72, v28, v29
    v_exp_f32 v30, v42
    v_mfma_f32_32x32x16_bf16 v[56:71], a[216:219], v[224:227], v[56:71]
    ds_read_b128 a[212:215], v6 offset:16384
    v_exp_f32 v31, v43
    v_add_f32 v20, v20, v30
    v_add_f32 v20, v20, v31
    v_cvt_pk_bf16_f32 v73, v30, v31
    v_mfma_f32_32x32x16_bf16 v[56:71], a[220:223], v[228:231], v[56:71]
    s_waitcnt lgkmcnt(6)
    buffer_store_dwordx4 v[136:139], v240, s[24:27], s37 offen offset:0 nt
    v_mfma_f32_32x32x16_bf16 a[176:191], a[236:239], v[80:83], a[176:191]
    ds_read_b64_tr_b16 a[228:229], v10 offset:8192
    ds_read_b64_tr_b16 a[230:231], v10 offset:10240
    v_exp_f32 v32, v44
    v_exp_f32 v33, v45
    v_mfma_f32_32x32x16_bf16 a[128:143], a[240:243], v[84:87], a[128:143]
    ds_read_b64_tr_b16 a[240:241], v9 offset:12288
L_stub2_1:
    s_cbranch_scc1 L_walk_done
    ds_read_b64_tr_b16 a[242:243], v9 offset:14336
    v_add_f32 v20, v20, v32
    v_add_f32 v20, v20, v33
    v_cvt_pk_bf16_f32 v74, v32, v33
    v_mfma_f32_32x32x16_bf16 a[144:159], a[244:247], v[84:87], a[144:159]
    s_waitcnt lgkmcnt(9)
    buffer_store_dwordx4 v[140:143], v241, s[24:27], s37 offen offset:1024 nt
    v_mfma_f32_32x32x16_bf16 a[160:175], a[248:251], v[84:87], a[160:175]
    v_exp_f32 v34, v46
    v_exp_f32 v35, v47
    v_add_f32 v20, v20, v34
    v_add_f32 v20, v20, v35
    v_cvt_pk_bf16_f32 v75, v34, v35
    v_exp_f32 v28, v48
    v_exp_f32 v29, v49
    v_add_f32 v20, v20, v28
    v_add_f32 v20, v20, v29
    v_cvt_pk_bf16_f32 v76, v28, v29
    v_exp_f32 v30, v50
    v_exp_f32 v31, v51
    v_add_f32 v20, v20, v30
    v_add_f32 v20, v20, v31
    v_cvt_pk_bf16_f32 v77, v30, v31
    v_exp_f32 v32, v52
    v_exp_f32 v33, v53
    v_add_f32 v20, v20, v32
    v_add_f32 v20, v20, v33
    v_cvt_pk_bf16_f32 v78, v32, v33
    v_exp_f32 v34, v54
    v_exp_f32 v35, v55
    v_add_f32 v20, v20, v34
    v_add_f32 v20, v20, v35
    v_cvt_pk_bf16_f32 v79, v34, v35
    v_cmp_lt_f32 vcc, s29, v20
    v_mfma_f32_32x32x16_bf16 a[176:191], a[252:255], v[84:87], a[176:191]
    s_cbranch_vccnz L_tr40
L_bk40:
    ds_read_b128 a[216:219], v7 offset:16384
    ds_read_b128 a[220:223], v8 offset:16384
    v_exp_f32 v28, v56
    v_exp_f32 v29, v57
    v_mfma_f32_32x32x16_bf16 v[40:55], a[192:195], v[200:203], v[120:135]
    s_waitcnt lgkmcnt(10)
    buffer_store_dwordx4 v[144:147], v242, s[24:27], s37 offen offset:2048 nt
    v_add_f32 v21, v28, v29
    v_mfma_f32_32x32x16_bf16 v[40:55], a[196:199], v[204:207], v[40:55]
    ds_read_b64_tr_b16 a[244:245], v10 offset:12288
    ds_read_b64_tr_b16 a[246:247], v10 offset:14336
    v_cvt_pk_bf16_f32 v80, v28, v29
    v_exp_f32 v30, v58
    v_add_f32 v18, v18, v20
    v_mfma_f32_32x32x16_bf16 a[64:79], a[224:227], v[72:75], a[64:79]
    ds_read_b64_tr_b16 a[232:233], v11 offset:8192
    ds_read_b64_tr_b16 a[234:235], v11 offset:10240
    v_exp_f32 v31, v59
    v_add_f32 v21, v21, v30
    v_add_f32 v21, v21, v31
    v_mfma_f32_32x32x16_bf16 v[40:55], a[200:203], v[208:211], v[40:55]
    s_waitcnt lgkmcnt(12)
    buffer_store_dwordx4 v[148:151], v243, s[24:27], s37 offen offset:3072 nt
    v_cvt_pk_bf16_f32 v81, v30, v31
    v_mov_b32 v250, v18
    v_mfma_f32_32x32x16_bf16 v[40:55], a[204:207], v[212:215], v[40:55]
    s_waitcnt lgkmcnt(6)
    ds_read_b64_tr_b16 a[248:249], v11 offset:12288
    ds_read_b64_tr_b16 a[250:251], v11 offset:14336
    v_exp_f32 v32, v60
    v_exp_f32 v33, v61
    v_mfma_f32_32x32x16_bf16 a[64:79], a[240:243], v[76:79], a[64:79]
    ds_read_b64_tr_b16 a[236:237], v12 offset:8192
    ds_read_b64_tr_b16 a[238:239], v12 offset:10240
    v_add_f32 v21, v21, v32
    v_add_f32 v21, v21, v33
    v_cvt_pk_bf16_f32 v82, v32, v33
    s_nop 0
    v_mfma_f32_32x32x16_bf16 v[40:55], a[208:211], v[216:219], v[40:55]
    ds_read_b64_tr_b16 a[252:253], v12 offset:12288
    ds_read_b64_tr_b16 a[254:255], v12 offset:14336
    v_exp_f32 v34, v62
    v_exp_f32 v35, v63
    v_mfma_f32_32x32x16_bf16 v[40:55], a[212:215], v[220:223], v[40:55]
    ds_read_b128 a[192:195], v1 offset:24576
    ds_read_b128 a[196:199], v2 offset:24576
    v_add_f32 v21, v21, v34
    v_add_f32 v21, v21, v35
    v_cvt_pk_bf16_f32 v83, v34, v35
    v_accvgpr_read_b32 v168, a64
    v_mfma_f32_32x32x16_bf16 a[80:95], a[228:231], v[72:75], a[80:95]
    s_waitcnt lgkmcnt(13)
    ds_read_b128 a[200:203], v3 offset:24576
    ds_read_b128 a[204:207], v4 offset:24576
    v_exp_f32 v28, v64
    v_exp_f32 v29, v65
    v_mfma_f32_32x32x16_bf16 v[40:55], a[216:219], v[224:227], v[40:55]
    s_waitcnt lgkmcnt(14)
    ds_read_b128 a[208:211], v5 offset:24576
    ds_read_b128 a[212:215], v6 offset:24576
    v_add_f32 v21, v21, v28
    v_add_f32 v21, v21, v29
    v_cvt_pk_bf16_f32 v84, v28, v29
    v_accvgpr_read_b32 v169, a65
    v_mfma_f32_32x32x16_bf16 v[40:55], a[220:223], v[228:231], v[40:55]
    s_waitcnt lgkmcnt(14)
    v_exp_f32 v30, v66
    v_exp_f32 v31, v67
    v_add_f32 v21, v21, v30
    v_add_f32 v21, v21, v31
    v_mfma_f32_32x32x16_bf16 a[80:95], a[244:247], v[76:79], a[80:95]
    s_waitcnt lgkmcnt(12)
    ds_read_b128 a[216:219], v7 offset:24576
    v_cvt_pk_bf16_f32 v85, v30, v31
    v_exp_f32 v32, v68
    v_exp_f32 v33, v69
    v_mfma_f32_32x32x16_bf16 a[96:111], a[232:235], v[72:75], a[96:111]
    s_waitcnt lgkmcnt(11)
    ds_read_b128 a[220:223], v8 offset:24576
    v_add_f32 v21, v21, v32
    v_add_f32 v21, v21, v33
    v_cvt_pk_bf16_f32 v86, v32, v33
    v_exp_f32 v34, v70
    v_mfma_f32_32x32x16_bf16 a[96:111], a[248:251], v[76:79], a[96:111]
    s_waitcnt lgkmcnt(10)
    v_exp_f32 v35, v71
    v_add_f32 v21, v21, v34
    v_add_f32 v21, v21, v35
    v_cvt_pk_bf16_f32 v87, v34, v35
    v_cmp_lt_f32 vcc, s29, v21
    v_mfma_f32_32x32x16_bf16 a[112:127], a[236:239], v[72:75], a[112:127]
    s_waitcnt lgkmcnt(8)
    s_cbranch_vccnz L_tr41
L_bk41:
    v_permlane32_swap_b32 v18, v250
    v_add_f32 v250, v18, v250
    v_rcp_f32 v248, v250
    v_mfma_f32_32x32x16_bf16 a[112:127], a[252:255], v[76:79], a[112:127]
    s_waitcnt lgkmcnt(7)
    v_accvgpr_read_b32 v170, a66
    v_accvgpr_read_b32 v171, a67
    v_accvgpr_read_b32 v172, a68
    v_accvgpr_read_b32 v173, a69
    v_accvgpr_read_b32 v174, a70
    v_accvgpr_read_b32 v175, a71
    v_mfma_f32_32x32x16_bf16 v[56:71], a[192:195], v[200:203], v[120:135]
    s_waitcnt lgkmcnt(6)
    v_mul_f32 v168, v248, v168
    v_mul_f32 v169, v248, v169
    v_mul_f32 v170, v248, v170
    v_mul_f32 v171, v248, v171
    v_mul_f32 v172, v248, v172
    v_mul_f32 v173, v248, v173
    v_mfma_f32_32x32x16_bf16 v[56:71], a[196:199], v[204:207], v[56:71]
    v_mul_f32 v174, v248, v174
    v_mul_f32 v175, v248, v175
    v_cvt_pk_bf16_f32 v184, v168, v169
    v_cvt_pk_bf16_f32 v185, v170, v171
    v_cvt_pk_bf16_f32 v186, v172, v173
    v_cvt_pk_bf16_f32 v187, v174, v175
    v_mfma_f32_32x32x16_bf16 a[128:143], a[224:227], v[80:83], a[128:143]
    s_waitcnt lgkmcnt(5)
    ds_write_b128 v232, v[184:187] offset:0
    v_accvgpr_read_b32 v176, a72
    v_mfma_f32_32x32x16_bf16 v[56:71], a[200:203], v[208:211], v[56:71]
    s_waitcnt lgkmcnt(5)
    ds_read_b128 a[192:195], v1 offset:32768
    ds_read_b128 a[196:199], v2 offset:32768
    v_accvgpr_read_b32 v177, a73
    v_accvgpr_read_b32 v178, a74
    v_accvgpr_read_b32 v179, a75
    v_accvgpr_read_b32 v180, a76
    v_mfma_f32_32x32x16_bf16 v[56:71], a[204:207], v[212:215], v[56:71]
    ds_read_b64_tr_b16 a[224:225], v9 offset:16384
    ds_read_b64_tr_b16 a[226:227], v9 offset:18432
    v_accvgpr_read_b32 v181, a77
    v_accvgpr_read_b32 v182, a78
    v_accvgpr_read_b32 v183, a79
    v_mul_f32 v176, v248, v176
    v_mfma_f32_32x32x16_bf16 a[144:159], a[228:231], v[80:83], a[144:159]
    s_waitcnt lgkmcnt(8)
    ds_read_b128 a[200:203], v3 offset:32768
    v_mul_f32 v177, v248, v177
    v_mul_f32 v178, v248, v178
    v_mul_f32 v179, v248, v179
    v_mul_f32 v180, v248, v180
    v_mul_f32 v181, v248, v181
    v_mfma_f32_32x32x16_bf16 v[56:71], a[208:211], v[216:219], v[56:71]
    s_waitcnt lgkmcnt(8)
    ds_read_b128 a[204:207], v4 offset:32768
    v_mul_f32 v182, v248, v182
    v_mul_f32 v183, v248, v183
    v_cvt_pk_bf16_f32 v188, v176, v177
    v_cvt_pk_bf16_f32 v189, v178, v179
    v_cvt_pk_bf16_f32 v190, v180, v181
    v_mfma_f32_32x32x16_bf16 v[56:71], a[212:215], v[220:223], v[56:71]
    ds_read_b64_tr_b16 a[228:229], v10 offset:16384
    ds_read_b64_tr_b16 a[230:231], v10 offset:18432
    v_cvt_pk_bf16_f32 v191, v182, v183
    v_accvgpr_read_b32 v168, a80
    v_accvgpr_read_b32 v169, a81
    v_accvgpr_read_b32 v170, a82
    v_mfma_f32_32x32x16_bf16 a[160:175], a[232:235], v[80:83], a[160:175]
    s_waitcnt lgkmcnt(10)
    ds_write_b128 v233, v[188:191] offset:0
    v_accvgpr_read_b32 v171, a83
    v_mfma_f32_32x32x16_bf16 v[56:71], a[216:219], v[224:227], v[56:71]
    s_waitcnt lgkmcnt(10)
    ds_read_b128 a[208:211], v5 offset:32768
    ds_read_b128 a[212:215], v6 offset:32768
    v_accvgpr_read_b32 v172, a84
    v_accvgpr_read_b32 v173, a85
    v_accvgpr_read_b32 v174, a86
    v_accvgpr_read_b32 v175, a87
    v_mfma_f32_32x32x16_bf16 v[56:71], a[220:223], v[228:231], v[56:71]
    ds_read_b64_tr_b16 a[232:233], v11 offset:16384
    ds_read_b64_tr_b16 a[234:235], v11 offset:18432
    v_mul_f32 v168, v248, v168
    v_mul_f32 v169, v248, v169
    v_mul_f32 v170, v248, v170
    v_mul_f32 v171, v248, v171
    v_mfma_f32_32x32x16_bf16 a[176:191], a[236:239], v[80:83], a[176:191]
    ds_read_b128 a[216:219], v7 offset:32768
    v_mul_f32 v172, v248, v172
    v_mul_f32 v173, v248, v173
    v_mul_f32 v174, v248, v174
    v_mul_f32 v175, v248, v175
    v_cvt_pk_bf16_f32 v192, v168, v169
    v_mfma_f32_32x32x16_bf16 a[128:143], a[240:243], v[84:87], a[128:143]
    ds_read_b128 a[220:223], v8 offset:32768
    v_cvt_pk_bf16_f32 v193, v170, v171
    v_cvt_pk_bf16_f32 v194, v172, v173
    v_cvt_pk_bf16_f32 v195, v174, v175
    v_accvgpr_read_b32 v176, a88
    v_accvgpr_read_b32 v177, a89
    v_mfma_f32_32x32x16_bf16 a[144:159], a[244:247], v[84:87], a[144:159]
    ds_write_b128 v234, v[192:195] offset:0
    v_accvgpr_read_b32 v178, a90
    v_mfma_f32_32x32x16_bf16 a[160:175], a[248:251], v[84:87], a[160:175]
    v_accvgpr_read_b32 v179, a91
    v_accvgpr_read_b32 v180, a92
    v_accvgpr_read_b32 v181, a93
    v_accvgpr_read_b32 v182, a94
    v_accvgpr_read_b32 v183, a95
    v_mul_f32 v176, v248, v176
    v_mul_f32 v177, v248, v177
    v_mul_f32 v178, v248, v178
    v_mul_f32 v179, v248, v179
    v_mul_f32 v180, v248, v180
    v_mul_f32 v181, v248, v181
    v_mul_f32 v182, v248, v182
    v_mul_f32 v183, v248, v183
    v_cvt_pk_bf16_f32 v196, v176, v177
    v_cvt_pk_bf16_f32 v197, v178, v179
    v_cvt_pk_bf16_f32 v198, v180, v181
    v_cvt_pk_bf16_f32 v199, v182, v183
    v_add_f32 v19, v19, v21
    v_exp_f32 v28, v40
    v_exp_f32 v29, v41
    s_nop 0
    v_add_f32 v20, v28, v29
    v_cvt_pk_bf16_f32 v72, v28, v29
    v_exp_f32 v30, v42
    v_exp_f32 v31, v43
    v_add_f32 v20, v20, v30
    v_add_f32 v20, v20, v31
    v_cvt_pk_bf16_f32 v73, v30, v31
    v_exp_f32 v32, v44
    v_exp_f32 v33, v45
    v_add_f32 v20, v20, v32
    v_add_f32 v20, v20, v33
    v_cvt_pk_bf16_f32 v74, v32, v33
    v_exp_f32 v34, v46
    v_exp_f32 v35, v47
    v_add_f32 v20, v20, v34
    v_add_f32 v20, v20, v35
    v_cvt_pk_bf16_f32 v75, v34, v35
    v_exp_f32 v28, v48
    v_exp_f32 v29, v49
    v_add_f32 v20, v20, v28
    v_add_f32 v20, v20, v29
    v_cvt_pk_bf16_f32 v76, v28, v29
    v_exp_f32 v30, v50
    v_exp_f32 v31, v51
    v_add_f32 v20, v20, v30
    v_add_f32 v20, v20, v31
    v_cvt_pk_bf16_f32 v77, v30, v31
    v_exp_f32 v32, v52
    v_exp_f32 v33, v53
    v_add_f32 v20, v20, v32
    v_add_f32 v20, v20, v33
    v_cvt_pk_bf16_f32 v78, v32, v33
    v_exp_f32 v34, v54
    v_exp_f32 v35, v55
    v_add_f32 v20, v20, v34
    v_add_f32 v20, v20, v35
    v_cvt_pk_bf16_f32 v79, v34, v35
    v_cmp_lt_f32 vcc, s29, v20
    v_mfma_f32_32x32x16_bf16 a[176:191], a[252:255], v[84:87], a[176:191]
    s_waitcnt lgkmcnt(15)
    ds_write_b128 v235, v[196:199] offset:0
    ds_read_b128 v[104:107], v16 offset:0
    ds_read_b128 v[108:111], v16 offset:1024
    s_cbranch_vccnz L_tr42
L_bk42:
    v_mfma_f32_32x32x16_bf16 v[40:55], a[192:195], v[200:203], v[120:135]
    s_waitcnt lgkmcnt(15)
    ds_read_b128 v[112:115], v16 offset:2048
    ds_read_b128 v[116:119], v16 offset:3072
    v_accvgpr_read_b32 v168, a96
    v_accvgpr_read_b32 v169, a97
    v_accvgpr_read_b32 v170, a98
    v_accvgpr_read_b32 v171, a99
    v_mfma_f32_32x32x16_bf16 v[40:55], a[196:199], v[204:207], v[40:55]
    ds_read_b64_tr_b16 a[236:237], v12 offset:16384
    ds_read_b64_tr_b16 a[238:239], v12 offset:18432
    v_accvgpr_read_b32 v172, a100
    v_accvgpr_read_b32 v173, a101
    v_accvgpr_read_b32 v174, a102
    v_accvgpr_read_b32 v175, a103
    v_mfma_f32_32x32x16_bf16 a[128:143], a[224:227], v[72:75], a[128:143]
    s_waitcnt lgkmcnt(15)
    ds_read_b64_tr_b16 a[240:241], v9 offset:20480
    ds_read_b64_tr_b16 a[242:243], v9 offset:22528
    v_mul_f32 v168, v248, v168
    v_mul_f32 v169, v248, v169
    v_mul_f32 v170, v248, v170
    v_mul_f32 v171, v248, v171
    v_mfma_f32_32x32x16_bf16 v[40:55], a[200:203], v[208:211], v[40:55]
    s_waitcnt lgkmcnt(7)
    buffer_store_dwordx4 v[104:107], v240, s[24:27], s38 offen offset:0 nt
    v_mul_f32 v172, v248, v172
    v_mfma_f32_32x32x16_bf16 v[40:55], a[204:207], v[212:215], v[40:55]
    ds_read_b64_tr_b16 a[244:245], v10 offset:20480
    ds_read_b64_tr_b16 a[246:247], v10 offset:22528
    v_mul_f32 v173, v248, v173
    v_mul_f32 v174, v248, v174
    v_mul_f32 v175, v248, v175
    v_cvt_pk_bf16_f32 v184, v168, v169
    v_mfma_f32_32x32x16_bf16 a[144:159], a[228:231], v[72:75], a[144:159]
    ds_read_b64_tr_b16 a[248:249], v11 offset:20480
    ds_read_b64_tr_b16 a[250:251], v11 offset:22528
    v_cvt_pk_bf16_f32 v185, v170, v171
    v_cvt_pk_bf16_f32 v186, v172, v173
    v_cvt_pk_bf16_f32 v187, v174, v175
    v_accvgpr_read_b32 v176, a104
    v_mfma_f32_32x32x16_bf16 v[40:55], a[208:211], v[216:219], v[40:55]
    s_waitcnt lgkmcnt(10)
    buffer_store_dwordx4 v[108:111], v241, s[24:27], s38 offen offset:1024 nt
    v_accvgpr_read_b32 v177, a105
    v_mfma_f32_32x32x16_bf16 v[40:55], a[212:215], v[220:223], v[40:55]
    ds_write_b128 v232, v[184:187] offset:4096
    v_accvgpr_read_b32 v178, a106
    v_mfma_f32_32x32x16_bf16 a[160:175], a[232:235], v[72:75], a[160:175]
    ds_read_b64_tr_b16 a[252:253], v12 offset:20480
    ds_read_b64_tr_b16 a[254:255], v12 offset:22528
    v_accvgpr_read_b32 v179, a107
    v_accvgpr_read_b32 v180, a108
    v_accvgpr_read_b32 v181, a109
    v_accvgpr_read_b32 v182, a110
    v_mfma_f32_32x32x16_bf16 v[40:55], a[216:219], v[224:227], v[40:55]
    s_waitcnt lgkmcnt(12)
    buffer_store_dwordx4 v[112:115], v242, s[24:27], s38 offen offset:2048 nt
    v_accvgpr_read_b32 v183, a111
    v_mfma_f32_32x32x16_bf16 v[40:55], a[220:223], v[228:231], v[40:55]
    s_waitcnt lgkmcnt(9)
    ds_read_b128 a[192:195], v1 offset:57344
    ds_read_b128 a[196:199], v2 offset:57344
    v_mul_f32 v176, v248, v176
    v_mul_f32 v177, v248, v177
    v_mul_f32 v178, v248, v178
    v_mul_f32 v179, v248, v179
    v_mfma_f32_32x32x16_bf16 a[176:191], a[236:239], v[72:75], a[176:191]
    s_waitcnt lgkmcnt(9)
    ds_read_b64_tr_b16 a[224:225], v9 offset:24576
    ds_read_b64_tr_b16 a[226:227], v9 offset:26624
    v_mul_f32 v180, v248, v180
    v_mul_f32 v181, v248, v181
    v_mul_f32 v182, v248, v182
    v_mul_f32 v183, v248, v183
    v_mfma_f32_32x32x16_bf16 a[128:143], a[240:243], v[76:79], a[128:143]
    s_waitcnt lgkmcnt(9)
    buffer_store_dwordx4 v[116:119], v243, s[24:27], s38 offen offset:3072 nt
    v_cvt_pk_bf16_f32 v188, v176, v177
    v_cvt_pk_bf16_f32 v189, v178, v179
    v_cvt_pk_bf16_f32 v190, v180, v181
    v_cvt_pk_bf16_f32 v191, v182, v183
    v_mfma_f32_32x32x16_bf16 a[144:159], a[244:247], v[76:79], a[144:159]
    s_waitcnt lgkmcnt(7)
    ds_write_b128 v233, v[188:191] offset:4096
    v_accvgpr_read_b32 v168, a112
    v_accvgpr_read_b32 v169, a113
    v_accvgpr_read_b32 v170, a114
    v_mfma_f32_32x32x16_bf16 a[160:175], a[248:251], v[76:79], a[160:175]
    s_waitcnt lgkmcnt(5)
    v_accvgpr_read_b32 v171, a115
    v_accvgpr_read_b32 v172, a116
    v_accvgpr_read_b32 v173, a117
    v_accvgpr_read_b32 v174, a118
    v_accvgpr_read_b32 v175, a119
    v_add_f32 v19, v19, v20
    v_exp_f32 v28, v56
    v_exp_f32 v29, v57
    s_nop 0
    v_add_f32 v21, v28, v29
    v_cvt_pk_bf16_f32 v80, v28, v29
    v_exp_f32 v30, v58
    v_exp_f32 v31, v59
    v_add_f32 v21, v21, v30
    v_add_f32 v21, v21, v31
    v_cvt_pk_bf16_f32 v81, v30, v31
    v_exp_f32 v32, v60
    v_exp_f32 v33, v61
    v_add_f32 v21, v21, v32
    v_add_f32 v21, v21, v33
    v_cvt_pk_bf16_f32 v82, v32, v33
    v_exp_f32 v34, v62
    v_exp_f32 v35, v63
    v_add_f32 v21, v21, v34
    v_add_f32 v21, v21, v35
    v_cvt_pk_bf16_f32 v83, v34, v35
    v_exp_f32 v28, v64
    v_exp_f32 v29, v65
    v_add_f32 v21, v21, v28
    v_add_f32 v21, v21, v29
    v_cvt_pk_bf16_f32 v84, v28, v29
    v_exp_f32 v30, v66
    v_exp_f32 v31, v67
    v_add_f32 v21, v21, v30
    v_add_f32 v21, v21, v31
    v_cvt_pk_bf16_f32 v85, v30, v31
    v_exp_f32 v32, v68
    v_exp_f32 v33, v69
    v_add_f32 v21, v21, v32
    v_add_f32 v21, v21, v33
    v_cvt_pk_bf16_f32 v86, v32, v33
    v_exp_f32 v34, v70
    v_exp_f32 v35, v71
    v_add_f32 v21, v21, v34
    v_add_f32 v21, v21, v35
    v_cvt_pk_bf16_f32 v87, v34, v35
    v_cmp_lt_f32 vcc, s29, v21
    v_mfma_f32_32x32x16_bf16 a[176:191], a[252:255], v[76:79], a[176:191]
    s_waitcnt lgkmcnt(4)
    s_cbranch_vccnz L_tr43
L_bk43:
    ds_read_b128 a[200:203], v3 offset:57344
    v_mul_f32 v168, v248, v168
    v_mul_f32 v169, v248, v169
    v_mul_f32 v170, v248, v170
    v_mul_f32 v171, v248, v171
    v_mul_f32 v172, v248, v172
    v_mfma_f32_32x32x16_bf16 v[56:71], a[192:195], v[200:203], v[120:135]
    s_waitcnt lgkmcnt(4)
    ds_read_b128 a[204:207], v4 offset:57344
    v_mul_f32 v173, v248, v173
    v_mul_f32 v174, v248, v174
    v_mul_f32 v175, v248, v175
    v_cvt_pk_bf16_f32 v192, v168, v169
    v_cvt_pk_bf16_f32 v193, v170, v171
    v_cvt_pk_bf16_f32 v194, v172, v173
    v_cvt_pk_bf16_f32 v195, v174, v175
    v_mfma_f32_32x32x16_bf16 v[56:71], a[196:199], v[204:207], v[56:71]
    s_waitcnt lgkmcnt(3)
    ds_write_b128 v234, v[192:195] offset:4096
    ds_read_b64_tr_b16 a[228:229], v10 offset:24576
    ds_read_b64_tr_b16 a[230:231], v10 offset:26624
    v_accvgpr_read_b32 v176, a120
    v_mfma_f32_32x32x16_bf16 a[128:143], a[224:227], v[80:83], a[128:143]
    s_waitcnt lgkmcnt(4)
    ds_read_b128 a[208:211], v5 offset:57344
    v_accvgpr_read_b32 v177, a121
    v_accvgpr_read_b32 v178, a122
    v_accvgpr_read_b32 v179, a123
    v_accvgpr_read_b32 v180, a124
    v_accvgpr_read_b32 v181, a125
    v_accvgpr_read_b32 v182, a126
    v_accvgpr_read_b32 v183, a127
    v_mul_f32 v176, v248, v176
    v_mul_f32 v177, v248, v177
    v_mul_f32 v178, v248, v178
    v_mul_f32 v179, v248, v179
    v_mul_f32 v180, v248, v180
    v_mul_f32 v181, v248, v181
    v_mul_f32 v182, v248, v182
    v_mul_f32 v183, v248, v183
    v_cvt_pk_bf16_f32 v196, v176, v177
    v_cvt_pk_bf16_f32 v197, v178, v179
    v_cvt_pk_bf16_f32 v198, v180, v181
    v_cvt_pk_bf16_f32 v199, v182, v183
    v_mfma_f32_32x32x16_bf16 v[56:71], a[200:203], v[208:211], v[56:71]
    s_waitcnt lgkmcnt(4)
    ds_write_b128 v235, v[196:199] offset:4096
    ds_read_b128 v[168:171], v16 offset:4096
    ds_read_b128 v[172:175], v16 offset:5120
    ds_read_b128 v[176:179], v16 offset:6144
    ds_read_b128 v[180:183], v16 offset:7168
    ds_read_b128 a[212:215], v6 offset:57344
    v_mfma_f32_32x32x16_bf16 v[56:71], a[204:207], v[212:215], v[56:71]
    s_waitcnt lgkmcnt(7)
    ds_read_b64_tr_b16 a[232:233], v11 offset:24576
    ds_read_b64_tr_b16 a[234:235], v11 offset:26624
    ds_read_b128 a[216:219], v7 offset:57344
    ds_read_b128 a[220:223], v8 offset:57344
    v_add_f32 v19, v19, v21
    v_mfma_f32_32x32x16_bf16 a[144:159], a[228:231], v[80:83], a[144:159]
    s_waitcnt lgkmcnt(10)
    ds_read_b64_tr_b16 a[236:237], v12 offset:24576
    ds_read_b64_tr_b16 a[238:239], v12 offset:26624
    v_exp_f32 v28, v40
    v_exp_f32 v29, v41
    v_mfma_f32_32x32x16_bf16 v[56:71], a[208:211], v[216:219], v[56:71]
    s_waitcnt lgkmcnt(6)
    buffer_store_dwordx4 v[168:171], v240, s[24:27], s39 offen offset:0 nt
    ds_read_b64_tr_b16 a[240:241], v9 offset:28672
    ds_read_b64_tr_b16 a[242:243], v9 offset:30720
    v_mfma_f32_32x32x16_bf16 v[56:71], a[212:215], v[220:223], v[56:71]
    s_waitcnt lgkmcnt(6)
    ds_read_b64_tr_b16 a[244:245], v10 offset:28672
    ds_read_b64_tr_b16 a[246:247], v10 offset:30720
    v_add_f32 v20, v28, v29
    v_cvt_pk_bf16_f32 v72, v28, v29
    v_exp_f32 v30, v42
    v_mfma_f32_32x32x16_bf16 a[160:175], a[232:235], v[80:83], a[160:175]
    s_waitcnt lgkmcnt(7)
    ds_read_b64_tr_b16 a[248:249], v11 offset:28672
    ds_read_b64_tr_b16 a[250:251], v11 offset:30720
    v_exp_f32 v31, v43
    v_add_f32 v20, v20, v30
    v_add_f32 v20, v20, v31
    v_mfma_f32_32x32x16_bf16 v[56:71], a[216:219], v[224:227], v[56:71]
    s_waitcnt lgkmcnt(8)
    buffer_store_dwordx4 v[172:175], v241, s[24:27], s39 offen offset:1024 nt
    ds_read_b64_tr_b16 a[252:253], v12 offset:28672
    ds_read_b64_tr_b16 a[254:255], v12 offset:30720
    v_mfma_f32_32x32x16_bf16 v[56:71], a[220:223], v[228:231], v[56:71]
    s_waitcnt lgkmcnt(8)
    ds_read_b128 a[192:195], v1 offset:40960
    ds_read_b128 a[196:199], v2 offset:40960
    v_cvt_pk_bf16_f32 v73, v30, v31
    v_exp_f32 v32, v44
    v_mfma_f32_32x32x16_bf16 a[176:191], a[236:239], v[80:83], a[176:191]
    s_waitcnt lgkmcnt(8)
    ds_read_b64_tr_b16 a[224:225], v9 offset:32768
    ds_read_b64_tr_b16 a[226:227], v9 offset:34816
    v_exp_f32 v33, v45
    v_add_f32 v20, v20, v32
    v_add_f32 v20, v20, v33
    v_mfma_f32_32x32x16_bf16 a[128:143], a[240:243], v[84:87], a[128:143]
    s_waitcnt lgkmcnt(8)
    buffer_store_dwordx4 v[176:179], v242, s[24:27], s39 offen offset:2048 nt
    v_cvt_pk_bf16_f32 v74, v32, v33
    v_mfma_f32_32x32x16_bf16 a[144:159], a[244:247], v[84:87], a[144:159]
    s_waitcnt lgkmcnt(6)
    ds_read_b128 a[200:203], v3 offset:40960
    ds_read_b128 a[204:207], v4 offset:40960
    v_exp_f32 v34, v46
    v_exp_f32 v35, v47
    v_mfma_f32_32x32x16_bf16 a[160:175], a[248:251], v[84:87], a[160:175]
    s_waitcnt lgkmcnt(6)
    v_add_f32 v20, v20, v34
    v_add_f32 v20, v20, v35
    v_cvt_pk_bf16_f32 v75, v34, v35
    v_exp_f32 v28, v48
    v_exp_f32 v29, v49
    v_add_f32 v20, v20, v28
    v_add_f32 v20, v20, v29
    v_cvt_pk_bf16_f32 v76, v28, v29
    v_exp_f32 v30, v50
    v_exp_f32 v31, v51
    v_add_f32 v20, v20, v30
    v_add_f32 v20, v20, v31
    v_cvt_pk_bf16_f32 v77, v30, v31
    v_exp_f32 v32, v52
    v_exp_f32 v33, v53
    v_add_f32 v20, v20, v32
    v_add_f32 v20, v20, v33
    v_cvt_pk_bf16_f32 v78, v32, v33
    v_exp_f32 v34, v54
    v_exp_f32 v35, v55
    v_add_f32 v20, v20, v34
    v_add_f32 v20, v20, v35
    v_cvt_pk_bf16_f32 v79, v34, v35
    v_cmp_lt_f32 vcc, s29, v20
    v_mfma_f32_32x32x16_bf16 a[176:191], a[252:255], v[84:87], a[176:191]
    s_waitcnt lgkmcnt(5)
    buffer_store_dwordx4 v[180:183], v243, s[24:27], s39 offen offset:3072 nt
    s_cbranch_vccnz L_tr44
L_bk44:
    ds_read_b64_tr_b16 a[228:229], v10 offset:32768
    v_mfma_f32_32x32x16_bf16 v[40:55], a[192:195], v[200:203], v[120:135]
    s_waitcnt lgkmcnt(5)
    ds_read_b64_tr_b16 a[230:231], v10 offset:34816
    ds_read_b128 a[208:211], v5 offset:40960
    v_add_f32 v19, v19, v20
    v_exp_f32 v28, v56
    v_mfma_f32_32x32x16_bf16 v[40:55], a[196:199], v[204:207], v[40:55]
    s_waitcnt lgkmcnt(5)
    ds_read_b128 a[212:215], v6 offset:40960
    ds_read_b64_tr_b16 a[232:233], v11 offset:32768
    v_exp_f32 v29, v57
    v_exp_f32 v30, v58
    v_mfma_f32_32x32x16_bf16 a[128:143], a[224:227], v[72:75], a[128:143]
    s_waitcnt lgkmcnt(6)
    ds_read_b64_tr_b16 a[234:235], v11 offset:34816
    ds_read_b128 a[216:219], v7 offset:40960
    v_add_f32 v21, v28, v29
    v_cvt_pk_bf16_f32 v80, v28, v29
    v_exp_f32 v31, v59
    v_mfma_f32_32x32x16_bf16 v[40:55], a[200:203], v[208:211], v[40:55]
    s_waitcnt lgkmcnt(7)
    ds_read_b128 a[220:223], v8 offset:40960
    ds_read_b64_tr_b16 a[236:237], v12 offset:32768
    v_add_f32 v21, v21, v30
    v_add_f32 v21, v21, v31
    v_cvt_pk_bf16_f32 v81, v30, v31
    v_mfma_f32_32x32x16_bf16 v[40:55], a[204:207], v[212:215], v[40:55]
    s_waitcnt lgkmcnt(7)
    ds_read_b64_tr_b16 a[238:239], v12 offset:34816
    ds_read_b64_tr_b16 a[240:241], v9 offset:36864
    v_exp_f32 v32, v60
    v_exp_f32 v33, v61
    v_mfma_f32_32x32x16_bf16 a[144:159], a[228:231], v[72:75], a[144:159]
    s_waitcnt lgkmcnt(8)
    ds_read_b64_tr_b16 a[242:243], v9 offset:38912
    ds_read_b64_tr_b16 a[244:245], v10 offset:36864
    v_add_f32 v21, v21, v32
    v_add_f32 v21, v21, v33
    v_cvt_pk_bf16_f32 v82, v32, v33
    v_mfma_f32_32x32x16_bf16 v[40:55], a[208:211], v[216:219], v[40:55]
    s_waitcnt lgkmcnt(9)
    ds_read_b64_tr_b16 a[246:247], v10 offset:38912
    ds_read_b64_tr_b16 a[248:249], v11 offset:36864
    v_exp_f32 v34, v62
    v_exp_f32 v35, v63
    v_mfma_f32_32x32x16_bf16 v[40:55], a[212:215], v[220:223], v[40:55]
    s_waitcnt lgkmcnt(9)
    ds_read_b64_tr_b16 a[250:251], v11 offset:38912
    ds_read_b64_tr_b16 a[252:253], v12 offset:36864
    v_add_f32 v21, v21, v34
    v_add_f32 v21, v21, v35
    v_cvt_pk_bf16_f32 v83, v34, v35
    v_mfma_f32_32x32x16_bf16 a[160:175], a[232:235], v[72:75], a[160:175]
    s_waitcnt lgkmcnt(10)
    ds_read_b64_tr_b16 a[254:255], v12 offset:38912
    ds_read_b128 a[192:195], v1 offset:49152
    v_exp_f32 v28, v64
    v_exp_f32 v29, v65
    v_mfma_f32_32x32x16_bf16 v[40:55], a[216:219], v[224:227], v[40:55]
    s_waitcnt lgkmcnt(11)
    ds_read_b128 a[196:199], v2 offset:49152
    ds_read_b64_tr_b16 a[224:225], v9 offset:57344
    v_add_f32 v21, v21, v28
    v_add_f32 v21, v21, v29
    v_cvt_pk_bf16_f32 v84, v28, v29
    v_mfma_f32_32x32x16_bf16 v[40:55], a[220:223], v[228:231], v[40:55]
    s_waitcnt lgkmcnt(11)
    ds_read_b64_tr_b16 a[226:227], v9 offset:59392
    ds_read_b128 a[200:203], v3 offset:49152
    v_exp_f32 v30, v66
    v_exp_f32 v31, v67
    v_mfma_f32_32x32x16_bf16 a[176:191], a[236:239], v[72:75], a[176:191]
    s_waitcnt lgkmcnt(11)
    ds_read_b128 a[204:207], v4 offset:49152
    ds_read_b64_tr_b16 a[228:229], v10 offset:57344
    v_add_f32 v21, v21, v30
    v_add_f32 v21, v21, v31
    v_cvt_pk_bf16_f32 v85, v30, v31
    v_mfma_f32_32x32x16_bf16 a[128:143], a[240:243], v[76:79], a[128:143]
    s_waitcnt lgkmcnt(11)
    ds_read_b64_tr_b16 a[230:231], v10 offset:59392
    ds_read_b128 a[208:211], v5 offset:49152
    v_exp_f32 v32, v68
    v_exp_f32 v33, v69
    v_mfma_f32_32x32x16_bf16 a[144:159], a[244:247], v[76:79], a[144:159]
    s_waitcnt lgkmcnt(11)
    ds_read_b128 a[212:215], v6 offset:49152
    ds_read_b64_tr_b16 a[232:233], v11 offset:57344
    v_add_f32 v21, v21, v32
L_stub3_0:
    s_cbranch_scc1 L_walk_done
    v_add_f32 v21, v21, v33
    v_cvt_pk_bf16_f32 v86, v32, v33
    v_mfma_f32_32x32x16_bf16 a[160:175], a[248:251], v[76:79], a[160:175]
    s_waitcnt lgkmcnt(11)
    v_exp_f32 v34, v70
    v_exp_f32 v35, v71
    v_add_f32 v21, v21, v34
    v_add_f32 v21, v21, v35
    v_cvt_pk_bf16_f32 v87, v34, v35
    v_cmp_lt_f32 vcc, s29, v21
    v_mfma_f32_32x32x16_bf16 a[176:191], a[252:255], v[76:79], a[176:191]
    s_waitcnt lgkmcnt(10)
    s_cbranch_vccnz L_tr45
L_bk45:
    ds_read_b64_tr_b16 a[234:235], v11 offset:59392
    v_add_f32 v19, v19, v21
    v_exp_f32 v28, v40
    v_mfma_f32_32x32x16_bf16 v[56:71], a[192:195], v[200:203], v[120:135]
    s_waitcnt lgkmcnt(10)
    ds_read_b128 a[216:219], v7 offset:49152
    ds_read_b128 a[220:223], v8 offset:49152
    v_exp_f32 v29, v41
    v_exp_f32 v30, v42
    v_mfma_f32_32x32x16_bf16 v[56:71], a[196:199], v[204:207], v[56:71]
    s_waitcnt lgkmcnt(10)
    ds_read_b64_tr_b16 a[236:237], v12 offset:57344
    ds_read_b64_tr_b16 a[238:239], v12 offset:59392
    v_add_f32 v20, v28, v29
    v_cvt_pk_bf16_f32 v72, v28, v29
    v_exp_f32 v31, v43
    v_mfma_f32_32x32x16_bf16 a[128:143], a[224:227], v[80:83], a[128:143]
    s_waitcnt lgkmcnt(11)
    ds_read_b64_tr_b16 a[240:241], v9 offset:61440
    ds_read_b64_tr_b16 a[242:243], v9 offset:63488
    v_add_f32 v20, v20, v30
    v_add_f32 v20, v20, v31
    v_cvt_pk_bf16_f32 v73, v30, v31
    v_mfma_f32_32x32x16_bf16 v[56:71], a[200:203], v[208:211], v[56:71]
    s_waitcnt lgkmcnt(12)
    ds_read_b64_tr_b16 a[244:245], v10 offset:61440
    ds_read_b64_tr_b16 a[246:247], v10 offset:63488
    v_exp_f32 v32, v44
    v_exp_f32 v33, v45
    v_mfma_f32_32x32x16_bf16 v[56:71], a[204:207], v[212:215], v[56:71]
    s_waitcnt lgkmcnt(12)
    ds_read_b64_tr_b16 a[248:249], v11 offset:61440
    ds_read_b64_tr_b16 a[250:251], v11 offset:63488
    v_add_f32 v20, v20, v32
    v_add_f32 v20, v20, v33
    v_cvt_pk_bf16_f32 v74, v32, v33
    v_mfma_f32_32x32x16_bf16 a[144:159], a[228:231], v[80:83], a[144:159]
    s_waitcnt lgkmcnt(13)
    ds_read_b64_tr_b16 a[252:253], v12 offset:61440
    ds_read_b64_tr_b16 a[254:255], v12 offset:63488
    v_exp_f32 v34, v46
    v_exp_f32 v35, v47
    v_mfma_f32_32x32x16_bf16 v[56:71], a[208:211], v[216:219], v[56:71]
    s_waitcnt lgkmcnt(14)
    ds_read_b64_tr_b16 a[224:225], v9 offset:40960
    ds_read_b64_tr_b16 a[226:227], v9 offset:43008
    v_add_f32 v20, v20, v34
    v_add_f32 v20, v20, v35
    v_cvt_pk_bf16_f32 v75, v34, v35
    v_mfma_f32_32x32x16_bf16 v[56:71], a[212:215], v[220:223], v[56:71]
    s_waitcnt lgkmcnt(14)
    ds_read_b64_tr_b16 a[228:229], v10 offset:40960
    ds_read_b64_tr_b16 a[230:231], v10 offset:43008
    v_exp_f32 v28, v48
    v_exp_f32 v29, v49
    v_mfma_f32_32x32x16_bf16 a[160:175], a[232:235], v[80:83], a[160:175]
    s_waitcnt lgkmcnt(15)
    ds_read_b64_tr_b16 a[232:233], v11 offset:40960
    ds_read_b64_tr_b16 a[234:235], v11 offset:43008
    v_add_f32 v20, v20, v28
    v_add_f32 v20, v20, v29
    v_cvt_pk_bf16_f32 v76, v28, v29
    v_mfma_f32_32x32x16_bf16 v[56:71], a[216:219], v[224:227], v[56:71]
    s_waitcnt lgkmcnt(15)
    v_exp_f32 v30, v50
    v_exp_f32 v31, v51
    v_add_f32 v20, v20, v30
    v_add_f32 v20, v20, v31
    v_mfma_f32_32x32x16_bf16 v[56:71], a[220:223], v[228:231], v[56:71]
    s_waitcnt lgkmcnt(14)
    v_cvt_pk_bf16_f32 v77, v30, v31
    v_exp_f32 v32, v52
    v_exp_f32 v33, v53
    v_add_f32 v20, v20, v32
    v_mfma_f32_32x32x16_bf16 a[176:191], a[236:239], v[80:83], a[176:191]
    s_waitcnt lgkmcnt(12)
    ds_read_b64_tr_b16 a[236:237], v12 offset:40960
    ds_read_b64_tr_b16 a[238:239], v12 offset:43008
    v_add_f32 v20, v20, v33
    v_cvt_pk_bf16_f32 v78, v32, v33
    v_exp_f32 v34, v54
    v_mfma_f32_32x32x16_bf16 a[128:143], a[240:243], v[84:87], a[128:143]
    s_waitcnt lgkmcnt(12)
    ds_read_b64_tr_b16 a[240:241], v9 offset:45056
    ds_read_b64_tr_b16 a[242:243], v9 offset:47104
    v_exp_f32 v35, v55
    v_add_f32 v20, v20, v34
    v_add_f32 v20, v20, v35
    v_mfma_f32_32x32x16_bf16 a[144:159], a[244:247], v[84:87], a[144:159]
    s_waitcnt lgkmcnt(12)
    ds_read_b64_tr_b16 a[244:245], v10 offset:45056
    ds_read_b64_tr_b16 a[246:247], v10 offset:47104
    v_cvt_pk_bf16_f32 v79, v34, v35
    v_cmp_lt_f32 vcc, s29, v20
    v_mfma_f32_32x32x16_bf16 a[160:175], a[248:251], v[84:87], a[160:175]
    s_waitcnt lgkmcnt(12)
    ds_read_b64_tr_b16 a[248:249], v11 offset:45056
    ds_read_b64_tr_b16 a[250:251], v11 offset:47104
    v_mfma_f32_32x32x16_bf16 a[176:191], a[252:255], v[84:87], a[176:191]
    s_waitcnt lgkmcnt(12)
    s_cbranch_vccnz L_tr46
L_bk46:
    ds_read_b64_tr_b16 a[252:253], v12 offset:45056
    v_add_f32 v19, v19, v20
    v_exp_f32 v28, v56
    v_mfma_f32_32x32x16_bf16 a[128:143], a[224:227], v[72:75], a[128:143]
    s_waitcnt lgkmcnt(11)
    ds_read_b64_tr_b16 a[254:255], v12 offset:47104
    ds_read_b64_tr_b16 a[224:225], v9 offset:49152
    v_exp_f32 v29, v57
    v_exp_f32 v30, v58
    v_mfma_f32_32x32x16_bf16 a[144:159], a[228:231], v[72:75], a[144:159]
    s_waitcnt lgkmcnt(11)
    ds_read_b64_tr_b16 a[226:227], v9 offset:51200
    ds_read_b64_tr_b16 a[228:229], v10 offset:49152
    v_add_f32 v21, v28, v29
    v_cvt_pk_bf16_f32 v80, v28, v29
    v_exp_f32 v31, v59
    v_mfma_f32_32x32x16_bf16 a[160:175], a[232:235], v[72:75], a[160:175]
    s_waitcnt lgkmcnt(11)
    ds_read_b64_tr_b16 a[230:231], v10 offset:51200
    ds_read_b64_tr_b16 a[232:233], v11 offset:49152
    v_add_f32 v21, v21, v30
    v_add_f32 v21, v21, v31
    v_cvt_pk_bf16_f32 v81, v30, v31
    v_mfma_f32_32x32x16_bf16 a[176:191], a[236:239], v[72:75], a[176:191]
    s_waitcnt lgkmcnt(11)
    ds_read_b64_tr_b16 a[234:235], v11 offset:51200
    ds_read_b64_tr_b16 a[236:237], v12 offset:49152
    v_exp_f32 v32, v60
    v_exp_f32 v33, v61
    v_mfma_f32_32x32x16_bf16 a[128:143], a[240:243], v[76:79], a[128:143]
    s_waitcnt lgkmcnt(11)
    ds_read_b64_tr_b16 a[240:241], v9 offset:53248
    ds_read_b64_tr_b16 a[242:243], v9 offset:55296
    v_add_f32 v21, v21, v32
    v_add_f32 v21, v21, v33
    v_cvt_pk_bf16_f32 v82, v32, v33
    v_mfma_f32_32x32x16_bf16 a[144:159], a[244:247], v[76:79], a[144:159]
    s_waitcnt lgkmcnt(11)
    ds_read_b64_tr_b16 a[244:245], v10 offset:53248
    ds_read_b64_tr_b16 a[246:247], v10 offset:55296
    v_exp_f32 v34, v62
    v_exp_f32 v35, v63
    v_mfma_f32_32x32x16_bf16 a[160:175], a[248:251], v[76:79], a[160:175]
    s_waitcnt lgkmcnt(11)
    v_add_f32 v21, v21, v34
    v_add_f32 v21, v21, v35
    v_cvt_pk_bf16_f32 v83, v34, v35
    v_exp_f32 v28, v64
    v_exp_f32 v29, v65
    v_add_f32 v21, v21, v28
    v_add_f32 v21, v21, v29
    v_cvt_pk_bf16_f32 v84, v28, v29
    v_exp_f32 v30, v66
    v_exp_f32 v31, v67
    v_add_f32 v21, v21, v30
    v_add_f32 v21, v21, v31
    v_cvt_pk_bf16_f32 v85, v30, v31
    v_exp_f32 v32, v68
    v_exp_f32 v33, v69
    v_add_f32 v21, v21, v32
    v_add_f32 v21, v21, v33
    v_cvt_pk_bf16_f32 v86, v32, v33
    v_exp_f32 v34, v70
    v_exp_f32 v35, v71
    v_add_f32 v21, v21, v34
    v_add_f32 v21, v21, v35
    v_cvt_pk_bf16_f32 v87, v34, v35
    v_cmp_lt_f32 vcc, s29, v21
    v_mfma_f32_32x32x16_bf16 a[176:191], a[252:255], v[76:79], a[176:191]
    s_waitcnt lgkmcnt(9)
    s_cbranch_vccnz L_tr47
L_bk47:
    ds_read_b64_tr_b16 a[248:249], v11 offset:53248
    ds_read_b64_tr_b16 a[250:251], v11 offset:55296
    v_add_f32 v19, v19, v21
    v_mov_b32 v254, v19
    v_mfma_f32_32x32x16_bf16 a[128:143], a[224:227], v[80:83], a[128:143]
    s_waitcnt lgkmcnt(4)
    ds_read_b64_tr_b16 a[238:239], v12 offset:51200
    ds_read_b64_tr_b16 a[252:253], v12 offset:53248
    v_permlane32_swap_b32 v19, v254
    v_add_f32 v254, v19, v254
    v_mfma_f32_32x32x16_bf16 a[128:143], a[240:243], v[84:87], a[128:143]
    ds_read_b64_tr_b16 a[254:255], v12 offset:55296
    v_rcp_f32 v252, v254
    s_nop 0
    v_mov_b32 v253, v252
    v_mfma_f32_32x32x16_bf16 a[144:159], a[228:231], v[80:83], a[144:159]
    s_waitcnt lgkmcnt(5)
    s_nop 4
    v_mfma_f32_32x32x16_bf16 a[144:159], a[244:247], v[84:87], a[144:159]
    v_accvgpr_read_b32 v200, a128
    v_accvgpr_read_b32 v201, a129
    v_accvgpr_read_b32 v202, a130
    v_accvgpr_read_b32 v203, a131
    v_accvgpr_read_b32 v204, a132
    v_mfma_f32_32x32x16_bf16 a[160:175], a[232:235], v[80:83], a[160:175]
    s_waitcnt lgkmcnt(3)
    v_accvgpr_read_b32 v205, a133
    v_accvgpr_read_b32 v206, a134
    v_accvgpr_read_b32 v207, a135
    v_mul_f32 v200, v252, v200
    v_mul_f32 v201, v252, v201
    v_mfma_f32_32x32x16_bf16 a[160:175], a[248:251], v[84:87], a[160:175]
    s_waitcnt lgkmcnt(2)
    v_mul_f32 v202, v252, v202
    v_mul_f32 v203, v252, v203
    v_mul_f32 v204, v252, v204
    v_mul_f32 v205, v252, v205
    v_mul_f32 v206, v252, v206
    v_mfma_f32_32x32x16_bf16 a[176:191], a[236:239], v[80:83], a[176:191]
    s_waitcnt lgkmcnt(0)
    v_mul_f32 v207, v252, v207
    v_cvt_pk_bf16_f32 v216, v200, v201
    v_cvt_pk_bf16_f32 v217, v202, v203
    v_cvt_pk_bf16_f32 v218, v204, v205
    v_cvt_pk_bf16_f32 v219, v206, v207
    v_mfma_f32_32x32x16_bf16 a[176:191], a[252:255], v[84:87], a[176:191]
    ds_write_b128 v232, v[216:219] offset:0
    v_accvgpr_read_b32 v208, a136
    v_accvgpr_read_b32 v209, a137
    v_accvgpr_read_b32 v210, a138
    v_accvgpr_read_b32 v211, a139
    v_accvgpr_read_b32 v212, a140
    v_accvgpr_read_b32 v213, a141
    v_accvgpr_read_b32 v214, a142
    v_accvgpr_read_b32 v215, a143
    v_mul_f32 v208, v252, v208
    v_mul_f32 v209, v252, v209
    v_mul_f32 v210, v252, v210
    v_mul_f32 v211, v252, v211
    v_mul_f32 v212, v252, v212
    v_mul_f32 v213, v252, v213
    v_mul_f32 v214, v252, v214
    v_mul_f32 v215, v252, v215
    v_cvt_pk_bf16_f32 v220, v208, v209
    v_cvt_pk_bf16_f32 v221, v210, v211
    v_cvt_pk_bf16_f32 v222, v212, v213
    v_cvt_pk_bf16_f32 v223, v214, v215
    ds_write_b128 v233, v[220:223] offset:0
    v_accvgpr_read_b32 v200, a144
    v_accvgpr_read_b32 v201, a145
    v_accvgpr_read_b32 v202, a146
    v_accvgpr_read_b32 v203, a147
    v_accvgpr_read_b32 v204, a148
    v_accvgpr_read_b32 v205, a149
    v_accvgpr_read_b32 v206, a150
    v_accvgpr_read_b32 v207, a151
    v_pk_mul_f32 v[200:201], v[252:253], v[200:201]
    v_pk_mul_f32 v[202:203], v[252:253], v[202:203]
    v_pk_mul_f32 v[204:205], v[252:253], v[204:205]
    v_pk_mul_f32 v[206:207], v[252:253], v[206:207]
    v_cvt_pk_bf16_f32 v224, v200, v201
    v_cvt_pk_bf16_f32 v225, v202, v203
    v_cvt_pk_bf16_f32 v226, v204, v205
    v_cvt_pk_bf16_f32 v227, v206, v207
    ds_write_b128 v234, v[224:227] offset:0
    v_accvgpr_read_b32 v208, a152
    v_accvgpr_read_b32 v209, a153
    v_accvgpr_read_b32 v210, a154
    v_accvgpr_read_b32 v211, a155
    v_accvgpr_read_b32 v212, a156
    v_accvgpr_read_b32 v213, a157
    v_accvgpr_read_b32 v214, a158
    v_accvgpr_read_b32 v215, a159
    v_pk_mul_f32 v[208:209], v[252:253], v[208:209]
    v_pk_mul_f32 v[210:211], v[252:253], v[210:211]
    v_pk_mul_f32 v[212:213], v[252:253], v[212:213]
    v_pk_mul_f32 v[214:215], v[252:253], v[214:215]
    v_cvt_pk_bf16_f32 v228, v208, v209
    v_cvt_pk_bf16_f32 v229, v210, v211
    v_cvt_pk_bf16_f32 v230, v212, v213
    v_cvt_pk_bf16_f32 v231, v214, v215
    ds_write_b128 v235, v[228:231] offset:0
    ds_read_b128 v[120:123], v16 offset:0
    ds_read_b128 v[124:127], v16 offset:1024
    ds_read_b128 v[128:131], v16 offset:2048
    ds_read_b128 v[132:135], v16 offset:3072
    v_accvgpr_read_b32 v200, a160
    v_accvgpr_read_b32 v201, a161
    v_accvgpr_read_b32 v202, a162
    v_accvgpr_read_b32 v203, a163
    v_accvgpr_read_b32 v204, a164
    v_accvgpr_read_b32 v205, a165
    v_accvgpr_read_b32 v206, a166
    v_accvgpr_read_b32 v207, a167
    v_pk_mul_f32 v[200:201], v[252:253], v[200:201]
    v_pk_mul_f32 v[202:203], v[252:253], v[202:203]
    v_pk_mul_f32 v[204:205], v[252:253], v[204:205]
    v_pk_mul_f32 v[206:207], v[252:253], v[206:207]
    v_cvt_pk_bf16_f32 v216, v200, v201
    v_cvt_pk_bf16_f32 v217, v202, v203
    v_cvt_pk_bf16_f32 v218, v204, v205
    v_cvt_pk_bf16_f32 v219, v206, v207
    ds_write_b128 v232, v[216:219] offset:4096
    s_waitcnt lgkmcnt(4)
    buffer_store_dwordx4 v[120:123], v240, s[24:27], s40 offen offset:0 nt
    v_accvgpr_read_b32 v208, a168
    v_accvgpr_read_b32 v209, a169
    v_accvgpr_read_b32 v210, a170
    v_accvgpr_read_b32 v211, a171
    v_accvgpr_read_b32 v212, a172
    v_accvgpr_read_b32 v213, a173
    s_waitcnt lgkmcnt(3)
    buffer_store_dwordx4 v[124:127], v241, s[24:27], s40 offen offset:1024 nt
    v_accvgpr_read_b32 v214, a174
    v_accvgpr_read_b32 v215, a175
    v_pk_mul_f32 v[208:209], v[252:253], v[208:209]
    v_pk_mul_f32 v[210:211], v[252:253], v[210:211]
    v_pk_mul_f32 v[212:213], v[252:253], v[212:213]
    v_pk_mul_f32 v[214:215], v[252:253], v[214:215]
    s_waitcnt lgkmcnt(2)
    buffer_store_dwordx4 v[128:131], v242, s[24:27], s40 offen offset:2048 nt
    v_cvt_pk_bf16_f32 v220, v208, v209
    v_cvt_pk_bf16_f32 v221, v210, v211
    v_cvt_pk_bf16_f32 v222, v212, v213
    v_cvt_pk_bf16_f32 v223, v214, v215
    ds_write_b128 v233, v[220:223] offset:4096
    s_waitcnt lgkmcnt(2)
    buffer_store_dwordx4 v[132:135], v243, s[24:27], s40 offen offset:3072 nt
    v_accvgpr_read_b32 v200, a176
    v_accvgpr_read_b32 v201, a177
    v_accvgpr_read_b32 v202, a178
    v_accvgpr_read_b32 v203, a179
    v_accvgpr_read_b32 v204, a180
    v_accvgpr_read_b32 v205, a181
    v_accvgpr_read_b32 v206, a182
    v_accvgpr_read_b32 v207, a183
    v_pk_mul_f32 v[200:201], v[252:253], v[200:201]
    v_pk_mul_f32 v[202:203], v[252:253], v[202:203]
    v_pk_mul_f32 v[204:205], v[252:253], v[204:205]
    v_pk_mul_f32 v[206:207], v[252:253], v[206:207]
    v_cvt_pk_bf16_f32 v224, v200, v201
    v_cvt_pk_bf16_f32 v225, v202, v203
    v_cvt_pk_bf16_f32 v226, v204, v205
    v_cvt_pk_bf16_f32 v227, v206, v207
    ds_write_b128 v234, v[224:227] offset:4096
    v_accvgpr_read_b32 v208, a184
    v_accvgpr_read_b32 v209, a185
    v_accvgpr_read_b32 v210, a186
    v_accvgpr_read_b32 v211, a187
    v_accvgpr_read_b32 v212, a188
    v_accvgpr_read_b32 v213, a189
    v_accvgpr_read_b32 v214, a190
    v_accvgpr_read_b32 v215, a191
    v_pk_mul_f32 v[208:209], v[252:253], v[208:209]
    v_pk_mul_f32 v[210:211], v[252:253], v[210:211]
    v_pk_mul_f32 v[212:213], v[252:253], v[212:213]
    v_pk_mul_f32 v[214:215], v[252:253], v[214:215]
    v_cvt_pk_bf16_f32 v228, v208, v209
    v_cvt_pk_bf16_f32 v229, v210, v211
    v_cvt_pk_bf16_f32 v230, v212, v213
    v_cvt_pk_bf16_f32 v231, v214, v215
    ds_write_b128 v235, v[228:231] offset:4096
    ds_read_b128 v[200:203], v16 offset:4096
    ds_read_b128 v[204:207], v16 offset:5120
    ds_read_b128 v[208:211], v16 offset:6144
    ds_read_b128 v[212:215], v16 offset:7168
    s_waitcnt lgkmcnt(3)
    buffer_store_dwordx4 v[200:203], v240, s[24:27], s41 offen offset:0 nt
    s_waitcnt lgkmcnt(2)
    buffer_store_dwordx4 v[204:207], v241, s[24:27], s41 offen offset:1024 nt
    s_waitcnt lgkmcnt(1)
    buffer_store_dwordx4 v[208:211], v242, s[24:27], s41 offen offset:2048 nt
    s_waitcnt lgkmcnt(0)
    buffer_store_dwordx4 v[212:215], v243, s[24:27], s41 offen offset:3072 nt
L_end:
    s_endpgm
L_tr1:
    s_call_b64 s[30:31], L_h011
    s_branch L_bk1
L_tr2:
    s_call_b64 s[30:31], L_h000
    s_branch L_bk2
L_tr4:
    s_call_b64 s[30:31], L_h000
    s_branch L_bk4
L_tr5:
    s_call_b64 s[30:31], L_h110
    s_branch L_bk5
L_tr6:
    s_call_b64 s[30:31], L_h000
    s_branch L_bk6
L_tr7:
    s_call_b64 s[30:31], L_h110
    s_branch L_bk7
L_tr8:
    s_call_b64 s[30:31], L_h000
    s_branch L_bk8
L_tr9:
    s_call_b64 s[30:31], L_h110
    s_branch L_bk9
L_tr10:
    s_call_b64 s[30:31], L_h000
    s_branch L_bk10
L_tr11:
    s_call_b64 s[30:31], L_h110
    s_branch L_bk11
L_tr12:
    s_call_b64 s[30:31], L_h000
    s_branch L_bk12
L_tr13:
    s_call_b64 s[30:31], L_h110
    s_branch L_bk13
L_tr14:
    s_call_b64 s[30:31], L_h000
    s_branch L_bk14
L_tr15:
    s_call_b64 s[30:31], L_h110
    s_branch L_bk15
L_tr17:
    s_call_b64 s[30:31], L_h010
    s_branch L_bk17
L_tr18:
    s_call_b64 s[30:31], L_h100
    s_branch L_bk18
L_tr19:
    s_call_b64 s[30:31], L_h210
    s_branch L_bk19
L_tr20:
    s_call_b64 s[30:31], L_h000
    s_branch L_bk20
L_tr21:
    s_call_b64 s[30:31], L_h110
    s_branch L_bk21
L_tr22:
    s_call_b64 s[30:31], L_h200
    s_branch L_bk22
L_tr23:
    s_call_b64 s[30:31], L_h010
    s_branch L_bk23
L_tr24:
    s_call_b64 s[30:31], L_h100
    s_branch L_bk24
L_tr25:
    s_call_b64 s[30:31], L_h210
    s_branch L_bk25
L_tr26:
    s_call_b64 s[30:31], L_h000
    s_branch L_bk26
L_tr27:
    s_call_b64 s[30:31], L_h110
    s_branch L_bk27
L_tr28:
    s_call_b64 s[30:31], L_h200
    s_branch L_bk28
L_tr29:
    s_call_b64 s[30:31], L_h010
    s_branch L_bk29
L_tr30:
    s_call_b64 s[30:31], L_h100
    s_branch L_bk30
L_tr31:
    s_call_b64 s[30:31], L_h210
    s_branch L_bk31
L_tr32:
    s_call_b64 s[30:31], L_h000
    s_branch L_bk32
L_tr33:
    s_call_b64 s[30:31], L_h110
    s_branch L_bk33
L_tr34:
    s_call_b64 s[30:31], L_h200
    s_branch L_bk34
L_tr35:
    s_call_b64 s[30:31], L_h010
    s_branch L_bk35
L_tr36:
    s_call_b64 s[30:31], L_h100
    s_branch L_bk36
L_tr37:
    s_call_b64 s[30:31], L_h210
    s_branch L_bk37
L_tr38:
    s_call_b64 s[30:31], L_h100
    s_branch L_bk38
L_tr39:
    s_call_b64 s[30:31], L_h210
    s_branch L_bk39
L_tr40:
    s_call_b64 s[30:31], L_h100
    s_branch L_bk40
L_tr41:
    s_call_b64 s[30:31], L_h211
    s_branch L_bk41
L_tr42:
    s_call_b64 s[30:31], L_h201
    s_branch L_bk42
L_tr43:
    s_call_b64 s[30:31], L_h211
    s_branch L_bk43
L_tr44:
    s_call_b64 s[30:31], L_h201
    s_branch L_bk44
L_tr45:
    s_call_b64 s[30:31], L_h211
    s_branch L_bk45
L_tr46:
    s_call_b64 s[30:31], L_h201
    s_branch L_bk46
L_tr47:
    s_call_b64 s[30:31], L_h210
    s_branch L_bk47
L_h000:
    s_nop 15
    s_nop 15
    v_max3_f32 v25, v40, v41, 0
    v_max3_f32 v25, v25, v42, v43
    v_max3_f32 v25, v25, v44, v45
    v_max3_f32 v25, v25, v46, v47
    v_max3_f32 v25, v25, v48, v49
    v_max3_f32 v25, v25, v50, v51
    v_max3_f32 v25, v25, v52, v53
    v_max3_f32 v25, v25, v54, v55
    v_mov_b32 v26, v25
    s_nop 1
    v_permlane32_swap_b32 v25, v26
    s_nop 1
    v_max_f32 v25, v25, v26
    v_sub_f32 v26, 0, v25
    v_exp_f32 v26, v26
    v_sub_f32 v88, v88, v25
    v_sub_f32 v89, v89, v25
    v_sub_f32 v90, v90, v25
    v_sub_f32 v91, v91, v25
    v_sub_f32 v92, v92, v25
    v_sub_f32 v93, v93, v25
    v_sub_f32 v94, v94, v25
    v_sub_f32 v95, v95, v25
    v_sub_f32 v96, v96, v25
    v_sub_f32 v97, v97, v25
    v_sub_f32 v98, v98, v25
    v_sub_f32 v99, v99, v25
    v_sub_f32 v100, v100, v25
    v_sub_f32 v101, v101, v25
    v_sub_f32 v102, v102, v25
    v_sub_f32 v103, v103, v25
    v_sub_f32 v40, v40, v25
    v_sub_f32 v41, v41, v25
    v_sub_f32 v42, v42, v25
    v_sub_f32 v43, v43, v25
    v_sub_f32 v44, v44, v25
    v_sub_f32 v45, v45, v25
    v_sub_f32 v46, v46, v25
    v_sub_f32 v47, v47, v25
    v_sub_f32 v48, v48, v25
    v_sub_f32 v49, v49, v25
    v_sub_f32 v50, v50, v25
    v_sub_f32 v51, v51, v25
    v_sub_f32 v52, v52, v25
    v_sub_f32 v53, v53, v25
    v_sub_f32 v54, v54, v25
    v_sub_f32 v55, v55, v25
    v_mul_f32 v17, v17, v26
    v_accvgpr_read_b32 v27, a0
    v_mul_f32 v27, v27, v26
    v_accvgpr_write_b32 a0, v27
    v_accvgpr_read_b32 v27, a1
    v_mul_f32 v27, v27, v26
    v_accvgpr_write_b32 a1, v27
    v_accvgpr_read_b32 v27, a2
    v_mul_f32 v27, v27, v26
    v_accvgpr_write_b32 a2, v27
    v_accvgpr_read_b32 v27, a3
    v_mul_f32 v27, v27, v26
    v_accvgpr_write_b32 a3, v27
    v_accvgpr_read_b32 v27, a4
    v_mul_f32 v27, v27, v26
    v_accvgpr_write_b32 a4, v27
    v_accvgpr_read_b32 v27, a5
    v_mul_f32 v27, v27, v26
    v_accvgpr_write_b32 a5, v27
    v_accvgpr_read_b32 v27, a6
    v_mul_f32 v27, v27, v26
    v_accvgpr_write_b32 a6, v27
    v_accvgpr_read_b32 v27, a7
    v_mul_f32 v27, v27, v26
    v_accvgpr_write_b32 a7, v27
    v_accvgpr_read_b32 v27, a8
    v_mul_f32 v27, v27, v26
    v_accvgpr_write_b32 a8, v27
    v_accvgpr_read_b32 v27, a9
    v_mul_f32 v27, v27, v26
    v_accvgpr_write_b32 a9, v27
    v_accvgpr_read_b32 v27, a10
    v_mul_f32 v27, v27, v26
    v_accvgpr_write_b32 a10, v27
    v_accvgpr_read_b32 v27, a11
    v_mul_f32 v27, v27, v26
    v_accvgpr_write_b32 a11, v27
    v_accvgpr_read_b32 v27, a12
    v_mul_f32 v27, v27, v26
    v_accvgpr_write_b32 a12, v27
    v_accvgpr_read_b32 v27, a13
    v_mul_f32 v27, v27, v26
    v_accvgpr_write_b32 a13, v27
    v_accvgpr_read_b32 v27, a14
    v_mul_f32 v27, v27, v26
    v_accvgpr_write_b32 a14, v27
    v_accvgpr_read_b32 v27, a15
    v_mul_f32 v27, v27, v26
    v_accvgpr_write_b32 a15, v27
    v_accvgpr_read_b32 v27, a16
    v_mul_f32 v27, v27, v26
    v_accvgpr_write_b32 a16, v27
    v_accvgpr_read_b32 v27, a17
    v_mul_f32 v27, v27, v26
    v_accvgpr_write_b32 a17, v27
    v_accvgpr_read_b32 v27, a18
    v_mul_f32 v27, v27, v26
    v_accvgpr_write_b32 a18, v27
    v_accvgpr_read_b32 v27, a19
    v_mul_f32 v27, v27, v26
    v_accvgpr_write_b32 a19, v27
    v_accvgpr_read_b32 v27, a20
    v_mul_f32 v27, v27, v26
    v_accvgpr_write_b32 a20, v27
    v_accvgpr_read_b32 v27, a21
    v_mul_f32 v27, v27, v26
    v_accvgpr_write_b32 a21, v27
    v_accvgpr_read_b32 v27, a22
    v_mul_f32 v27, v27, v26
    v_accvgpr_write_b32 a22, v27
    v_accvgpr_read_b32 v27, a23
    v_mul_f32 v27, v27, v26
    v_accvgpr_write_b32 a23, v27
    v_accvgpr_read_b32 v27, a24
    v_mul_f32 v27, v27, v26
    v_accvgpr_write_b32 a24, v27
    v_accvgpr_read_b32 v27, a25
    v_mul_f32 v27, v27, v26
    v_accvgpr_write_b32 a25, v27
    v_accvgpr_read_b32 v27, a26
    v_mul_f32 v27, v27, v26
    v_accvgpr_write_b32 a26, v27
    v_accvgpr_read_b32 v27, a27
    v_mul_f32 v27, v27, v26
    v_accvgpr_write_b32 a27, v27
    v_accvgpr_read_b32 v27, a28
    v_mul_f32 v27, v27, v26
    v_accvgpr_write_b32 a28, v27
    v_accvgpr_read_b32 v27, a29
    v_mul_f32 v27, v27, v26
    v_accvgpr_write_b32 a29, v27
    v_accvgpr_read_b32 v27, a30
    v_mul_f32 v27, v27, v26
    v_accvgpr_write_b32 a30, v27
    v_accvgpr_read_b32 v27, a31
    v_mul_f32 v27, v27, v26
    v_accvgpr_write_b32 a31, v27
    v_accvgpr_read_b32 v27, a32
    v_mul_f32 v27, v27, v26
    v_accvgpr_write_b32 a32, v27
    v_accvgpr_read_b32 v27, a33
    v_mul_f32 v27, v27, v26
    v_accvgpr_write_b32 a33, v27
    v_accvgpr_read_b32 v27, a34
    v_mul_f32 v27, v27, v26
    v_accvgpr_write_b32 a34, v27
    v_accvgpr_read_b32 v27, a35
    v_mul_f32 v27, v27, v26
    v_accvgpr_write_b32 a35, v27
    v_accvgpr_read_b32 v27, a36
    v_mul_f32 v27, v27, v26
    v_accvgpr_write_b32 a36, v27
    v_accvgpr_read_b32 v27, a37
    v_mul_f32 v27, v27, v26
    v_accvgpr_write_b32 a37, v27
    v_accvgpr_read_b32 v27, a38
    v_mul_f32 v27, v27, v26
    v_accvgpr_write_b32 a38, v27
    v_accvgpr_read_b32 v27, a39
    v_mul_f32 v27, v27, v26
    v_accvgpr_write_b32 a39, v27
    v_accvgpr_read_b32 v27, a40
    v_mul_f32 v27, v27, v26
    v_accvgpr_write_b32 a40, v27
    v_accvgpr_read_b32 v27, a41
    v_mul_f32 v27, v27, v26
    v_accvgpr_write_b32 a41, v27
    v_accvgpr_read_b32 v27, a42
    v_mul_f32 v27, v27, v26
    v_accvgpr_write_b32 a42, v27
    v_accvgpr_read_b32 v27, a43
    v_mul_f32 v27, v27, v26
    v_accvgpr_write_b32 a43, v27
    v_accvgpr_read_b32 v27, a44
    v_mul_f32 v27, v27, v26
    v_accvgpr_write_b32 a44, v27
    v_accvgpr_read_b32 v27, a45
    v_mul_f32 v27, v27, v26
    v_accvgpr_write_b32 a45, v27
    v_accvgpr_read_b32 v27, a46
    v_mul_f32 v27, v27, v26
    v_accvgpr_write_b32 a46, v27
    v_accvgpr_read_b32 v27, a47
    v_mul_f32 v27, v27, v26
    v_accvgpr_write_b32 a47, v27
    v_accvgpr_read_b32 v27, a48
    v_mul_f32 v27, v27, v26
    v_accvgpr_write_b32 a48, v27
    v_accvgpr_read_b32 v27, a49
    v_mul_f32 v27, v27, v26
    v_accvgpr_write_b32 a49, v27
    v_accvgpr_read_b32 v27, a50
    v_mul_f32 v27, v27, v26
    v_accvgpr_write_b32 a50, v27
    v_accvgpr_read_b32 v27, a51
    v_mul_f32 v27, v27, v26
    v_accvgpr_write_b32 a51, v27
    v_accvgpr_read_b32 v27, a52
    v_mul_f32 v27, v27, v26
    v_accvgpr_write_b32 a52, v27
    v_accvgpr_read_b32 v27, a53
    v_mul_f32 v27, v27, v26
    v_accvgpr_write_b32 a53, v27
    v_accvgpr_read_b32 v27, a54
    v_mul_f32 v27, v27, v26
    v_accvgpr_write_b32 a54, v27
    v_accvgpr_read_b32 v27, a55
    v_mul_f32 v27, v27, v26
    v_accvgpr_write_b32 a55, v27
    v_accvgpr_read_b32 v27, a56
    v_mul_f32 v27, v27, v26
    v_accvgpr_write_b32 a56, v27
    v_accvgpr_read_b32 v27, a57
    v_mul_f32 v27, v27, v26
    v_accvgpr_write_b32 a57, v27
    v_accvgpr_read_b32 v27, a58
    v_mul_f32 v27, v27, v26
    v_accvgpr_write_b32 a58, v27
    v_accvgpr_read_b32 v27, a59
    v_mul_f32 v27, v27, v26
    v_accvgpr_write_b32 a59, v27
    v_accvgpr_read_b32 v27, a60
    v_mul_f32 v27, v27, v26
    v_accvgpr_write_b32 a60, v27
    v_accvgpr_read_b32 v27, a61
    v_mul_f32 v27, v27, v26
    v_accvgpr_write_b32 a61, v27
    v_accvgpr_read_b32 v27, a62
    v_mul_f32 v27, v27, v26
    v_accvgpr_write_b32 a62, v27
    v_accvgpr_read_b32 v27, a63
    v_mul_f32 v27, v27, v26
    v_accvgpr_write_b32 a63, v27
    v_mov_b32 v20, 0
    v_exp_f32 v25, v40
    v_exp_f32 v27, v41
    s_nop 0
    v_add_f32 v20, v20, v25
    v_add_f32 v20, v20, v27
    v_cvt_pk_bf16_f32 v72, v25, v27
    v_exp_f32 v25, v42
    v_exp_f32 v27, v43
    s_nop 0
    v_add_f32 v20, v20, v25
    v_add_f32 v20, v20, v27
    v_cvt_pk_bf16_f32 v73, v25, v27
    v_exp_f32 v25, v44
    v_exp_f32 v27, v45
    s_nop 0
    v_add_f32 v20, v20, v25
    v_add_f32 v20, v20, v27
    v_cvt_pk_bf16_f32 v74, v25, v27
    v_exp_f32 v25, v46
    v_exp_f32 v27, v47
    s_nop 0
    v_add_f32 v20, v20, v25
    v_add_f32 v20, v20, v27
    v_cvt_pk_bf16_f32 v75, v25, v27
    v_exp_f32 v25, v48
    v_exp_f32 v27, v49
    s_nop 0
    v_add_f32 v20, v20, v25
    v_add_f32 v20, v20, v27
    v_cvt_pk_bf16_f32 v76, v25, v27
    v_exp_f32 v25, v50
    v_exp_f32 v27, v51
    s_nop 0
    v_add_f32 v20, v20, v25
    v_add_f32 v20, v20, v27
    v_cvt_pk_bf16_f32 v77, v25, v27
    v_exp_f32 v25, v52
    v_exp_f32 v27, v53
    s_nop 0
    v_add_f32 v20, v20, v25
    v_add_f32 v20, v20, v27
    v_cvt_pk_bf16_f32 v78, v25, v27
    v_exp_f32 v25, v54
    v_exp_f32 v27, v55
    s_nop 0
    v_add_f32 v20, v20, v25
    v_add_f32 v20, v20, v27
    v_cvt_pk_bf16_f32 v79, v25, v27
    s_nop 3
    s_setpc_b64 s[30:31]
L_h010:
    s_nop 15
    s_nop 15
    v_max3_f32 v25, v56, v57, 0
    v_max3_f32 v25, v25, v58, v59
    v_max3_f32 v25, v25, v60, v61
    v_max3_f32 v25, v25, v62, v63
    v_max3_f32 v25, v25, v64, v65
    v_max3_f32 v25, v25, v66, v67
    v_max3_f32 v25, v25, v68, v69
    v_max3_f32 v25, v25, v70, v71
    v_mov_b32 v26, v25
    s_nop 1
    v_permlane32_swap_b32 v25, v26
    s_nop 1
    v_max_f32 v25, v25, v26
    v_sub_f32 v26, 0, v25
    v_exp_f32 v26, v26
    v_sub_f32 v88, v88, v25
    v_sub_f32 v89, v89, v25
    v_sub_f32 v90, v90, v25
    v_sub_f32 v91, v91, v25
    v_sub_f32 v92, v92, v25
    v_sub_f32 v93, v93, v25
    v_sub_f32 v94, v94, v25
    v_sub_f32 v95, v95, v25
    v_sub_f32 v96, v96, v25
    v_sub_f32 v97, v97, v25
    v_sub_f32 v98, v98, v25
    v_sub_f32 v99, v99, v25
    v_sub_f32 v100, v100, v25
    v_sub_f32 v101, v101, v25
    v_sub_f32 v102, v102, v25
    v_sub_f32 v103, v103, v25
    v_sub_f32 v56, v56, v25
    v_sub_f32 v57, v57, v25
    v_sub_f32 v58, v58, v25
    v_sub_f32 v59, v59, v25
    v_sub_f32 v60, v60, v25
    v_sub_f32 v61, v61, v25
    v_sub_f32 v62, v62, v25
    v_sub_f32 v63, v63, v25
    v_sub_f32 v64, v64, v25
    v_sub_f32 v65, v65, v25
    v_sub_f32 v66, v66, v25
    v_sub_f32 v67, v67, v25
    v_sub_f32 v68, v68, v25
    v_sub_f32 v69, v69, v25
    v_sub_f32 v70, v70, v25
    v_sub_f32 v71, v71, v25
    v_mul_f32 v17, v17, v26
    v_accvgpr_read_b32 v27, a0
    v_mul_f32 v27, v27, v26
    v_accvgpr_write_b32 a0, v27
    v_accvgpr_read_b32 v27, a1
    v_mul_f32 v27, v27, v26
    v_accvgpr_write_b32 a1, v27
    v_accvgpr_read_b32 v27, a2
    v_mul_f32 v27, v27, v26
    v_accvgpr_write_b32 a2, v27
    v_accvgpr_read_b32 v27, a3
    v_mul_f32 v27, v27, v26
    v_accvgpr_write_b32 a3, v27
    v_accvgpr_read_b32 v27, a4
    v_mul_f32 v27, v27, v26
    v_accvgpr_write_b32 a4, v27
    v_accvgpr_read_b32 v27, a5
    v_mul_f32 v27, v27, v26
    v_accvgpr_write_b32 a5, v27
    v_accvgpr_read_b32 v27, a6
    v_mul_f32 v27, v27, v26
    v_accvgpr_write_b32 a6, v27
    v_accvgpr_read_b32 v27, a7
    v_mul_f32 v27, v27, v26
    v_accvgpr_write_b32 a7, v27
    v_accvgpr_read_b32 v27, a8
    v_mul_f32 v27, v27, v26
    v_accvgpr_write_b32 a8, v27
    v_accvgpr_read_b32 v27, a9
    v_mul_f32 v27, v27, v26
    v_accvgpr_write_b32 a9, v27
    v_accvgpr_read_b32 v27, a10
    v_mul_f32 v27, v27, v26
    v_accvgpr_write_b32 a10, v27
    v_accvgpr_read_b32 v27, a11
    v_mul_f32 v27, v27, v26
    v_accvgpr_write_b32 a11, v27
    v_accvgpr_read_b32 v27, a12
    v_mul_f32 v27, v27, v26
    v_accvgpr_write_b32 a12, v27
    v_accvgpr_read_b32 v27, a13
    v_mul_f32 v27, v27, v26
    v_accvgpr_write_b32 a13, v27
    v_accvgpr_read_b32 v27, a14
    v_mul_f32 v27, v27, v26
    v_accvgpr_write_b32 a14, v27
    v_accvgpr_read_b32 v27, a15
    v_mul_f32 v27, v27, v26
    v_accvgpr_write_b32 a15, v27
    v_accvgpr_read_b32 v27, a16
    v_mul_f32 v27, v27, v26
    v_accvgpr_write_b32 a16, v27
    v_accvgpr_read_b32 v27, a17
    v_mul_f32 v27, v27, v26
    v_accvgpr_write_b32 a17, v27
    v_accvgpr_read_b32 v27, a18
    v_mul_f32 v27, v27, v26
    v_accvgpr_write_b32 a18, v27
    v_accvgpr_read_b32 v27, a19
    v_mul_f32 v27, v27, v26
    v_accvgpr_write_b32 a19, v27
    v_accvgpr_read_b32 v27, a20
    v_mul_f32 v27, v27, v26
    v_accvgpr_write_b32 a20, v27
    v_accvgpr_read_b32 v27, a21
    v_mul_f32 v27, v27, v26
    v_accvgpr_write_b32 a21, v27
    v_accvgpr_read_b32 v27, a22
    v_mul_f32 v27, v27, v26
    v_accvgpr_write_b32 a22, v27
    v_accvgpr_read_b32 v27, a23
    v_mul_f32 v27, v27, v26
    v_accvgpr_write_b32 a23, v27
    v_accvgpr_read_b32 v27, a24
    v_mul_f32 v27, v27, v26
    v_accvgpr_write_b32 a24, v27
    v_accvgpr_read_b32 v27, a25
    v_mul_f32 v27, v27, v26
    v_accvgpr_write_b32 a25, v27
    v_accvgpr_read_b32 v27, a26
    v_mul_f32 v27, v27, v26
    v_accvgpr_write_b32 a26, v27
    v_accvgpr_read_b32 v27, a27
    v_mul_f32 v27, v27, v26
    v_accvgpr_write_b32 a27, v27
    v_accvgpr_read_b32 v27, a28
    v_mul_f32 v27, v27, v26
    v_accvgpr_write_b32 a28, v27
    v_accvgpr_read_b32 v27, a29
    v_mul_f32 v27, v27, v26
    v_accvgpr_write_b32 a29, v27
    v_accvgpr_read_b32 v27, a30
    v_mul_f32 v27, v27, v26
    v_accvgpr_write_b32 a30, v27
    v_accvgpr_read_b32 v27, a31
    v_mul_f32 v27, v27, v26
    v_accvgpr_write_b32 a31, v27
    v_accvgpr_read_b32 v27, a32
    v_mul_f32 v27, v27, v26
    v_accvgpr_write_b32 a32, v27
    v_accvgpr_read_b32 v27, a33
    v_mul_f32 v27, v27, v26
    v_accvgpr_write_b32 a33, v27
    v_accvgpr_read_b32 v27, a34
    v_mul_f32 v27, v27, v26
    v_accvgpr_write_b32 a34, v27
    v_accvgpr_read_b32 v27, a35
    v_mul_f32 v27, v27, v26
    v_accvgpr_write_b32 a35, v27
    v_accvgpr_read_b32 v27, a36
    v_mul_f32 v27, v27, v26
    v_accvgpr_write_b32 a36, v27
    v_accvgpr_read_b32 v27, a37
    v_mul_f32 v27, v27, v26
    v_accvgpr_write_b32 a37, v27
    v_accvgpr_read_b32 v27, a38
    v_mul_f32 v27, v27, v26
    v_accvgpr_write_b32 a38, v27
    v_accvgpr_read_b32 v27, a39
    v_mul_f32 v27, v27, v26
    v_accvgpr_write_b32 a39, v27
    v_accvgpr_read_b32 v27, a40
    v_mul_f32 v27, v27, v26
    v_accvgpr_write_b32 a40, v27
    v_accvgpr_read_b32 v27, a41
    v_mul_f32 v27, v27, v26
    v_accvgpr_write_b32 a41, v27
    v_accvgpr_read_b32 v27, a42
    v_mul_f32 v27, v27, v26
    v_accvgpr_write_b32 a42, v27
    v_accvgpr_read_b32 v27, a43
    v_mul_f32 v27, v27, v26
    v_accvgpr_write_b32 a43, v27
    v_accvgpr_read_b32 v27, a44
    v_mul_f32 v27, v27, v26
    v_accvgpr_write_b32 a44, v27
    v_accvgpr_read_b32 v27, a45
    v_mul_f32 v27, v27, v26
    v_accvgpr_write_b32 a45, v27
    v_accvgpr_read_b32 v27, a46
    v_mul_f32 v27, v27, v26
    v_accvgpr_write_b32 a46, v27
    v_accvgpr_read_b32 v27, a47
    v_mul_f32 v27, v27, v26
    v_accvgpr_write_b32 a47, v27
    v_accvgpr_read_b32 v27, a48
    v_mul_f32 v27, v27, v26
    v_accvgpr_write_b32 a48, v27
    v_accvgpr_read_b32 v27, a49
    v_mul_f32 v27, v27, v26
    v_accvgpr_write_b32 a49, v27
    v_accvgpr_read_b32 v27, a50
    v_mul_f32 v27, v27, v26
    v_accvgpr_write_b32 a50, v27
    v_accvgpr_read_b32 v27, a51
    v_mul_f32 v27, v27, v26
    v_accvgpr_write_b32 a51, v27
    v_accvgpr_read_b32 v27, a52
    v_mul_f32 v27, v27, v26
    v_accvgpr_write_b32 a52, v27
    v_accvgpr_read_b32 v27, a53
    v_mul_f32 v27, v27, v26
    v_accvgpr_write_b32 a53, v27
    v_accvgpr_read_b32 v27, a54
    v_mul_f32 v27, v27, v26
    v_accvgpr_write_b32 a54, v27
    v_accvgpr_read_b32 v27, a55
    v_mul_f32 v27, v27, v26
    v_accvgpr_write_b32 a55, v27
    v_accvgpr_read_b32 v27, a56
    v_mul_f32 v27, v27, v26
    v_accvgpr_write_b32 a56, v27
    v_accvgpr_read_b32 v27, a57
    v_mul_f32 v27, v27, v26
    v_accvgpr_write_b32 a57, v27
    v_accvgpr_read_b32 v27, a58
    v_mul_f32 v27, v27, v26
    v_accvgpr_write_b32 a58, v27
    v_accvgpr_read_b32 v27, a59
    v_mul_f32 v27, v27, v26
    v_accvgpr_write_b32 a59, v27
    v_accvgpr_read_b32 v27, a60
    v_mul_f32 v27, v27, v26
    v_accvgpr_write_b32 a60, v27
    v_accvgpr_read_b32 v27, a61
    v_mul_f32 v27, v27, v26
    v_accvgpr_write_b32 a61, v27
    v_accvgpr_read_b32 v27, a62
    v_mul_f32 v27, v27, v26
    v_accvgpr_write_b32 a62, v27
    v_accvgpr_read_b32 v27, a63
    v_mul_f32 v27, v27, v26
    v_accvgpr_write_b32 a63, v27
    v_mov_b32 v21, 0
    v_exp_f32 v25, v56
    v_exp_f32 v27, v57
    s_nop 0
    v_add_f32 v21, v21, v25
    v_add_f32 v21, v21, v27
    v_cvt_pk_bf16_f32 v80, v25, v27
    v_exp_f32 v25, v58
    v_exp_f32 v27, v59
    s_nop 0
    v_add_f32 v21, v21, v25
    v_add_f32 v21, v21, v27
    v_cvt_pk_bf16_f32 v81, v25, v27
    v_exp_f32 v25, v60
    v_exp_f32 v27, v61
    s_nop 0
    v_add_f32 v21, v21, v25
    v_add_f32 v21, v21, v27
    v_cvt_pk_bf16_f32 v82, v25, v27
    v_exp_f32 v25, v62
    v_exp_f32 v27, v63
    s_nop 0
    v_add_f32 v21, v21, v25
    v_add_f32 v21, v21, v27
    v_cvt_pk_bf16_f32 v83, v25, v27
    v_exp_f32 v25, v64
    v_exp_f32 v27, v65
    s_nop 0
    v_add_f32 v21, v21, v25
    v_add_f32 v21, v21, v27
    v_cvt_pk_bf16_f32 v84, v25, v27
    v_exp_f32 v25, v66
    v_exp_f32 v27, v67
    s_nop 0
    v_add_f32 v21, v21, v25
    v_add_f32 v21, v21, v27
    v_cvt_pk_bf16_f32 v85, v25, v27
    v_exp_f32 v25, v68
    v_exp_f32 v27, v69
    s_nop 0
    v_add_f32 v21, v21, v25
    v_add_f32 v21, v21, v27
    v_cvt_pk_bf16_f32 v86, v25, v27
    v_exp_f32 v25, v70
    v_exp_f32 v27, v71
    s_nop 0
    v_add_f32 v21, v21, v25
    v_add_f32 v21, v21, v27
    v_cvt_pk_bf16_f32 v87, v25, v27
    s_nop 3
    s_setpc_b64 s[30:31]
L_h011:
    s_nop 15
    s_nop 15
    v_max3_f32 v25, v56, v57, 0
    v_max3_f32 v25, v25, v58, v59
    v_max3_f32 v25, v25, v60, v61
    v_max3_f32 v25, v25, v62, v63
    v_max3_f32 v25, v25, v64, v65
    v_max3_f32 v25, v25, v66, v67
    v_max3_f32 v25, v25, v68, v69
    v_max3_f32 v25, v25, v70, v71
    v_mov_b32 v26, v25
    s_nop 1
    v_permlane32_swap_b32 v25, v26
    s_nop 1
    v_max_f32 v25, v25, v26
    v_sub_f32 v26, 0, v25
    v_exp_f32 v26, v26
    v_sub_f32 v88, v88, v25
    v_sub_f32 v89, v89, v25
    v_sub_f32 v90, v90, v25
    v_sub_f32 v91, v91, v25
    v_sub_f32 v92, v92, v25
    v_sub_f32 v93, v93, v25
    v_sub_f32 v94, v94, v25
    v_sub_f32 v95, v95, v25
    v_sub_f32 v96, v96, v25
    v_sub_f32 v97, v97, v25
    v_sub_f32 v98, v98, v25
    v_sub_f32 v99, v99, v25
    v_sub_f32 v100, v100, v25
    v_sub_f32 v101, v101, v25
    v_sub_f32 v102, v102, v25
    v_sub_f32 v103, v103, v25
    v_sub_f32 v56, v56, v25
    v_sub_f32 v57, v57, v25
    v_sub_f32 v58, v58, v25
    v_sub_f32 v59, v59, v25
    v_sub_f32 v60, v60, v25
    v_sub_f32 v61, v61, v25
    v_sub_f32 v62, v62, v25
    v_sub_f32 v63, v63, v25
    v_sub_f32 v64, v64, v25
    v_sub_f32 v65, v65, v25
    v_sub_f32 v66, v66, v25
    v_sub_f32 v67, v67, v25
    v_sub_f32 v68, v68, v25
    v_sub_f32 v69, v69, v25
    v_sub_f32 v70, v70, v25
    v_sub_f32 v71, v71, v25
    v_sub_f32 v40, v40, v25
    v_sub_f32 v41, v41, v25
    v_sub_f32 v42, v42, v25
    v_sub_f32 v43, v43, v25
    v_sub_f32 v44, v44, v25
    v_sub_f32 v45, v45, v25
    v_sub_f32 v46, v46, v25
    v_sub_f32 v47, v47, v25
    v_sub_f32 v48, v48, v25
    v_sub_f32 v49, v49, v25
    v_sub_f32 v50, v50, v25
    v_sub_f32 v51, v51, v25
    v_sub_f32 v52, v52, v25
    v_sub_f32 v53, v53, v25
    v_sub_f32 v54, v54, v25
    v_sub_f32 v55, v55, v25
    v_mul_f32 v17, v17, v26
    v_accvgpr_read_b32 v27, a0
    v_mul_f32 v27, v27, v26
    v_accvgpr_write_b32 a0, v27
    v_accvgpr_read_b32 v27, a1
    v_mul_f32 v27, v27, v26
    v_accvgpr_write_b32 a1, v27
    v_accvgpr_read_b32 v27, a2
    v_mul_f32 v27, v27, v26
    v_accvgpr_write_b32 a2, v27
    v_accvgpr_read_b32 v27, a3
    v_mul_f32 v27, v27, v26
    v_accvgpr_write_b32 a3, v27
    v_accvgpr_read_b32 v27, a4
    v_mul_f32 v27, v27, v26
    v_accvgpr_write_b32 a4, v27
    v_accvgpr_read_b32 v27, a5
    v_mul_f32 v27, v27, v26
    v_accvgpr_write_b32 a5, v27
    v_accvgpr_read_b32 v27, a6
    v_mul_f32 v27, v27, v26
    v_accvgpr_write_b32 a6, v27
    v_accvgpr_read_b32 v27, a7
    v_mul_f32 v27, v27, v26
    v_accvgpr_write_b32 a7, v27
    v_accvgpr_read_b32 v27, a8
    v_mul_f32 v27, v27, v26
    v_accvgpr_write_b32 a8, v27
    v_accvgpr_read_b32 v27, a9
    v_mul_f32 v27, v27, v26
    v_accvgpr_write_b32 a9, v27
    v_accvgpr_read_b32 v27, a10
    v_mul_f32 v27, v27, v26
    v_accvgpr_write_b32 a10, v27
    v_accvgpr_read_b32 v27, a11
    v_mul_f32 v27, v27, v26
    v_accvgpr_write_b32 a11, v27
    v_accvgpr_read_b32 v27, a12
    v_mul_f32 v27, v27, v26
    v_accvgpr_write_b32 a12, v27
    v_accvgpr_read_b32 v27, a13
    v_mul_f32 v27, v27, v26
    v_accvgpr_write_b32 a13, v27
    v_accvgpr_read_b32 v27, a14
    v_mul_f32 v27, v27, v26
    v_accvgpr_write_b32 a14, v27
    v_accvgpr_read_b32 v27, a15
    v_mul_f32 v27, v27, v26
    v_accvgpr_write_b32 a15, v27
    v_accvgpr_read_b32 v27, a16
    v_mul_f32 v27, v27, v26
    v_accvgpr_write_b32 a16, v27
    v_accvgpr_read_b32 v27, a17
    v_mul_f32 v27, v27, v26
    v_accvgpr_write_b32 a17, v27
    v_accvgpr_read_b32 v27, a18
    v_mul_f32 v27, v27, v26
    v_accvgpr_write_b32 a18, v27
    v_accvgpr_read_b32 v27, a19
    v_mul_f32 v27, v27, v26
    v_accvgpr_write_b32 a19, v27
    v_accvgpr_read_b32 v27, a20
    v_mul_f32 v27, v27, v26
    v_accvgpr_write_b32 a20, v27
    v_accvgpr_read_b32 v27, a21
    v_mul_f32 v27, v27, v26
    v_accvgpr_write_b32 a21, v27
    v_accvgpr_read_b32 v27, a22
    v_mul_f32 v27, v27, v26
    v_accvgpr_write_b32 a22, v27
    v_accvgpr_read_b32 v27, a23
    v_mul_f32 v27, v27, v26
    v_accvgpr_write_b32 a23, v27
    v_accvgpr_read_b32 v27, a24
    v_mul_f32 v27, v27, v26
    v_accvgpr_write_b32 a24, v27
    v_accvgpr_read_b32 v27, a25
    v_mul_f32 v27, v27, v26
    v_accvgpr_write_b32 a25, v27
    v_accvgpr_read_b32 v27, a26
    v_mul_f32 v27, v27, v26
    v_accvgpr_write_b32 a26, v27
    v_accvgpr_read_b32 v27, a27
    v_mul_f32 v27, v27, v26
    v_accvgpr_write_b32 a27, v27
    v_accvgpr_read_b32 v27, a28
    v_mul_f32 v27, v27, v26
    v_accvgpr_write_b32 a28, v27
    v_accvgpr_read_b32 v27, a29
    v_mul_f32 v27, v27, v26
    v_accvgpr_write_b32 a29, v27
    v_accvgpr_read_b32 v27, a30
    v_mul_f32 v27, v27, v26
    v_accvgpr_write_b32 a30, v27
    v_accvgpr_read_b32 v27, a31
    v_mul_f32 v27, v27, v26
    v_accvgpr_write_b32 a31, v27
    v_accvgpr_read_b32 v27, a32
    v_mul_f32 v27, v27, v26
    v_accvgpr_write_b32 a32, v27
    v_accvgpr_read_b32 v27, a33
    v_mul_f32 v27, v27, v26
    v_accvgpr_write_b32 a33, v27
    v_accvgpr_read_b32 v27, a34
    v_mul_f32 v27, v27, v26
    v_accvgpr_write_b32 a34, v27
    v_accvgpr_read_b32 v27, a35
    v_mul_f32 v27, v27, v26
    v_accvgpr_write_b32 a35, v27
    v_accvgpr_read_b32 v27, a36
    v_mul_f32 v27, v27, v26
    v_accvgpr_write_b32 a36, v27
    v_accvgpr_read_b32 v27, a37
    v_mul_f32 v27, v27, v26
    v_accvgpr_write_b32 a37, v27
    v_accvgpr_read_b32 v27, a38
    v_mul_f32 v27, v27, v26
    v_accvgpr_write_b32 a38, v27
    v_accvgpr_read_b32 v27, a39
    v_mul_f32 v27, v27, v26
    v_accvgpr_write_b32 a39, v27
    v_accvgpr_read_b32 v27, a40
    v_mul_f32 v27, v27, v26
    v_accvgpr_write_b32 a40, v27
    v_accvgpr_read_b32 v27, a41
    v_mul_f32 v27, v27, v26
    v_accvgpr_write_b32 a41, v27
    v_accvgpr_read_b32 v27, a42
    v_mul_f32 v27, v27, v26
    v_accvgpr_write_b32 a42, v27
    v_accvgpr_read_b32 v27, a43
    v_mul_f32 v27, v27, v26
    v_accvgpr_write_b32 a43, v27
    v_accvgpr_read_b32 v27, a44
    v_mul_f32 v27, v27, v26
    v_accvgpr_write_b32 a44, v27
    v_accvgpr_read_b32 v27, a45
    v_mul_f32 v27, v27, v26
    v_accvgpr_write_b32 a45, v27
    v_accvgpr_read_b32 v27, a46
    v_mul_f32 v27, v27, v26
    v_accvgpr_write_b32 a46, v27
    v_accvgpr_read_b32 v27, a47
    v_mul_f32 v27, v27, v26
    v_accvgpr_write_b32 a47, v27
    v_accvgpr_read_b32 v27, a48
    v_mul_f32 v27, v27, v26
    v_accvgpr_write_b32 a48, v27
    v_accvgpr_read_b32 v27, a49
    v_mul_f32 v27, v27, v26
    v_accvgpr_write_b32 a49, v27
    v_accvgpr_read_b32 v27, a50
    v_mul_f32 v27, v27, v26
    v_accvgpr_write_b32 a50, v27
    v_accvgpr_read_b32 v27, a51
    v_mul_f32 v27, v27, v26
    v_accvgpr_write_b32 a51, v27
    v_accvgpr_read_b32 v27, a52
    v_mul_f32 v27, v27, v26
    v_accvgpr_write_b32 a52, v27
    v_accvgpr_read_b32 v27, a53
    v_mul_f32 v27, v27, v26
    v_accvgpr_write_b32 a53, v27
    v_accvgpr_read_b32 v27, a54
    v_mul_f32 v27, v27, v26
    v_accvgpr_write_b32 a54, v27
    v_accvgpr_read_b32 v27, a55
    v_mul_f32 v27, v27, v26
    v_accvgpr_write_b32 a55, v27
    v_accvgpr_read_b32 v27, a56
    v_mul_f32 v27, v27, v26
    v_accvgpr_write_b32 a56, v27
    v_accvgpr_read_b32 v27, a57
    v_mul_f32 v27, v27, v26
    v_accvgpr_write_b32 a57, v27
    v_accvgpr_read_b32 v27, a58
    v_mul_f32 v27, v27, v26
    v_accvgpr_write_b32 a58, v27
    v_accvgpr_read_b32 v27, a59
    v_mul_f32 v27, v27, v26
    v_accvgpr_write_b32 a59, v27
    v_accvgpr_read_b32 v27, a60
    v_mul_f32 v27, v27, v26
    v_accvgpr_write_b32 a60, v27
    v_accvgpr_read_b32 v27, a61
    v_mul_f32 v27, v27, v26
    v_accvgpr_write_b32 a61, v27
    v_accvgpr_read_b32 v27, a62
    v_mul_f32 v27, v27, v26
    v_accvgpr_write_b32 a62, v27
    v_accvgpr_read_b32 v27, a63
    v_mul_f32 v27, v27, v26
    v_accvgpr_write_b32 a63, v27
    v_mov_b32 v21, 0
    v_exp_f32 v25, v56
    v_exp_f32 v27, v57
    s_nop 0
    v_add_f32 v21, v21, v25
    v_add_f32 v21, v21, v27
    v_cvt_pk_bf16_f32 v80, v25, v27
    v_exp_f32 v25, v58
    v_exp_f32 v27, v59
    s_nop 0
    v_add_f32 v21, v21, v25
    v_add_f32 v21, v21, v27
    v_cvt_pk_bf16_f32 v81, v25, v27
    v_exp_f32 v25, v60
    v_exp_f32 v27, v61
    s_nop 0
    v_add_f32 v21, v21, v25
    v_add_f32 v21, v21, v27
    v_cvt_pk_bf16_f32 v82, v25, v27
    v_exp_f32 v25, v62
    v_exp_f32 v27, v63
    s_nop 0
    v_add_f32 v21, v21, v25
    v_add_f32 v21, v21, v27
    v_cvt_pk_bf16_f32 v83, v25, v27
    v_exp_f32 v25, v64
    v_exp_f32 v27, v65
    s_nop 0
    v_add_f32 v21, v21, v25
    v_add_f32 v21, v21, v27
    v_cvt_pk_bf16_f32 v84, v25, v27
    v_exp_f32 v25, v66
    v_exp_f32 v27, v67
    s_nop 0
    v_add_f32 v21, v21, v25
    v_add_f32 v21, v21, v27
    v_cvt_pk_bf16_f32 v85, v25, v27
    v_exp_f32 v25, v68
    v_exp_f32 v27, v69
    s_nop 0
    v_add_f32 v21, v21, v25
    v_add_f32 v21, v21, v27
    v_cvt_pk_bf16_f32 v86, v25, v27
    v_exp_f32 v25, v70
    v_exp_f32 v27, v71
    s_nop 0
    v_add_f32 v21, v21, v25
    v_add_f32 v21, v21, v27
    v_cvt_pk_bf16_f32 v87, v25, v27
    s_nop 3
    s_setpc_b64 s[30:31]
L_h100:
    s_nop 15
    s_nop 15
    v_max3_f32 v25, v40, v41, 0
    v_max3_f32 v25, v25, v42, v43
    v_max3_f32 v25, v25, v44, v45
    v_max3_f32 v25, v25, v46, v47
    v_max3_f32 v25, v25, v48, v49
    v_max3_f32 v25, v25, v50, v51
    v_max3_f32 v25, v25, v52, v53
    v_max3_f32 v25, v25, v54, v55
    v_mov_b32 v26, v25
    s_nop 1
    v_permlane32_swap_b32 v25, v26
    s_nop 1
    v_max_f32 v25, v25, v26
    v_sub_f32 v26, 0, v25
    v_exp_f32 v26, v26
    v_sub_f32 v104, v104, v25
    v_sub_f32 v105, v105, v25
    v_sub_f32 v106, v106, v25
    v_sub_f32 v107, v107, v25
    v_sub_f32 v108, v108, v25
    v_sub_f32 v109, v109, v25
    v_sub_f32 v110, v110, v25
    v_sub_f32 v111, v111, v25
    v_sub_f32 v112, v112, v25
    v_sub_f32 v113, v113, v25
    v_sub_f32 v114, v114, v25
    v_sub_f32 v115, v115, v25
    v_sub_f32 v116, v116, v25
    v_sub_f32 v117, v117, v25
    v_sub_f32 v118, v118, v25
    v_sub_f32 v119, v119, v25
    v_sub_f32 v40, v40, v25
    v_sub_f32 v41, v41, v25
    v_sub_f32 v42, v42, v25
    v_sub_f32 v43, v43, v25
    v_sub_f32 v44, v44, v25
    v_sub_f32 v45, v45, v25
    v_sub_f32 v46, v46, v25
    v_sub_f32 v47, v47, v25
    v_sub_f32 v48, v48, v25
    v_sub_f32 v49, v49, v25
    v_sub_f32 v50, v50, v25
    v_sub_f32 v51, v51, v25
    v_sub_f32 v52, v52, v25
    v_sub_f32 v53, v53, v25
    v_sub_f32 v54, v54, v25
    v_sub_f32 v55, v55, v25
    v_mul_f32 v18, v18, v26
    v_accvgpr_read_b32 v27, a64
    v_mul_f32 v27, v27, v26
    v_accvgpr_write_b32 a64, v27
    v_accvgpr_read_b32 v27, a65
    v_mul_f32 v27, v27, v26
    v_accvgpr_write_b32 a65, v27
    v_accvgpr_read_b32 v27, a66
    v_mul_f32 v27, v27, v26
    v_accvgpr_write_b32 a66, v27
    v_accvgpr_read_b32 v27, a67
    v_mul_f32 v27, v27, v26
    v_accvgpr_write_b32 a67, v27
    v_accvgpr_read_b32 v27, a68
    v_mul_f32 v27, v27, v26
    v_accvgpr_write_b32 a68, v27
    v_accvgpr_read_b32 v27, a69
    v_mul_f32 v27, v27, v26
    v_accvgpr_write_b32 a69, v27
    v_accvgpr_read_b32 v27, a70
    v_mul_f32 v27, v27, v26
    v_accvgpr_write_b32 a70, v27
    v_accvgpr_read_b32 v27, a71
    v_mul_f32 v27, v27, v26
    v_accvgpr_write_b32 a71, v27
    v_accvgpr_read_b32 v27, a72
    v_mul_f32 v27, v27, v26
    v_accvgpr_write_b32 a72, v27
    v_accvgpr_read_b32 v27, a73
    v_mul_f32 v27, v27, v26
    v_accvgpr_write_b32 a73, v27
    v_accvgpr_read_b32 v27, a74
    v_mul_f32 v27, v27, v26
    v_accvgpr_write_b32 a74, v27
    v_accvgpr_read_b32 v27, a75
    v_mul_f32 v27, v27, v26
    v_accvgpr_write_b32 a75, v27
    v_accvgpr_read_b32 v27, a76
    v_mul_f32 v27, v27, v26
    v_accvgpr_write_b32 a76, v27
    v_accvgpr_read_b32 v27, a77
    v_mul_f32 v27, v27, v26
    v_accvgpr_write_b32 a77, v27
    v_accvgpr_read_b32 v27, a78
    v_mul_f32 v27, v27, v26
    v_accvgpr_write_b32 a78, v27
    v_accvgpr_read_b32 v27, a79
    v_mul_f32 v27, v27, v26
    v_accvgpr_write_b32 a79, v27
    v_accvgpr_read_b32 v27, a80
    v_mul_f32 v27, v27, v26
    v_accvgpr_write_b32 a80, v27
    v_accvgpr_read_b32 v27, a81
    v_mul_f32 v27, v27, v26
    v_accvgpr_write_b32 a81, v27
    v_accvgpr_read_b32 v27, a82
    v_mul_f32 v27, v27, v26
    v_accvgpr_write_b32 a82, v27
    v_accvgpr_read_b32 v27, a83
    v_mul_f32 v27, v27, v26
    v_accvgpr_write_b32 a83, v27
    v_accvgpr_read_b32 v27, a84
    v_mul_f32 v27, v27, v26
    v_accvgpr_write_b32 a84, v27
    v_accvgpr_read_b32 v27, a85
    v_mul_f32 v27, v27, v26
    v_accvgpr_write_b32 a85, v27
    v_accvgpr_read_b32 v27, a86
    v_mul_f32 v27, v27, v26
    v_accvgpr_write_b32 a86, v27
    v_accvgpr_read_b32 v27, a87
    v_mul_f32 v27, v27, v26
    v_accvgpr_write_b32 a87, v27
    v_accvgpr_read_b32 v27, a88
    v_mul_f32 v27, v27, v26
    v_accvgpr_write_b32 a88, v27
    v_accvgpr_read_b32 v27, a89
    v_mul_f32 v27, v27, v26
    v_accvgpr_write_b32 a89, v27
    v_accvgpr_read_b32 v27, a90
    v_mul_f32 v27, v27, v26
    v_accvgpr_write_b32 a90, v27
    v_accvgpr_read_b32 v27, a91
    v_mul_f32 v27, v27, v26
    v_accvgpr_write_b32 a91, v27
    v_accvgpr_read_b32 v27, a92
    v_mul_f32 v27, v27, v26
    v_accvgpr_write_b32 a92, v27
    v_accvgpr_read_b32 v27, a93
    v_mul_f32 v27, v27, v26
    v_accvgpr_write_b32 a93, v27
    v_accvgpr_read_b32 v27, a94
    v_mul_f32 v27, v27, v26
    v_accvgpr_write_b32 a94, v27
    v_accvgpr_read_b32 v27, a95
    v_mul_f32 v27, v27, v26
    v_accvgpr_write_b32 a95, v27
    v_accvgpr_read_b32 v27, a96
    v_mul_f32 v27, v27, v26
    v_accvgpr_write_b32 a96, v27
    v_accvgpr_read_b32 v27, a97
    v_mul_f32 v27, v27, v26
    v_accvgpr_write_b32 a97, v27
    v_accvgpr_read_b32 v27, a98
    v_mul_f32 v27, v27, v26
    v_accvgpr_write_b32 a98, v27
    v_accvgpr_read_b32 v27, a99
    v_mul_f32 v27, v27, v26
    v_accvgpr_write_b32 a99, v27
    v_accvgpr_read_b32 v27, a100
    v_mul_f32 v27, v27, v26
    v_accvgpr_write_b32 a100, v27
    v_accvgpr_read_b32 v27, a101
    v_mul_f32 v27, v27, v26
    v_accvgpr_write_b32 a101, v27
    v_accvgpr_read_b32 v27, a102
    v_mul_f32 v27, v27, v26
    v_accvgpr_write_b32 a102, v27
    v_accvgpr_read_b32 v27, a103
    v_mul_f32 v27, v27, v26
    v_accvgpr_write_b32 a103, v27
    v_accvgpr_read_b32 v27, a104
    v_mul_f32 v27, v27, v26
    v_accvgpr_write_b32 a104, v27
    v_accvgpr_read_b32 v27, a105
    v_mul_f32 v27, v27, v26
    v_accvgpr_write_b32 a105, v27
    v_accvgpr_read_b32 v27, a106
    v_mul_f32 v27, v27, v26
    v_accvgpr_write_b32 a106, v27
    v_accvgpr_read_b32 v27, a107
    v_mul_f32 v27, v27, v26
    v_accvgpr_write_b32 a107, v27
    v_accvgpr_read_b32 v27, a108
    v_mul_f32 v27, v27, v26
    v_accvgpr_write_b32 a108, v27
    v_accvgpr_read_b32 v27, a109
    v_mul_f32 v27, v27, v26
    v_accvgpr_write_b32 a109, v27
    v_accvgpr_read_b32 v27, a110
    v_mul_f32 v27, v27, v26
    v_accvgpr_write_b32 a110, v27
    v_accvgpr_read_b32 v27, a111
    v_mul_f32 v27, v27, v26
    v_accvgpr_write_b32 a111, v27
    v_accvgpr_read_b32 v27, a112
    v_mul_f32 v27, v27, v26
    v_accvgpr_write_b32 a112, v27
    v_accvgpr_read_b32 v27, a113
    v_mul_f32 v27, v27, v26
    v_accvgpr_write_b32 a113, v27
    v_accvgpr_read_b32 v27, a114
    v_mul_f32 v27, v27, v26
    v_accvgpr_write_b32 a114, v27
    v_accvgpr_read_b32 v27, a115
    v_mul_f32 v27, v27, v26
    v_accvgpr_write_b32 a115, v27
    v_accvgpr_read_b32 v27, a116
    v_mul_f32 v27, v27, v26
    v_accvgpr_write_b32 a116, v27
    v_accvgpr_read_b32 v27, a117
    v_mul_f32 v27, v27, v26
    v_accvgpr_write_b32 a117, v27
    v_accvgpr_read_b32 v27, a118
    v_mul_f32 v27, v27, v26
    v_accvgpr_write_b32 a118, v27
    v_accvgpr_read_b32 v27, a119
    v_mul_f32 v27, v27, v26
    v_accvgpr_write_b32 a119, v27
    v_accvgpr_read_b32 v27, a120
    v_mul_f32 v27, v27, v26
    v_accvgpr_write_b32 a120, v27
    v_accvgpr_read_b32 v27, a121
    v_mul_f32 v27, v27, v26
    v_accvgpr_write_b32 a121, v27
    v_accvgpr_read_b32 v27, a122
    v_mul_f32 v27, v27, v26
    v_accvgpr_write_b32 a122, v27
    v_accvgpr_read_b32 v27, a123
    v_mul_f32 v27, v27, v26
    v_accvgpr_write_b32 a123, v27
    v_accvgpr_read_b32 v27, a124
    v_mul_f32 v27, v27, v26
    v_accvgpr_write_b32 a124, v27
    v_accvgpr_read_b32 v27, a125
    v_mul_f32 v27, v27, v26
    v_accvgpr_write_b32 a125, v27
    v_accvgpr_read_b32 v27, a126
    v_mul_f32 v27, v27, v26
    v_accvgpr_write_b32 a126, v27
    v_accvgpr_read_b32 v27, a127
    v_mul_f32 v27, v27, v26
    v_accvgpr_write_b32 a127, v27
    v_mov_b32 v20, 0
    v_exp_f32 v25, v40
    v_exp_f32 v27, v41
    s_nop 0
    v_add_f32 v20, v20, v25
    v_add_f32 v20, v20, v27
    v_cvt_pk_bf16_f32 v72, v25, v27
    v_exp_f32 v25, v42
    v_exp_f32 v27, v43
    s_nop 0
    v_add_f32 v20, v20, v25
    v_add_f32 v20, v20, v27
    v_cvt_pk_bf16_f32 v73, v25, v27
    v_exp_f32 v25, v44
    v_exp_f32 v27, v45
    s_nop 0
    v_add_f32 v20, v20, v25
    v_add_f32 v20, v20, v27
    v_cvt_pk_bf16_f32 v74, v25, v27
    v_exp_f32 v25, v46
    v_exp_f32 v27, v47
    s_nop 0
    v_add_f32 v20, v20, v25
    v_add_f32 v20, v20, v27
    v_cvt_pk_bf16_f32 v75, v25, v27
    v_exp_f32 v25, v48
    v_exp_f32 v27, v49
    s_nop 0
    v_add_f32 v20, v20, v25
    v_add_f32 v20, v20, v27
    v_cvt_pk_bf16_f32 v76, v25, v27
    v_exp_f32 v25, v50
    v_exp_f32 v27, v51
    s_nop 0
    v_add_f32 v20, v20, v25
    v_add_f32 v20, v20, v27
    v_cvt_pk_bf16_f32 v77, v25, v27
    v_exp_f32 v25, v52
    v_exp_f32 v27, v53
    s_nop 0
    v_add_f32 v20, v20, v25
    v_add_f32 v20, v20, v27
    v_cvt_pk_bf16_f32 v78, v25, v27
    v_exp_f32 v25, v54
    v_exp_f32 v27, v55
    s_nop 0
    v_add_f32 v20, v20, v25
    v_add_f32 v20, v20, v27
    v_cvt_pk_bf16_f32 v79, v25, v27
    s_nop 3
    s_setpc_b64 s[30:31]
L_h110:
    s_nop 15
    s_nop 15
    v_max3_f32 v25, v56, v57, 0
    v_max3_f32 v25, v25, v58, v59
    v_max3_f32 v25, v25, v60, v61
    v_max3_f32 v25, v25, v62, v63
    v_max3_f32 v25, v25, v64, v65
    v_max3_f32 v25, v25, v66, v67
    v_max3_f32 v25, v25, v68, v69
    v_max3_f32 v25, v25, v70, v71
    v_mov_b32 v26, v25
    s_nop 1
    v_permlane32_swap_b32 v25, v26
    s_nop 1
    v_max_f32 v25, v25, v26
    v_sub_f32 v26, 0, v25
    v_exp_f32 v26, v26
    v_sub_f32 v104, v104, v25
    v_sub_f32 v105, v105, v25
    v_sub_f32 v106, v106, v25
    v_sub_f32 v107, v107, v25
    v_sub_f32 v108, v108, v25
    v_sub_f32 v109, v109, v25
    v_sub_f32 v110, v110, v25
    v_sub_f32 v111, v111, v25
    v_sub_f32 v112, v112, v25
    v_sub_f32 v113, v113, v25
    v_sub_f32 v114, v114, v25
    v_sub_f32 v115, v115, v25
    v_sub_f32 v116, v116, v25
    v_sub_f32 v117, v117, v25
    v_sub_f32 v118, v118, v25
    v_sub_f32 v119, v119, v25
    v_sub_f32 v56, v56, v25
    v_sub_f32 v57, v57, v25
    v_sub_f32 v58, v58, v25
    v_sub_f32 v59, v59, v25
    v_sub_f32 v60, v60, v25
    v_sub_f32 v61, v61, v25
    v_sub_f32 v62, v62, v25
    v_sub_f32 v63, v63, v25
    v_sub_f32 v64, v64, v25
    v_sub_f32 v65, v65, v25
    v_sub_f32 v66, v66, v25
    v_sub_f32 v67, v67, v25
    v_sub_f32 v68, v68, v25
    v_sub_f32 v69, v69, v25
    v_sub_f32 v70, v70, v25
    v_sub_f32 v71, v71, v25
    v_mul_f32 v18, v18, v26
    v_accvgpr_read_b32 v27, a64
    v_mul_f32 v27, v27, v26
    v_accvgpr_write_b32 a64, v27
    v_accvgpr_read_b32 v27, a65
    v_mul_f32 v27, v27, v26
    v_accvgpr_write_b32 a65, v27
    v_accvgpr_read_b32 v27, a66
    v_mul_f32 v27, v27, v26
    v_accvgpr_write_b32 a66, v27
    v_accvgpr_read_b32 v27, a67
    v_mul_f32 v27, v27, v26
    v_accvgpr_write_b32 a67, v27
    v_accvgpr_read_b32 v27, a68
    v_mul_f32 v27, v27, v26
    v_accvgpr_write_b32 a68, v27
    v_accvgpr_read_b32 v27, a69
    v_mul_f32 v27, v27, v26
    v_accvgpr_write_b32 a69, v27
    v_accvgpr_read_b32 v27, a70
    v_mul_f32 v27, v27, v26
    v_accvgpr_write_b32 a70, v27
    v_accvgpr_read_b32 v27, a71
    v_mul_f32 v27, v27, v26
    v_accvgpr_write_b32 a71, v27
    v_accvgpr_read_b32 v27, a72
    v_mul_f32 v27, v27, v26
    v_accvgpr_write_b32 a72, v27
    v_accvgpr_read_b32 v27, a73
    v_mul_f32 v27, v27, v26
    v_accvgpr_write_b32 a73, v27
    v_accvgpr_read_b32 v27, a74
    v_mul_f32 v27, v27, v26
    v_accvgpr_write_b32 a74, v27
    v_accvgpr_read_b32 v27, a75
    v_mul_f32 v27, v27, v26
    v_accvgpr_write_b32 a75, v27
    v_accvgpr_read_b32 v27, a76
    v_mul_f32 v27, v27, v26
    v_accvgpr_write_b32 a76, v27
    v_accvgpr_read_b32 v27, a77
    v_mul_f32 v27, v27, v26
    v_accvgpr_write_b32 a77, v27
    v_accvgpr_read_b32 v27, a78
    v_mul_f32 v27, v27, v26
    v_accvgpr_write_b32 a78, v27
    v_accvgpr_read_b32 v27, a79
    v_mul_f32 v27, v27, v26
    v_accvgpr_write_b32 a79, v27
    v_accvgpr_read_b32 v27, a80
    v_mul_f32 v27, v27, v26
    v_accvgpr_write_b32 a80, v27
    v_accvgpr_read_b32 v27, a81
    v_mul_f32 v27, v27, v26
    v_accvgpr_write_b32 a81, v27
    v_accvgpr_read_b32 v27, a82
    v_mul_f32 v27, v27, v26
    v_accvgpr_write_b32 a82, v27
    v_accvgpr_read_b32 v27, a83
    v_mul_f32 v27, v27, v26
    v_accvgpr_write_b32 a83, v27
    v_accvgpr_read_b32 v27, a84
    v_mul_f32 v27, v27, v26
    v_accvgpr_write_b32 a84, v27
    v_accvgpr_read_b32 v27, a85
    v_mul_f32 v27, v27, v26
    v_accvgpr_write_b32 a85, v27
    v_accvgpr_read_b32 v27, a86
    v_mul_f32 v27, v27, v26
    v_accvgpr_write_b32 a86, v27
    v_accvgpr_read_b32 v27, a87
    v_mul_f32 v27, v27, v26
    v_accvgpr_write_b32 a87, v27
    v_accvgpr_read_b32 v27, a88
    v_mul_f32 v27, v27, v26
    v_accvgpr_write_b32 a88, v27
    v_accvgpr_read_b32 v27, a89
    v_mul_f32 v27, v27, v26
    v_accvgpr_write_b32 a89, v27
    v_accvgpr_read_b32 v27, a90
    v_mul_f32 v27, v27, v26
    v_accvgpr_write_b32 a90, v27
    v_accvgpr_read_b32 v27, a91
    v_mul_f32 v27, v27, v26
    v_accvgpr_write_b32 a91, v27
    v_accvgpr_read_b32 v27, a92
    v_mul_f32 v27, v27, v26
    v_accvgpr_write_b32 a92, v27
    v_accvgpr_read_b32 v27, a93
    v_mul_f32 v27, v27, v26
    v_accvgpr_write_b32 a93, v27
    v_accvgpr_read_b32 v27, a94
    v_mul_f32 v27, v27, v26
    v_accvgpr_write_b32 a94, v27
    v_accvgpr_read_b32 v27, a95
    v_mul_f32 v27, v27, v26
    v_accvgpr_write_b32 a95, v27
    v_accvgpr_read_b32 v27, a96
    v_mul_f32 v27, v27, v26
    v_accvgpr_write_b32 a96, v27
    v_accvgpr_read_b32 v27, a97
    v_mul_f32 v27, v27, v26
    v_accvgpr_write_b32 a97, v27
    v_accvgpr_read_b32 v27, a98
    v_mul_f32 v27, v27, v26
    v_accvgpr_write_b32 a98, v27
    v_accvgpr_read_b32 v27, a99
    v_mul_f32 v27, v27, v26
    v_accvgpr_write_b32 a99, v27
    v_accvgpr_read_b32 v27, a100
    v_mul_f32 v27, v27, v26
    v_accvgpr_write_b32 a100, v27
    v_accvgpr_read_b32 v27, a101
    v_mul_f32 v27, v27, v26
    v_accvgpr_write_b32 a101, v27
    v_accvgpr_read_b32 v27, a102
    v_mul_f32 v27, v27, v26
    v_accvgpr_write_b32 a102, v27
    v_accvgpr_read_b32 v27, a103
    v_mul_f32 v27, v27, v26
    v_accvgpr_write_b32 a103, v27
    v_accvgpr_read_b32 v27, a104
    v_mul_f32 v27, v27, v26
    v_accvgpr_write_b32 a104, v27
    v_accvgpr_read_b32 v27, a105
    v_mul_f32 v27, v27, v26
    v_accvgpr_write_b32 a105, v27
    v_accvgpr_read_b32 v27, a106
    v_mul_f32 v27, v27, v26
    v_accvgpr_write_b32 a106, v27
    v_accvgpr_read_b32 v27, a107
    v_mul_f32 v27, v27, v26
    v_accvgpr_write_b32 a107, v27
    v_accvgpr_read_b32 v27, a108
    v_mul_f32 v27, v27, v26
    v_accvgpr_write_b32 a108, v27
    v_accvgpr_read_b32 v27, a109
    v_mul_f32 v27, v27, v26
    v_accvgpr_write_b32 a109, v27
    v_accvgpr_read_b32 v27, a110
    v_mul_f32 v27, v27, v26
    v_accvgpr_write_b32 a110, v27
    v_accvgpr_read_b32 v27, a111
    v_mul_f32 v27, v27, v26
    v_accvgpr_write_b32 a111, v27
    v_accvgpr_read_b32 v27, a112
    v_mul_f32 v27, v27, v26
    v_accvgpr_write_b32 a112, v27
    v_accvgpr_read_b32 v27, a113
    v_mul_f32 v27, v27, v26
    v_accvgpr_write_b32 a113, v27
    v_accvgpr_read_b32 v27, a114
    v_mul_f32 v27, v27, v26
    v_accvgpr_write_b32 a114, v27
    v_accvgpr_read_b32 v27, a115
    v_mul_f32 v27, v27, v26
    v_accvgpr_write_b32 a115, v27
    v_accvgpr_read_b32 v27, a116
    v_mul_f32 v27, v27, v26
    v_accvgpr_write_b32 a116, v27
    v_accvgpr_read_b32 v27, a117
    v_mul_f32 v27, v27, v26
    v_accvgpr_write_b32 a117, v27
    v_accvgpr_read_b32 v27, a118
    v_mul_f32 v27, v27, v26
    v_accvgpr_write_b32 a118, v27
    v_accvgpr_read_b32 v27, a119
    v_mul_f32 v27, v27, v26
    v_accvgpr_write_b32 a119, v27
    v_accvgpr_read_b32 v27, a120
    v_mul_f32 v27, v27, v26
    v_accvgpr_write_b32 a120, v27
    v_accvgpr_read_b32 v27, a121
    v_mul_f32 v27, v27, v26
    v_accvgpr_write_b32 a121, v27
    v_accvgpr_read_b32 v27, a122
    v_mul_f32 v27, v27, v26
    v_accvgpr_write_b32 a122, v27
    v_accvgpr_read_b32 v27, a123
    v_mul_f32 v27, v27, v26
    v_accvgpr_write_b32 a123, v27
    v_accvgpr_read_b32 v27, a124
    v_mul_f32 v27, v27, v26
    v_accvgpr_write_b32 a124, v27
    v_accvgpr_read_b32 v27, a125
    v_mul_f32 v27, v27, v26
    v_accvgpr_write_b32 a125, v27
    v_accvgpr_read_b32 v27, a126
    v_mul_f32 v27, v27, v26
    v_accvgpr_write_b32 a126, v27
    v_accvgpr_read_b32 v27, a127
    v_mul_f32 v27, v27, v26
    v_accvgpr_write_b32 a127, v27
    v_mov_b32 v21, 0
    v_exp_f32 v25, v56
    v_exp_f32 v27, v57
    s_nop 0
    v_add_f32 v21, v21, v25
    v_add_f32 v21, v21, v27
    v_cvt_pk_bf16_f32 v80, v25, v27
    v_exp_f32 v25, v58
    v_exp_f32 v27, v59
    s_nop 0
    v_add_f32 v21, v21, v25
    v_add_f32 v21, v21, v27
    v_cvt_pk_bf16_f32 v81, v25, v27
    v_exp_f32 v25, v60
    v_exp_f32 v27, v61
    s_nop 0
    v_add_f32 v21, v21, v25
    v_add_f32 v21, v21, v27
    v_cvt_pk_bf16_f32 v82, v25, v27
    v_exp_f32 v25, v62
    v_exp_f32 v27, v63
    s_nop 0
    v_add_f32 v21, v21, v25
    v_add_f32 v21, v21, v27
    v_cvt_pk_bf16_f32 v83, v25, v27
    v_exp_f32 v25, v64
    v_exp_f32 v27, v65
    s_nop 0
    v_add_f32 v21, v21, v25
    v_add_f32 v21, v21, v27
    v_cvt_pk_bf16_f32 v84, v25, v27
    v_exp_f32 v25, v66
    v_exp_f32 v27, v67
    s_nop 0
    v_add_f32 v21, v21, v25
    v_add_f32 v21, v21, v27
    v_cvt_pk_bf16_f32 v85, v25, v27
    v_exp_f32 v25, v68
    v_exp_f32 v27, v69
    s_nop 0
    v_add_f32 v21, v21, v25
    v_add_f32 v21, v21, v27
    v_cvt_pk_bf16_f32 v86, v25, v27
    v_exp_f32 v25, v70
    v_exp_f32 v27, v71
    s_nop 0
    v_add_f32 v21, v21, v25
    v_add_f32 v21, v21, v27
    v_cvt_pk_bf16_f32 v87, v25, v27
    s_nop 3
    s_setpc_b64 s[30:31]
L_h200:
    s_nop 15
    s_nop 15
    v_max3_f32 v25, v40, v41, 0
    v_max3_f32 v25, v25, v42, v43
    v_max3_f32 v25, v25, v44, v45
    v_max3_f32 v25, v25, v46, v47
    v_max3_f32 v25, v25, v48, v49
    v_max3_f32 v25, v25, v50, v51
    v_max3_f32 v25, v25, v52, v53
    v_max3_f32 v25, v25, v54, v55
    v_mov_b32 v26, v25
    s_nop 1
    v_permlane32_swap_b32 v25, v26
    s_nop 1
    v_max_f32 v25, v25, v26
    v_sub_f32 v26, 0, v25
    v_exp_f32 v26, v26
    v_sub_f32 v120, v120, v25
    v_sub_f32 v121, v121, v25
    v_sub_f32 v122, v122, v25
    v_sub_f32 v123, v123, v25
    v_sub_f32 v124, v124, v25
    v_sub_f32 v125, v125, v25
    v_sub_f32 v126, v126, v25
    v_sub_f32 v127, v127, v25
    v_sub_f32 v128, v128, v25
    v_sub_f32 v129, v129, v25
    v_sub_f32 v130, v130, v25
    v_sub_f32 v131, v131, v25
    v_sub_f32 v132, v132, v25
    v_sub_f32 v133, v133, v25
    v_sub_f32 v134, v134, v25
    v_sub_f32 v135, v135, v25
    v_sub_f32 v40, v40, v25
    v_sub_f32 v41, v41, v25
    v_sub_f32 v42, v42, v25
    v_sub_f32 v43, v43, v25
    v_sub_f32 v44, v44, v25
    v_sub_f32 v45, v45, v25
    v_sub_f32 v46, v46, v25
    v_sub_f32 v47, v47, v25
    v_sub_f32 v48, v48, v25
    v_sub_f32 v49, v49, v25
    v_sub_f32 v50, v50, v25
    v_sub_f32 v51, v51, v25
    v_sub_f32 v52, v52, v25
    v_sub_f32 v53, v53, v25
    v_sub_f32 v54, v54, v25
    v_sub_f32 v55, v55, v25
    v_mul_f32 v19, v19, v26
    v_accvgpr_read_b32 v27, a128
    v_mul_f32 v27, v27, v26
    v_accvgpr_write_b32 a128, v27
    v_accvgpr_read_b32 v27, a129
    v_mul_f32 v27, v27, v26
    v_accvgpr_write_b32 a129, v27
    v_accvgpr_read_b32 v27, a130
    v_mul_f32 v27, v27, v26
    v_accvgpr_write_b32 a130, v27
    v_accvgpr_read_b32 v27, a131
    v_mul_f32 v27, v27, v26
    v_accvgpr_write_b32 a131, v27
    v_accvgpr_read_b32 v27, a132
    v_mul_f32 v27, v27, v26
    v_accvgpr_write_b32 a132, v27
    v_accvgpr_read_b32 v27, a133
    v_mul_f32 v27, v27, v26
    v_accvgpr_write_b32 a133, v27
    v_accvgpr_read_b32 v27, a134
    v_mul_f32 v27, v27, v26
    v_accvgpr_write_b32 a134, v27
    v_accvgpr_read_b32 v27, a135
    v_mul_f32 v27, v27, v26
    v_accvgpr_write_b32 a135, v27
    v_accvgpr_read_b32 v27, a136
    v_mul_f32 v27, v27, v26
    v_accvgpr_write_b32 a136, v27
    v_accvgpr_read_b32 v27, a137
    v_mul_f32 v27, v27, v26
    v_accvgpr_write_b32 a137, v27
    v_accvgpr_read_b32 v27, a138
    v_mul_f32 v27, v27, v26
    v_accvgpr_write_b32 a138, v27
    v_accvgpr_read_b32 v27, a139
    v_mul_f32 v27, v27, v26
    v_accvgpr_write_b32 a139, v27
    v_accvgpr_read_b32 v27, a140
    v_mul_f32 v27, v27, v26
    v_accvgpr_write_b32 a140, v27
    v_accvgpr_read_b32 v27, a141
    v_mul_f32 v27, v27, v26
    v_accvgpr_write_b32 a141, v27
    v_accvgpr_read_b32 v27, a142
    v_mul_f32 v27, v27, v26
    v_accvgpr_write_b32 a142, v27
    v_accvgpr_read_b32 v27, a143
    v_mul_f32 v27, v27, v26
    v_accvgpr_write_b32 a143, v27
    v_accvgpr_read_b32 v27, a144
    v_mul_f32 v27, v27, v26
    v_accvgpr_write_b32 a144, v27
    v_accvgpr_read_b32 v27, a145
    v_mul_f32 v27, v27, v26
    v_accvgpr_write_b32 a145, v27
    v_accvgpr_read_b32 v27, a146
    v_mul_f32 v27, v27, v26
    v_accvgpr_write_b32 a146, v27
    v_accvgpr_read_b32 v27, a147
    v_mul_f32 v27, v27, v26
    v_accvgpr_write_b32 a147, v27
    v_accvgpr_read_b32 v27, a148
    v_mul_f32 v27, v27, v26
    v_accvgpr_write_b32 a148, v27
    v_accvgpr_read_b32 v27, a149
    v_mul_f32 v27, v27, v26
    v_accvgpr_write_b32 a149, v27
    v_accvgpr_read_b32 v27, a150
    v_mul_f32 v27, v27, v26
    v_accvgpr_write_b32 a150, v27
    v_accvgpr_read_b32 v27, a151
    v_mul_f32 v27, v27, v26
    v_accvgpr_write_b32 a151, v27
    v_accvgpr_read_b32 v27, a152
    v_mul_f32 v27, v27, v26
    v_accvgpr_write_b32 a152, v27
    v_accvgpr_read_b32 v27, a153
    v_mul_f32 v27, v27, v26
    v_accvgpr_write_b32 a153, v27
    v_accvgpr_read_b32 v27, a154
    v_mul_f32 v27, v27, v26
    v_accvgpr_write_b32 a154, v27
    v_accvgpr_read_b32 v27, a155
    v_mul_f32 v27, v27, v26
    v_accvgpr_write_b32 a155, v27
    v_accvgpr_read_b32 v27, a156
    v_mul_f32 v27, v27, v26
    v_accvgpr_write_b32 a156, v27
    v_accvgpr_read_b32 v27, a157
    v_mul_f32 v27, v27, v26
    v_accvgpr_write_b32 a157, v27
    v_accvgpr_read_b32 v27, a158
    v_mul_f32 v27, v27, v26
    v_accvgpr_write_b32 a158, v27
    v_accvgpr_read_b32 v27, a159
    v_mul_f32 v27, v27, v26
    v_accvgpr_write_b32 a159, v27
    v_accvgpr_read_b32 v27, a160
    v_mul_f32 v27, v27, v26
    v_accvgpr_write_b32 a160, v27
    v_accvgpr_read_b32 v27, a161
    v_mul_f32 v27, v27, v26
    v_accvgpr_write_b32 a161, v27
    v_accvgpr_read_b32 v27, a162
    v_mul_f32 v27, v27, v26
    v_accvgpr_write_b32 a162, v27
    v_accvgpr_read_b32 v27, a163
    v_mul_f32 v27, v27, v26
    v_accvgpr_write_b32 a163, v27
    v_accvgpr_read_b32 v27, a164
    v_mul_f32 v27, v27, v26
    v_accvgpr_write_b32 a164, v27
    v_accvgpr_read_b32 v27, a165
    v_mul_f32 v27, v27, v26
    v_accvgpr_write_b32 a165, v27
    v_accvgpr_read_b32 v27, a166
    v_mul_f32 v27, v27, v26
    v_accvgpr_write_b32 a166, v27
    v_accvgpr_read_b32 v27, a167
    v_mul_f32 v27, v27, v26
    v_accvgpr_write_b32 a167, v27
    v_accvgpr_read_b32 v27, a168
    v_mul_f32 v27, v27, v26
    v_accvgpr_write_b32 a168, v27
    v_accvgpr_read_b32 v27, a169
    v_mul_f32 v27, v27, v26
    v_accvgpr_write_b32 a169, v27
    v_accvgpr_read_b32 v27, a170
    v_mul_f32 v27, v27, v26
    v_accvgpr_write_b32 a170, v27
    v_accvgpr_read_b32 v27, a171
    v_mul_f32 v27, v27, v26
    v_accvgpr_write_b32 a171, v27
    v_accvgpr_read_b32 v27, a172
    v_mul_f32 v27, v27, v26
    v_accvgpr_write_b32 a172, v27
    v_accvgpr_read_b32 v27, a173
    v_mul_f32 v27, v27, v26
    v_accvgpr_write_b32 a173, v27
    v_accvgpr_read_b32 v27, a174
    v_mul_f32 v27, v27, v26
    v_accvgpr_write_b32 a174, v27
    v_accvgpr_read_b32 v27, a175
    v_mul_f32 v27, v27, v26
    v_accvgpr_write_b32 a175, v27
    v_accvgpr_read_b32 v27, a176
    v_mul_f32 v27, v27, v26
    v_accvgpr_write_b32 a176, v27
    v_accvgpr_read_b32 v27, a177
    v_mul_f32 v27, v27, v26
    v_accvgpr_write_b32 a177, v27
    v_accvgpr_read_b32 v27, a178
    v_mul_f32 v27, v27, v26
    v_accvgpr_write_b32 a178, v27
    v_accvgpr_read_b32 v27, a179
    v_mul_f32 v27, v27, v26
    v_accvgpr_write_b32 a179, v27
    v_accvgpr_read_b32 v27, a180
    v_mul_f32 v27, v27, v26
    v_accvgpr_write_b32 a180, v27
    v_accvgpr_read_b32 v27, a181
    v_mul_f32 v27, v27, v26
    v_accvgpr_write_b32 a181, v27
    v_accvgpr_read_b32 v27, a182
    v_mul_f32 v27, v27, v26
    v_accvgpr_write_b32 a182, v27
    v_accvgpr_read_b32 v27, a183
    v_mul_f32 v27, v27, v26
    v_accvgpr_write_b32 a183, v27
    v_accvgpr_read_b32 v27, a184
    v_mul_f32 v27, v27, v26
    v_accvgpr_write_b32 a184, v27
    v_accvgpr_read_b32 v27, a185
    v_mul_f32 v27, v27, v26
    v_accvgpr_write_b32 a185, v27
    v_accvgpr_read_b32 v27, a186
    v_mul_f32 v27, v27, v26
    v_accvgpr_write_b32 a186, v27
    v_accvgpr_read_b32 v27, a187
    v_mul_f32 v27, v27, v26
    v_accvgpr_write_b32 a187, v27
    v_accvgpr_read_b32 v27, a188
    v_mul_f32 v27, v27, v26
    v_accvgpr_write_b32 a188, v27
    v_accvgpr_read_b32 v27, a189
    v_mul_f32 v27, v27, v26
    v_accvgpr_write_b32 a189, v27
    v_accvgpr_read_b32 v27, a190
    v_mul_f32 v27, v27, v26
    v_accvgpr_write_b32 a190, v27
    v_accvgpr_read_b32 v27, a191
    v_mul_f32 v27, v27, v26
    v_accvgpr_write_b32 a191, v27
    v_mov_b32 v20, 0
    v_exp_f32 v25, v40
    v_exp_f32 v27, v41
    s_nop 0
    v_add_f32 v20, v20, v25
    v_add_f32 v20, v20, v27
    v_cvt_pk_bf16_f32 v72, v25, v27
    v_exp_f32 v25, v42
    v_exp_f32 v27, v43
    s_nop 0
    v_add_f32 v20, v20, v25
    v_add_f32 v20, v20, v27
    v_cvt_pk_bf16_f32 v73, v25, v27
    v_exp_f32 v25, v44
    v_exp_f32 v27, v45
    s_nop 0
    v_add_f32 v20, v20, v25
    v_add_f32 v20, v20, v27
    v_cvt_pk_bf16_f32 v74, v25, v27
    v_exp_f32 v25, v46
    v_exp_f32 v27, v47
    s_nop 0
    v_add_f32 v20, v20, v25
    v_add_f32 v20, v20, v27
    v_cvt_pk_bf16_f32 v75, v25, v27
    v_exp_f32 v25, v48
    v_exp_f32 v27, v49
    s_nop 0
    v_add_f32 v20, v20, v25
    v_add_f32 v20, v20, v27
    v_cvt_pk_bf16_f32 v76, v25, v27
    v_exp_f32 v25, v50
    v_exp_f32 v27, v51
    s_nop 0
    v_add_f32 v20, v20, v25
    v_add_f32 v20, v20, v27
    v_cvt_pk_bf16_f32 v77, v25, v27
    v_exp_f32 v25, v52
    v_exp_f32 v27, v53
    s_nop 0
    v_add_f32 v20, v20, v25
    v_add_f32 v20, v20, v27
    v_cvt_pk_bf16_f32 v78, v25, v27
    v_exp_f32 v25, v54
    v_exp_f32 v27, v55
    s_nop 0
    v_add_f32 v20, v20, v25
    v_add_f32 v20, v20, v27
    v_cvt_pk_bf16_f32 v79, v25, v27
    s_nop 3
    s_setpc_b64 s[30:31]
L_h201:
    s_nop 15
    s_nop 15
    v_max3_f32 v25, v40, v41, 0
    v_max3_f32 v25, v25, v42, v43
    v_max3_f32 v25, v25, v44, v45
    v_max3_f32 v25, v25, v46, v47
    v_max3_f32 v25, v25, v48, v49
    v_max3_f32 v25, v25, v50, v51
    v_max3_f32 v25, v25, v52, v53
    v_max3_f32 v25, v25, v54, v55
    v_mov_b32 v26, v25
    s_nop 1
    v_permlane32_swap_b32 v25, v26
    s_nop 1
    v_max_f32 v25, v25, v26
    v_sub_f32 v26, 0, v25
    v_exp_f32 v26, v26
    v_sub_f32 v120, v120, v25
    v_sub_f32 v121, v121, v25
    v_sub_f32 v122, v122, v25
    v_sub_f32 v123, v123, v25
    v_sub_f32 v124, v124, v25
    v_sub_f32 v125, v125, v25
    v_sub_f32 v126, v126, v25
    v_sub_f32 v127, v127, v25
    v_sub_f32 v128, v128, v25
    v_sub_f32 v129, v129, v25
    v_sub_f32 v130, v130, v25
    v_sub_f32 v131, v131, v25
    v_sub_f32 v132, v132, v25
    v_sub_f32 v133, v133, v25
    v_sub_f32 v134, v134, v25
    v_sub_f32 v135, v135, v25
    v_sub_f32 v40, v40, v25
    v_sub_f32 v41, v41, v25
    v_sub_f32 v42, v42, v25
    v_sub_f32 v43, v43, v25
    v_sub_f32 v44, v44, v25
    v_sub_f32 v45, v45, v25
    v_sub_f32 v46, v46, v25
    v_sub_f32 v47, v47, v25
    v_sub_f32 v48, v48, v25
    v_sub_f32 v49, v49, v25
    v_sub_f32 v50, v50, v25
    v_sub_f32 v51, v51, v25
    v_sub_f32 v52, v52, v25
    v_sub_f32 v53, v53, v25
    v_sub_f32 v54, v54, v25
    v_sub_f32 v55, v55, v25
    v_sub_f32 v56, v56, v25
    v_sub_f32 v57, v57, v25
    v_sub_f32 v58, v58, v25
    v_sub_f32 v59, v59, v25
    v_sub_f32 v60, v60, v25
    v_sub_f32 v61, v61, v25
    v_sub_f32 v62, v62, v25
    v_sub_f32 v63, v63, v25
    v_sub_f32 v64, v64, v25
    v_sub_f32 v65, v65, v25
    v_sub_f32 v66, v66, v25
    v_sub_f32 v67, v67, v25
    v_sub_f32 v68, v68, v25
    v_sub_f32 v69, v69, v25
    v_sub_f32 v70, v70, v25
    v_sub_f32 v71, v71, v25
    v_mul_f32 v19, v19, v26
    v_accvgpr_read_b32 v27, a128
    v_mul_f32 v27, v27, v26
    v_accvgpr_write_b32 a128, v27
    v_accvgpr_read_b32 v27, a129
    v_mul_f32 v27, v27, v26
    v_accvgpr_write_b32 a129, v27
    v_accvgpr_read_b32 v27, a130
    v_mul_f32 v27, v27, v26
    v_accvgpr_write_b32 a130, v27
    v_accvgpr_read_b32 v27, a131
    v_mul_f32 v27, v27, v26
    v_accvgpr_write_b32 a131, v27
    v_accvgpr_read_b32 v27, a132
    v_mul_f32 v27, v27, v26
    v_accvgpr_write_b32 a132, v27
    v_accvgpr_read_b32 v27, a133
    v_mul_f32 v27, v27, v26
    v_accvgpr_write_b32 a133, v27
    v_accvgpr_read_b32 v27, a134
    v_mul_f32 v27, v27, v26
    v_accvgpr_write_b32 a134, v27
    v_accvgpr_read_b32 v27, a135
    v_mul_f32 v27, v27, v26
    v_accvgpr_write_b32 a135, v27
    v_accvgpr_read_b32 v27, a136
    v_mul_f32 v27, v27, v26
    v_accvgpr_write_b32 a136, v27
    v_accvgpr_read_b32 v27, a137
    v_mul_f32 v27, v27, v26
    v_accvgpr_write_b32 a137, v27
    v_accvgpr_read_b32 v27, a138
    v_mul_f32 v27, v27, v26
    v_accvgpr_write_b32 a138, v27
    v_accvgpr_read_b32 v27, a139
    v_mul_f32 v27, v27, v26
    v_accvgpr_write_b32 a139, v27
    v_accvgpr_read_b32 v27, a140
    v_mul_f32 v27, v27, v26
    v_accvgpr_write_b32 a140, v27
    v_accvgpr_read_b32 v27, a141
    v_mul_f32 v27, v27, v26
    v_accvgpr_write_b32 a141, v27
    v_accvgpr_read_b32 v27, a142
    v_mul_f32 v27, v27, v26
    v_accvgpr_write_b32 a142, v27
    v_accvgpr_read_b32 v27, a143
    v_mul_f32 v27, v27, v26
    v_accvgpr_write_b32 a143, v27
    v_accvgpr_read_b32 v27, a144
    v_mul_f32 v27, v27, v26
    v_accvgpr_write_b32 a144, v27
    v_accvgpr_read_b32 v27, a145
    v_mul_f32 v27, v27, v26
    v_accvgpr_write_b32 a145, v27
    v_accvgpr_read_b32 v27, a146
    v_mul_f32 v27, v27, v26
    v_accvgpr_write_b32 a146, v27
    v_accvgpr_read_b32 v27, a147
    v_mul_f32 v27, v27, v26
    v_accvgpr_write_b32 a147, v27
    v_accvgpr_read_b32 v27, a148
    v_mul_f32 v27, v27, v26
    v_accvgpr_write_b32 a148, v27
    v_accvgpr_read_b32 v27, a149
    v_mul_f32 v27, v27, v26
    v_accvgpr_write_b32 a149, v27
    v_accvgpr_read_b32 v27, a150
    v_mul_f32 v27, v27, v26
    v_accvgpr_write_b32 a150, v27
    v_accvgpr_read_b32 v27, a151
    v_mul_f32 v27, v27, v26
    v_accvgpr_write_b32 a151, v27
    v_accvgpr_read_b32 v27, a152
    v_mul_f32 v27, v27, v26
    v_accvgpr_write_b32 a152, v27
    v_accvgpr_read_b32 v27, a153
    v_mul_f32 v27, v27, v26
    v_accvgpr_write_b32 a153, v27
    v_accvgpr_read_b32 v27, a154
    v_mul_f32 v27, v27, v26
    v_accvgpr_write_b32 a154, v27
    v_accvgpr_read_b32 v27, a155
    v_mul_f32 v27, v27, v26
    v_accvgpr_write_b32 a155, v27
    v_accvgpr_read_b32 v27, a156
    v_mul_f32 v27, v27, v26
    v_accvgpr_write_b32 a156, v27
    v_accvgpr_read_b32 v27, a157
    v_mul_f32 v27, v27, v26
    v_accvgpr_write_b32 a157, v27
    v_accvgpr_read_b32 v27, a158
    v_mul_f32 v27, v27, v26
    v_accvgpr_write_b32 a158, v27
    v_accvgpr_read_b32 v27, a159
    v_mul_f32 v27, v27, v26
    v_accvgpr_write_b32 a159, v27
    v_accvgpr_read_b32 v27, a160
    v_mul_f32 v27, v27, v26
    v_accvgpr_write_b32 a160, v27
    v_accvgpr_read_b32 v27, a161
    v_mul_f32 v27, v27, v26
    v_accvgpr_write_b32 a161, v27
    v_accvgpr_read_b32 v27, a162
    v_mul_f32 v27, v27, v26
    v_accvgpr_write_b32 a162, v27
    v_accvgpr_read_b32 v27, a163
    v_mul_f32 v27, v27, v26
    v_accvgpr_write_b32 a163, v27
    v_accvgpr_read_b32 v27, a164
    v_mul_f32 v27, v27, v26
    v_accvgpr_write_b32 a164, v27
    v_accvgpr_read_b32 v27, a165
    v_mul_f32 v27, v27, v26
    v_accvgpr_write_b32 a165, v27
    v_accvgpr_read_b32 v27, a166
    v_mul_f32 v27, v27, v26
    v_accvgpr_write_b32 a166, v27
    v_accvgpr_read_b32 v27, a167
    v_mul_f32 v27, v27, v26
    v_accvgpr_write_b32 a167, v27
    v_accvgpr_read_b32 v27, a168
    v_mul_f32 v27, v27, v26
    v_accvgpr_write_b32 a168, v27
    v_accvgpr_read_b32 v27, a169
    v_mul_f32 v27, v27, v26
    v_accvgpr_write_b32 a169, v27
    v_accvgpr_read_b32 v27, a170
    v_mul_f32 v27, v27, v26
    v_accvgpr_write_b32 a170, v27
    v_accvgpr_read_b32 v27, a171
    v_mul_f32 v27, v27, v26
    v_accvgpr_write_b32 a171, v27
    v_accvgpr_read_b32 v27, a172
    v_mul_f32 v27, v27, v26
    v_accvgpr_write_b32 a172, v27
    v_accvgpr_read_b32 v27, a173
    v_mul_f32 v27, v27, v26
    v_accvgpr_write_b32 a173, v27
    v_accvgpr_read_b32 v27, a174
    v_mul_f32 v27, v27, v26
    v_accvgpr_write_b32 a174, v27
    v_accvgpr_read_b32 v27, a175
    v_mul_f32 v27, v27, v26
    v_accvgpr_write_b32 a175, v27
    v_accvgpr_read_b32 v27, a176
    v_mul_f32 v27, v27, v26
    v_accvgpr_write_b32 a176, v27
    v_accvgpr_read_b32 v27, a177
    v_mul_f32 v27, v27, v26
    v_accvgpr_write_b32 a177, v27
    v_accvgpr_read_b32 v27, a178
    v_mul_f32 v27, v27, v26
    v_accvgpr_write_b32 a178, v27
    v_accvgpr_read_b32 v27, a179
    v_mul_f32 v27, v27, v26
    v_accvgpr_write_b32 a179, v27
    v_accvgpr_read_b32 v27, a180
    v_mul_f32 v27, v27, v26
    v_accvgpr_write_b32 a180, v27
    v_accvgpr_read_b32 v27, a181
    v_mul_f32 v27, v27, v26
    v_accvgpr_write_b32 a181, v27
    v_accvgpr_read_b32 v27, a182
    v_mul_f32 v27, v27, v26
    v_accvgpr_write_b32 a182, v27
    v_accvgpr_read_b32 v27, a183
    v_mul_f32 v27, v27, v26
    v_accvgpr_write_b32 a183, v27
    v_accvgpr_read_b32 v27, a184
    v_mul_f32 v27, v27, v26
    v_accvgpr_write_b32 a184, v27
    v_accvgpr_read_b32 v27, a185
    v_mul_f32 v27, v27, v26
    v_accvgpr_write_b32 a185, v27
    v_accvgpr_read_b32 v27, a186
    v_mul_f32 v27, v27, v26
    v_accvgpr_write_b32 a186, v27
    v_accvgpr_read_b32 v27, a187
    v_mul_f32 v27, v27, v26
    v_accvgpr_write_b32 a187, v27
    v_accvgpr_read_b32 v27, a188
    v_mul_f32 v27, v27, v26
    v_accvgpr_write_b32 a188, v27
    v_accvgpr_read_b32 v27, a189
    v_mul_f32 v27, v27, v26
    v_accvgpr_write_b32 a189, v27
    v_accvgpr_read_b32 v27, a190
    v_mul_f32 v27, v27, v26
    v_accvgpr_write_b32 a190, v27
    v_accvgpr_read_b32 v27, a191
    v_mul_f32 v27, v27, v26
    v_accvgpr_write_b32 a191, v27
    v_mov_b32 v20, 0
    v_exp_f32 v25, v40
    v_exp_f32 v27, v41
    s_nop 0
    v_add_f32 v20, v20, v25
    v_add_f32 v20, v20, v27
    v_cvt_pk_bf16_f32 v72, v25, v27
    v_exp_f32 v25, v42
    v_exp_f32 v27, v43
    s_nop 0
    v_add_f32 v20, v20, v25
    v_add_f32 v20, v20, v27
    v_cvt_pk_bf16_f32 v73, v25, v27
    v_exp_f32 v25, v44
    v_exp_f32 v27, v45
    s_nop 0
    v_add_f32 v20, v20, v25
    v_add_f32 v20, v20, v27
    v_cvt_pk_bf16_f32 v74, v25, v27
    v_exp_f32 v25, v46
    v_exp_f32 v27, v47
    s_nop 0
    v_add_f32 v20, v20, v25
    v_add_f32 v20, v20, v27
    v_cvt_pk_bf16_f32 v75, v25, v27
    v_exp_f32 v25, v48
    v_exp_f32 v27, v49
    s_nop 0
    v_add_f32 v20, v20, v25
    v_add_f32 v20, v20, v27
    v_cvt_pk_bf16_f32 v76, v25, v27
    v_exp_f32 v25, v50
    v_exp_f32 v27, v51
    s_nop 0
    v_add_f32 v20, v20, v25
    v_add_f32 v20, v20, v27
    v_cvt_pk_bf16_f32 v77, v25, v27
    v_exp_f32 v25, v52
    v_exp_f32 v27, v53
    s_nop 0
    v_add_f32 v20, v20, v25
    v_add_f32 v20, v20, v27
    v_cvt_pk_bf16_f32 v78, v25, v27
    v_exp_f32 v25, v54
    v_exp_f32 v27, v55
    s_nop 0
    v_add_f32 v20, v20, v25
    v_add_f32 v20, v20, v27
    v_cvt_pk_bf16_f32 v79, v25, v27
    s_nop 3
    s_setpc_b64 s[30:31]
L_h210:
    s_nop 15
    s_nop 15
    v_max3_f32 v25, v56, v57, 0
    v_max3_f32 v25, v25, v58, v59
    v_max3_f32 v25, v25, v60, v61
    v_max3_f32 v25, v25, v62, v63
    v_max3_f32 v25, v25, v64, v65
    v_max3_f32 v25, v25, v66, v67
    v_max3_f32 v25, v25, v68, v69
    v_max3_f32 v25, v25, v70, v71
    v_mov_b32 v26, v25
    s_nop 1
    v_permlane32_swap_b32 v25, v26
    s_nop 1
    v_max_f32 v25, v25, v26
    v_sub_f32 v26, 0, v25
    v_exp_f32 v26, v26
    v_sub_f32 v120, v120, v25
    v_sub_f32 v121, v121, v25
    v_sub_f32 v122, v122, v25
    v_sub_f32 v123, v123, v25
    v_sub_f32 v124, v124, v25
    v_sub_f32 v125, v125, v25
    v_sub_f32 v126, v126, v25
    v_sub_f32 v127, v127, v25
    v_sub_f32 v128, v128, v25
    v_sub_f32 v129, v129, v25
    v_sub_f32 v130, v130, v25
    v_sub_f32 v131, v131, v25
    v_sub_f32 v132, v132, v25
    v_sub_f32 v133, v133, v25
    v_sub_f32 v134, v134, v25
    v_sub_f32 v135, v135, v25
    v_sub_f32 v56, v56, v25
    v_sub_f32 v57, v57, v25
    v_sub_f32 v58, v58, v25
    v_sub_f32 v59, v59, v25
    v_sub_f32 v60, v60, v25
    v_sub_f32 v61, v61, v25
    v_sub_f32 v62, v62, v25
    v_sub_f32 v63, v63, v25
    v_sub_f32 v64, v64, v25
    v_sub_f32 v65, v65, v25
    v_sub_f32 v66, v66, v25
    v_sub_f32 v67, v67, v25
    v_sub_f32 v68, v68, v25
    v_sub_f32 v69, v69, v25
    v_sub_f32 v70, v70, v25
    v_sub_f32 v71, v71, v25
    v_mul_f32 v19, v19, v26
    v_accvgpr_read_b32 v27, a128
    v_mul_f32 v27, v27, v26
    v_accvgpr_write_b32 a128, v27
    v_accvgpr_read_b32 v27, a129
    v_mul_f32 v27, v27, v26
    v_accvgpr_write_b32 a129, v27
    v_accvgpr_read_b32 v27, a130
    v_mul_f32 v27, v27, v26
    v_accvgpr_write_b32 a130, v27
    v_accvgpr_read_b32 v27, a131
    v_mul_f32 v27, v27, v26
    v_accvgpr_write_b32 a131, v27
    v_accvgpr_read_b32 v27, a132
    v_mul_f32 v27, v27, v26
    v_accvgpr_write_b32 a132, v27
    v_accvgpr_read_b32 v27, a133
    v_mul_f32 v27, v27, v26
    v_accvgpr_write_b32 a133, v27
    v_accvgpr_read_b32 v27, a134
    v_mul_f32 v27, v27, v26
    v_accvgpr_write_b32 a134, v27
    v_accvgpr_read_b32 v27, a135
    v_mul_f32 v27, v27, v26
    v_accvgpr_write_b32 a135, v27
    v_accvgpr_read_b32 v27, a136
    v_mul_f32 v27, v27, v26
    v_accvgpr_write_b32 a136, v27
    v_accvgpr_read_b32 v27, a137
    v_mul_f32 v27, v27, v26
    v_accvgpr_write_b32 a137, v27
    v_accvgpr_read_b32 v27, a138
    v_mul_f32 v27, v27, v26
    v_accvgpr_write_b32 a138, v27
    v_accvgpr_read_b32 v27, a139
    v_mul_f32 v27, v27, v26
    v_accvgpr_write_b32 a139, v27
    v_accvgpr_read_b32 v27, a140
    v_mul_f32 v27, v27, v26
    v_accvgpr_write_b32 a140, v27
    v_accvgpr_read_b32 v27, a141
    v_mul_f32 v27, v27, v26
    v_accvgpr_write_b32 a141, v27
    v_accvgpr_read_b32 v27, a142
    v_mul_f32 v27, v27, v26
    v_accvgpr_write_b32 a142, v27
    v_accvgpr_read_b32 v27, a143
    v_mul_f32 v27, v27, v26
    v_accvgpr_write_b32 a143, v27
    v_accvgpr_read_b32 v27, a144
    v_mul_f32 v27, v27, v26
    v_accvgpr_write_b32 a144, v27
    v_accvgpr_read_b32 v27, a145
    v_mul_f32 v27, v27, v26
    v_accvgpr_write_b32 a145, v27
    v_accvgpr_read_b32 v27, a146
    v_mul_f32 v27, v27, v26
    v_accvgpr_write_b32 a146, v27
    v_accvgpr_read_b32 v27, a147
    v_mul_f32 v27, v27, v26
    v_accvgpr_write_b32 a147, v27
    v_accvgpr_read_b32 v27, a148
    v_mul_f32 v27, v27, v26
    v_accvgpr_write_b32 a148, v27
    v_accvgpr_read_b32 v27, a149
    v_mul_f32 v27, v27, v26
    v_accvgpr_write_b32 a149, v27
    v_accvgpr_read_b32 v27, a150
    v_mul_f32 v27, v27, v26
    v_accvgpr_write_b32 a150, v27
    v_accvgpr_read_b32 v27, a151
    v_mul_f32 v27, v27, v26
    v_accvgpr_write_b32 a151, v27
    v_accvgpr_read_b32 v27, a152
    v_mul_f32 v27, v27, v26
    v_accvgpr_write_b32 a152, v27
    v_accvgpr_read_b32 v27, a153
    v_mul_f32 v27, v27, v26
    v_accvgpr_write_b32 a153, v27
    v_accvgpr_read_b32 v27, a154
    v_mul_f32 v27, v27, v26
    v_accvgpr_write_b32 a154, v27
    v_accvgpr_read_b32 v27, a155
    v_mul_f32 v27, v27, v26
    v_accvgpr_write_b32 a155, v27
    v_accvgpr_read_b32 v27, a156
    v_mul_f32 v27, v27, v26
    v_accvgpr_write_b32 a156, v27
    v_accvgpr_read_b32 v27, a157
    v_mul_f32 v27, v27, v26
    v_accvgpr_write_b32 a157, v27
    v_accvgpr_read_b32 v27, a158
    v_mul_f32 v27, v27, v26
    v_accvgpr_write_b32 a158, v27
    v_accvgpr_read_b32 v27, a159
    v_mul_f32 v27, v27, v26
    v_accvgpr_write_b32 a159, v27
    v_accvgpr_read_b32 v27, a160
    v_mul_f32 v27, v27, v26
    v_accvgpr_write_b32 a160, v27
    v_accvgpr_read_b32 v27, a161
    v_mul_f32 v27, v27, v26
    v_accvgpr_write_b32 a161, v27
    v_accvgpr_read_b32 v27, a162
    v_mul_f32 v27, v27, v26
    v_accvgpr_write_b32 a162, v27
    v_accvgpr_read_b32 v27, a163
    v_mul_f32 v27, v27, v26
    v_accvgpr_write_b32 a163, v27
    v_accvgpr_read_b32 v27, a164
    v_mul_f32 v27, v27, v26
    v_accvgpr_write_b32 a164, v27
    v_accvgpr_read_b32 v27, a165
    v_mul_f32 v27, v27, v26
    v_accvgpr_write_b32 a165, v27
    v_accvgpr_read_b32 v27, a166
    v_mul_f32 v27, v27, v26
    v_accvgpr_write_b32 a166, v27
    v_accvgpr_read_b32 v27, a167
    v_mul_f32 v27, v27, v26
    v_accvgpr_write_b32 a167, v27
    v_accvgpr_read_b32 v27, a168
    v_mul_f32 v27, v27, v26
    v_accvgpr_write_b32 a168, v27
    v_accvgpr_read_b32 v27, a169
    v_mul_f32 v27, v27, v26
    v_accvgpr_write_b32 a169, v27
    v_accvgpr_read_b32 v27, a170
    v_mul_f32 v27, v27, v26
    v_accvgpr_write_b32 a170, v27
    v_accvgpr_read_b32 v27, a171
    v_mul_f32 v27, v27, v26
    v_accvgpr_write_b32 a171, v27
    v_accvgpr_read_b32 v27, a172
    v_mul_f32 v27, v27, v26
    v_accvgpr_write_b32 a172, v27
    v_accvgpr_read_b32 v27, a173
    v_mul_f32 v27, v27, v26
    v_accvgpr_write_b32 a173, v27
    v_accvgpr_read_b32 v27, a174
    v_mul_f32 v27, v27, v26
    v_accvgpr_write_b32 a174, v27
    v_accvgpr_read_b32 v27, a175
    v_mul_f32 v27, v27, v26
    v_accvgpr_write_b32 a175, v27
    v_accvgpr_read_b32 v27, a176
    v_mul_f32 v27, v27, v26
    v_accvgpr_write_b32 a176, v27
    v_accvgpr_read_b32 v27, a177
    v_mul_f32 v27, v27, v26
    v_accvgpr_write_b32 a177, v27
    v_accvgpr_read_b32 v27, a178
    v_mul_f32 v27, v27, v26
    v_accvgpr_write_b32 a178, v27
    v_accvgpr_read_b32 v27, a179
    v_mul_f32 v27, v27, v26
    v_accvgpr_write_b32 a179, v27
    v_accvgpr_read_b32 v27, a180
    v_mul_f32 v27, v27, v26
    v_accvgpr_write_b32 a180, v27
    v_accvgpr_read_b32 v27, a181
    v_mul_f32 v27, v27, v26
    v_accvgpr_write_b32 a181, v27
    v_accvgpr_read_b32 v27, a182
    v_mul_f32 v27, v27, v26
    v_accvgpr_write_b32 a182, v27
    v_accvgpr_read_b32 v27, a183
    v_mul_f32 v27, v27, v26
    v_accvgpr_write_b32 a183, v27
    v_accvgpr_read_b32 v27, a184
    v_mul_f32 v27, v27, v26
    v_accvgpr_write_b32 a184, v27
    v_accvgpr_read_b32 v27, a185
    v_mul_f32 v27, v27, v26
    v_accvgpr_write_b32 a185, v27
    v_accvgpr_read_b32 v27, a186
    v_mul_f32 v27, v27, v26
    v_accvgpr_write_b32 a186, v27
    v_accvgpr_read_b32 v27, a187
    v_mul_f32 v27, v27, v26
    v_accvgpr_write_b32 a187, v27
    v_accvgpr_read_b32 v27, a188
    v_mul_f32 v27, v27, v26
    v_accvgpr_write_b32 a188, v27
    v_accvgpr_read_b32 v27, a189
    v_mul_f32 v27, v27, v26
    v_accvgpr_write_b32 a189, v27
    v_accvgpr_read_b32 v27, a190
    v_mul_f32 v27, v27, v26
    v_accvgpr_write_b32 a190, v27
    v_accvgpr_read_b32 v27, a191
    v_mul_f32 v27, v27, v26
    v_accvgpr_write_b32 a191, v27
    v_mov_b32 v21, 0
    v_exp_f32 v25, v56
    v_exp_f32 v27, v57
    s_nop 0
    v_add_f32 v21, v21, v25
    v_add_f32 v21, v21, v27
    v_cvt_pk_bf16_f32 v80, v25, v27
    v_exp_f32 v25, v58
    v_exp_f32 v27, v59
    s_nop 0
    v_add_f32 v21, v21, v25
    v_add_f32 v21, v21, v27
    v_cvt_pk_bf16_f32 v81, v25, v27
    v_exp_f32 v25, v60
    v_exp_f32 v27, v61
    s_nop 0
    v_add_f32 v21, v21, v25
    v_add_f32 v21, v21, v27
    v_cvt_pk_bf16_f32 v82, v25, v27
    v_exp_f32 v25, v62
    v_exp_f32 v27, v63
    s_nop 0
    v_add_f32 v21, v21, v25
    v_add_f32 v21, v21, v27
    v_cvt_pk_bf16_f32 v83, v25, v27
    v_exp_f32 v25, v64
    v_exp_f32 v27, v65
    s_nop 0
    v_add_f32 v21, v21, v25
    v_add_f32 v21, v21, v27
    v_cvt_pk_bf16_f32 v84, v25, v27
    v_exp_f32 v25, v66
    v_exp_f32 v27, v67
    s_nop 0
    v_add_f32 v21, v21, v25
    v_add_f32 v21, v21, v27
    v_cvt_pk_bf16_f32 v85, v25, v27
    v_exp_f32 v25, v68
    v_exp_f32 v27, v69
    s_nop 0
    v_add_f32 v21, v21, v25
    v_add_f32 v21, v21, v27
    v_cvt_pk_bf16_f32 v86, v25, v27
    v_exp_f32 v25, v70
    v_exp_f32 v27, v71
    s_nop 0
    v_add_f32 v21, v21, v25
    v_add_f32 v21, v21, v27
    v_cvt_pk_bf16_f32 v87, v25, v27
    s_nop 3
    s_setpc_b64 s[30:31]
L_h211:
    s_nop 15
    s_nop 15
    v_max3_f32 v25, v56, v57, 0
    v_max3_f32 v25, v25, v58, v59
    v_max3_f32 v25, v25, v60, v61
    v_max3_f32 v25, v25, v62, v63
    v_max3_f32 v25, v25, v64, v65
    v_max3_f32 v25, v25, v66, v67
    v_max3_f32 v25, v25, v68, v69
    v_max3_f32 v25, v25, v70, v71
    v_mov_b32 v26, v25
    s_nop 1
    v_permlane32_swap_b32 v25, v26
    s_nop 1
    v_max_f32 v25, v25, v26
    v_sub_f32 v26, 0, v25
    v_exp_f32 v26, v26
    v_sub_f32 v120, v120, v25
    v_sub_f32 v121, v121, v25
    v_sub_f32 v122, v122, v25
    v_sub_f32 v123, v123, v25
    v_sub_f32 v124, v124, v25
    v_sub_f32 v125, v125, v25
    v_sub_f32 v126, v126, v25
    v_sub_f32 v127, v127, v25
    v_sub_f32 v128, v128, v25
    v_sub_f32 v129, v129, v25
    v_sub_f32 v130, v130, v25
    v_sub_f32 v131, v131, v25
    v_sub_f32 v132, v132, v25
    v_sub_f32 v133, v133, v25
    v_sub_f32 v134, v134, v25
    v_sub_f32 v135, v135, v25
    v_sub_f32 v56, v56, v25
    v_sub_f32 v57, v57, v25
    v_sub_f32 v58, v58, v25
    v_sub_f32 v59, v59, v25
    v_sub_f32 v60, v60, v25
    v_sub_f32 v61, v61, v25
    v_sub_f32 v62, v62, v25
    v_sub_f32 v63, v63, v25
    v_sub_f32 v64, v64, v25
    v_sub_f32 v65, v65, v25
    v_sub_f32 v66, v66, v25
    v_sub_f32 v67, v67, v25
    v_sub_f32 v68, v68, v25
    v_sub_f32 v69, v69, v25
    v_sub_f32 v70, v70, v25
    v_sub_f32 v71, v71, v25
    v_sub_f32 v40, v40, v25
    v_sub_f32 v41, v41, v25
    v_sub_f32 v42, v42, v25
    v_sub_f32 v43, v43, v25
    v_sub_f32 v44, v44, v25
    v_sub_f32 v45, v45, v25
    v_sub_f32 v46, v46, v25
    v_sub_f32 v47, v47, v25
    v_sub_f32 v48, v48, v25
    v_sub_f32 v49, v49, v25
    v_sub_f32 v50, v50, v25
    v_sub_f32 v51, v51, v25
    v_sub_f32 v52, v52, v25
    v_sub_f32 v53, v53, v25
    v_sub_f32 v54, v54, v25
    v_sub_f32 v55, v55, v25
    v_mul_f32 v19, v19, v26
    v_accvgpr_read_b32 v27, a128
    v_mul_f32 v27, v27, v26
    v_accvgpr_write_b32 a128, v27
    v_accvgpr_read_b32 v27, a129
    v_mul_f32 v27, v27, v26
    v_accvgpr_write_b32 a129, v27
    v_accvgpr_read_b32 v27, a130
    v_mul_f32 v27, v27, v26
    v_accvgpr_write_b32 a130, v27
    v_accvgpr_read_b32 v27, a131
    v_mul_f32 v27, v27, v26
    v_accvgpr_write_b32 a131, v27
    v_accvgpr_read_b32 v27, a132
    v_mul_f32 v27, v27, v26
    v_accvgpr_write_b32 a132, v27
    v_accvgpr_read_b32 v27, a133
    v_mul_f32 v27, v27, v26
    v_accvgpr_write_b32 a133, v27
    v_accvgpr_read_b32 v27, a134
    v_mul_f32 v27, v27, v26
    v_accvgpr_write_b32 a134, v27
    v_accvgpr_read_b32 v27, a135
    v_mul_f32 v27, v27, v26
    v_accvgpr_write_b32 a135, v27
    v_accvgpr_read_b32 v27, a136
    v_mul_f32 v27, v27, v26
    v_accvgpr_write_b32 a136, v27
    v_accvgpr_read_b32 v27, a137
    v_mul_f32 v27, v27, v26
    v_accvgpr_write_b32 a137, v27
    v_accvgpr_read_b32 v27, a138
    v_mul_f32 v27, v27, v26
    v_accvgpr_write_b32 a138, v27
    v_accvgpr_read_b32 v27, a139
    v_mul_f32 v27, v27, v26
    v_accvgpr_write_b32 a139, v27
    v_accvgpr_read_b32 v27, a140
    v_mul_f32 v27, v27, v26
    v_accvgpr_write_b32 a140, v27
    v_accvgpr_read_b32 v27, a141
    v_mul_f32 v27, v27, v26
    v_accvgpr_write_b32 a141, v27
    v_accvgpr_read_b32 v27, a142
    v_mul_f32 v27, v27, v26
    v_accvgpr_write_b32 a142, v27
    v_accvgpr_read_b32 v27, a143
    v_mul_f32 v27, v27, v26
    v_accvgpr_write_b32 a143, v27
    v_accvgpr_read_b32 v27, a144
    v_mul_f32 v27, v27, v26
    v_accvgpr_write_b32 a144, v27
    v_accvgpr_read_b32 v27, a145
    v_mul_f32 v27, v27, v26
    v_accvgpr_write_b32 a145, v27
    v_accvgpr_read_b32 v27, a146
    v_mul_f32 v27, v27, v26
    v_accvgpr_write_b32 a146, v27
    v_accvgpr_read_b32 v27, a147
    v_mul_f32 v27, v27, v26
    v_accvgpr_write_b32 a147, v27
    v_accvgpr_read_b32 v27, a148
    v_mul_f32 v27, v27, v26
    v_accvgpr_write_b32 a148, v27
    v_accvgpr_read_b32 v27, a149
    v_mul_f32 v27, v27, v26
    v_accvgpr_write_b32 a149, v27
    v_accvgpr_read_b32 v27, a150
    v_mul_f32 v27, v27, v26
    v_accvgpr_write_b32 a150, v27
    v_accvgpr_read_b32 v27, a151
    v_mul_f32 v27, v27, v26
    v_accvgpr_write_b32 a151, v27
    v_accvgpr_read_b32 v27, a152
    v_mul_f32 v27, v27, v26
    v_accvgpr_write_b32 a152, v27
    v_accvgpr_read_b32 v27, a153
    v_mul_f32 v27, v27, v26
    v_accvgpr_write_b32 a153, v27
    v_accvgpr_read_b32 v27, a154
    v_mul_f32 v27, v27, v26
    v_accvgpr_write_b32 a154, v27
    v_accvgpr_read_b32 v27, a155
    v_mul_f32 v27, v27, v26
    v_accvgpr_write_b32 a155, v27
    v_accvgpr_read_b32 v27, a156
    v_mul_f32 v27, v27, v26
    v_accvgpr_write_b32 a156, v27
    v_accvgpr_read_b32 v27, a157
    v_mul_f32 v27, v27, v26
    v_accvgpr_write_b32 a157, v27
    v_accvgpr_read_b32 v27, a158
    v_mul_f32 v27, v27, v26
    v_accvgpr_write_b32 a158, v27
    v_accvgpr_read_b32 v27, a159
    v_mul_f32 v27, v27, v26
    v_accvgpr_write_b32 a159, v27
    v_accvgpr_read_b32 v27, a160
    v_mul_f32 v27, v27, v26
    v_accvgpr_write_b32 a160, v27
    v_accvgpr_read_b32 v27, a161
    v_mul_f32 v27, v27, v26
    v_accvgpr_write_b32 a161, v27
    v_accvgpr_read_b32 v27, a162
    v_mul_f32 v27, v27, v26
    v_accvgpr_write_b32 a162, v27
    v_accvgpr_read_b32 v27, a163
    v_mul_f32 v27, v27, v26
    v_accvgpr_write_b32 a163, v27
    v_accvgpr_read_b32 v27, a164
    v_mul_f32 v27, v27, v26
    v_accvgpr_write_b32 a164, v27
    v_accvgpr_read_b32 v27, a165
    v_mul_f32 v27, v27, v26
    v_accvgpr_write_b32 a165, v27
    v_accvgpr_read_b32 v27, a166
    v_mul_f32 v27, v27, v26
    v_accvgpr_write_b32 a166, v27
    v_accvgpr_read_b32 v27, a167
    v_mul_f32 v27, v27, v26
    v_accvgpr_write_b32 a167, v27
    v_accvgpr_read_b32 v27, a168
    v_mul_f32 v27, v27, v26
    v_accvgpr_write_b32 a168, v27
    v_accvgpr_read_b32 v27, a169
    v_mul_f32 v27, v27, v26
    v_accvgpr_write_b32 a169, v27
    v_accvgpr_read_b32 v27, a170
    v_mul_f32 v27, v27, v26
    v_accvgpr_write_b32 a170, v27
    v_accvgpr_read_b32 v27, a171
    v_mul_f32 v27, v27, v26
    v_accvgpr_write_b32 a171, v27
    v_accvgpr_read_b32 v27, a172
    v_mul_f32 v27, v27, v26
    v_accvgpr_write_b32 a172, v27
    v_accvgpr_read_b32 v27, a173
    v_mul_f32 v27, v27, v26
    v_accvgpr_write_b32 a173, v27
    v_accvgpr_read_b32 v27, a174
    v_mul_f32 v27, v27, v26
    v_accvgpr_write_b32 a174, v27
    v_accvgpr_read_b32 v27, a175
    v_mul_f32 v27, v27, v26
    v_accvgpr_write_b32 a175, v27
    v_accvgpr_read_b32 v27, a176
    v_mul_f32 v27, v27, v26
    v_accvgpr_write_b32 a176, v27
    v_accvgpr_read_b32 v27, a177
    v_mul_f32 v27, v27, v26
    v_accvgpr_write_b32 a177, v27
    v_accvgpr_read_b32 v27, a178
    v_mul_f32 v27, v27, v26
    v_accvgpr_write_b32 a178, v27
    v_accvgpr_read_b32 v27, a179
    v_mul_f32 v27, v27, v26
    v_accvgpr_write_b32 a179, v27
    v_accvgpr_read_b32 v27, a180
    v_mul_f32 v27, v27, v26
    v_accvgpr_write_b32 a180, v27
    v_accvgpr_read_b32 v27, a181
    v_mul_f32 v27, v27, v26
    v_accvgpr_write_b32 a181, v27
    v_accvgpr_read_b32 v27, a182
    v_mul_f32 v27, v27, v26
    v_accvgpr_write_b32 a182, v27
    v_accvgpr_read_b32 v27, a183
    v_mul_f32 v27, v27, v26
    v_accvgpr_write_b32 a183, v27
    v_accvgpr_read_b32 v27, a184
    v_mul_f32 v27, v27, v26
    v_accvgpr_write_b32 a184, v27
    v_accvgpr_read_b32 v27, a185
    v_mul_f32 v27, v27, v26
    v_accvgpr_write_b32 a185, v27
    v_accvgpr_read_b32 v27, a186
    v_mul_f32 v27, v27, v26
    v_accvgpr_write_b32 a186, v27
    v_accvgpr_read_b32 v27, a187
    v_mul_f32 v27, v27, v26
    v_accvgpr_write_b32 a187, v27
    v_accvgpr_read_b32 v27, a188
    v_mul_f32 v27, v27, v26
    v_accvgpr_write_b32 a188, v27
    v_accvgpr_read_b32 v27, a189
    v_mul_f32 v27, v27, v26
    v_accvgpr_write_b32 a189, v27
    v_accvgpr_read_b32 v27, a190
    v_mul_f32 v27, v27, v26
    v_accvgpr_write_b32 a190, v27
    v_accvgpr_read_b32 v27, a191
    v_mul_f32 v27, v27, v26
    v_accvgpr_write_b32 a191, v27
    v_mov_b32 v21, 0
    v_exp_f32 v25, v56
    v_exp_f32 v27, v57
    s_nop 0
    v_add_f32 v21, v21, v25
    v_add_f32 v21, v21, v27
    v_cvt_pk_bf16_f32 v80, v25, v27
    v_exp_f32 v25, v58
    v_exp_f32 v27, v59
    s_nop 0
    v_add_f32 v21, v21, v25
    v_add_f32 v21, v21, v27
    v_cvt_pk_bf16_f32 v81, v25, v27
    v_exp_f32 v25, v60
    v_exp_f32 v27, v61
    s_nop 0
    v_add_f32 v21, v21, v25
    v_add_f32 v21, v21, v27
    v_cvt_pk_bf16_f32 v82, v25, v27
    v_exp_f32 v25, v62
    v_exp_f32 v27, v63
    s_nop 0
    v_add_f32 v21, v21, v25
    v_add_f32 v21, v21, v27
    v_cvt_pk_bf16_f32 v83, v25, v27
    v_exp_f32 v25, v64
    v_exp_f32 v27, v65
    s_nop 0
    v_add_f32 v21, v21, v25
    v_add_f32 v21, v21, v27
    v_cvt_pk_bf16_f32 v84, v25, v27
    v_exp_f32 v25, v66
    v_exp_f32 v27, v67
    s_nop 0
    v_add_f32 v21, v21, v25
    v_add_f32 v21, v21, v27
    v_cvt_pk_bf16_f32 v85, v25, v27
    v_exp_f32 v25, v68
    v_exp_f32 v27, v69
    s_nop 0
    v_add_f32 v21, v21, v25
    v_add_f32 v21, v21, v27
    v_cvt_pk_bf16_f32 v86, v25, v27
    v_exp_f32 v25, v70
    v_exp_f32 v27, v71
    s_nop 0
    v_add_f32 v21, v21, v25
    v_add_f32 v21, v21, v27
    v_cvt_pk_bf16_f32 v87, v25, v27
    s_nop 3
    s_setpc_b64 s[30:31]
    s_endpgm
.section .rodata,"a"
.p2align 6
.amdhsa_kernel standalone__gqa_softmax__near_ridge_kernel
  .amdhsa_next_free_vgpr 512
  .amdhsa_next_free_sgpr 64
  .amdhsa_accum_offset 256
  .amdhsa_group_segment_fixed_size 0
  .amdhsa_kernarg_size 48
  .amdhsa_user_sgpr_count 2
  .amdhsa_user_sgpr_kernarg_segment_ptr 1
  .amdhsa_system_sgpr_workgroup_id_x 1
.end_amdhsa_kernel
```
